```python
import torch

def _softmax(x, axis=-1):
    return torch.softmax(x, dim=axis)
def _gelu(x):
    return torch.nn.functional.gelu(x, approximate="tanh")
def _silu(x):
    return torch.nn.functional.silu(x)
def _sigmoid(x):
    return torch.sigmoid(x)
def _layernorm(x, axis=-1, eps=1e-5):
    m = x.mean(dim=axis, keepdim=True)
    v = x.var(dim=axis, keepdim=True, unbiased=False)
    return (x - m) / torch.sqrt(v + eps)
def _scatter_add(tgt, idx, src, axis=0):
    return tgt.clone().index_add_(axis, idx, src)
def _segment_sum(src, seg, n):
    out = torch.zeros((n,) + src.shape[1:], dtype=src.dtype)
    return out.index_add_(0, seg, src)
def _pad(x, pw):
    flat = tuple(v for pair in reversed(pw) for v in pair)
    return torch.nn.functional.pad(x, flat)

kernel_name = 'standalone__mha_softmax__near_ridge'

def setup_inputs():

    _w = (lambda a: (lambda t: t.to(torch.bfloat16) if t.is_floating_point() else t)(torch.as_tensor(a)))
    B, H, Sq, Sk, D = 8, 16, 384, 2048, 256
    return {
        "q": _w((lambda *s: torch.randn(*s, dtype=torch.bfloat16) * 0.8)(B, H, Sq, D)),
        "k": _w((lambda *s: torch.randn(*s, dtype=torch.bfloat16) * 0.8)(B, H, Sk, D)),
        "v": _w((lambda *s: torch.randn(*s, dtype=torch.bfloat16) * 0.05)(B, H, Sk, D)),
    }

def reference(q, k, v):
    scale = q.shape[-1] ** -0.5
    scores = torch.einsum("bhqd,bhkd->bhqk", q, k) * scale
    p = _softmax(scores, axis=-1)
    return torch.einsum("bhqk,bhkd->bhqd", p, v)
```

```asm
; @launch grid=(256,1,1) block=(256,1,1) lds=133120
.amdgcn_target "amdgcn-amd-amdhsa--gfx950"
.text
.globl standalone__mha_softmax__near_ridge_kernel
.p2align 8
.type standalone__mha_softmax__near_ridge_kernel,@function
standalone__mha_softmax__near_ridge_kernel:
    s_cmp_ge_u32 s2, 256
    s_cbranch_scc1 L_end
    s_load_dwordx4 s[32:35], s[0:1], 0
    s_load_dwordx4 s[36:39], s[0:1], 16
    s_getpc_b64 s[46:47]
L_pc:
    s_bfe_u32 s40, s2, 0x30003
    s_lshl_b32 s40, s40, 12
    v_lshl_add_u32 v254, v0, 4, s40
    v_min_u32 v255, L_codeend - L_pc - 4, v254
    global_load_dword v253, v255, s[46:47]
    s_and_b32 s40, s2, 7
    s_lshr_b32 s41, s2, 4
    s_lshl_b32 s41, s41, 3
    s_or_b32 s40, s40, s41
    s_lshr_b32 s41, s2, 3
    s_and_b32 s41, s41, 1
    s_lshl_b32 s42, s40, 20
    s_lshl_b32 s43, s40, 1
    s_add_u32 s43, s43, s41
    s_mul_i32 s43, s43, 98304
    v_lshrrev_b32 v250, 6, v0
    v_and_b32 v251, 63, v0
    v_readfirstlane_b32 s20, v250
    v_lshlrev_b32 v222, 4, v251
    s_mov_b32 s6, 0x100000
    s_mov_b32 s7, 0x20000
    s_mov_b32 s14, 98304
    s_mov_b32 s15, 0x20000
    s_mul_i32 s21, s20, 8320
    s_lshl_b32 s23, s20, 13
    s_mul_i32 s50, s20, 24576
    s_lshr_b32 s44, s20, 1
    s_lshl_b32 s44, s44, 4
    s_and_b32 s45, s20, 1
    s_add_u32 s44, s44, s45
    s_mul_i32 s44, s44, 1040
    s_add_u32 s22, s44, 66560
    s_mov_b32 m0, s21
    s_waitcnt lgkmcnt(0)
    s_add_u32 s4, s34, s42
    s_addc_u32 s5, s35, 0
    s_add_u32 s12, s32, s43
    s_addc_u32 s13, s33, 0
    buffer_load_dwordx4 v222, s[4:7], s23 offen offset:0 nt lds
    s_add_u32 m0, m0, 16
    s_nop 0
    buffer_load_dwordx4 v222, s[4:7], s23 offen offset:1024 nt lds
    s_add_u32 m0, m0, 16
    s_nop 0
    buffer_load_dwordx4 v222, s[4:7], s23 offen offset:2048 nt lds
    s_add_u32 m0, m0, 16
    s_nop 0
    buffer_load_dwordx4 v222, s[4:7], s23 offen offset:3072 nt lds
    s_add_u32 m0, m0, 4112
    s_add_u32 s23, s23, 4096
    buffer_load_dwordx4 v222, s[4:7], s23 offen offset:0 nt lds
    s_add_u32 m0, m0, 16
    s_nop 0
    buffer_load_dwordx4 v222, s[4:7], s23 offen offset:1024 nt lds
    s_add_u32 m0, m0, 16
    s_nop 0
    buffer_load_dwordx4 v222, s[4:7], s23 offen offset:2048 nt lds
    s_add_u32 m0, m0, 16
    s_nop 0
    buffer_load_dwordx4 v222, s[4:7], s23 offen offset:3072 nt lds
    s_add_u32 m0, s22, 33280
    s_bitcmp1_b32 s2, 0
    s_cbranch_scc1 L_sg0
    s_waitcnt vmcnt(0)
L_sg0:
    s_barrier
    buffer_load_dwordx4 v222, s[12:15], s50 offen offset:0 nt lds
    s_add_u32 m0, m0, 1056
    s_nop 0
    buffer_load_dwordx4 v222, s[12:15], s50 offen offset:1024 nt lds
    s_add_u32 m0, m0, 1056
    s_nop 0
    buffer_load_dwordx4 v222, s[12:15], s50 offen offset:2048 nt lds
    s_add_u32 m0, m0, 1056
    s_nop 0
    buffer_load_dwordx4 v222, s[12:15], s50 offen offset:3072 nt lds
    s_add_u32 m0, m0, 5152
    s_add_u32 s50, s50, 4096
    buffer_load_dwordx4 v222, s[12:15], s50 offen offset:0 nt lds
    s_add_u32 m0, m0, 1056
    s_nop 0
    buffer_load_dwordx4 v222, s[12:15], s50 offen offset:1024 nt lds
    s_add_u32 m0, m0, 1056
    s_nop 0
    buffer_load_dwordx4 v222, s[12:15], s50 offen offset:2048 nt lds
    s_add_u32 m0, m0, 1056
    s_nop 0
    buffer_load_dwordx4 v222, s[12:15], s50 offen offset:3072 nt lds
    s_add_u32 s50, s50, 4096
    s_add_u32 s8, s36, s42
    s_addc_u32 s9, s37, 0
    s_mov_b32 s10, 0x100000
    s_mov_b32 s11, 0x20000
    s_add_u32 s16, s38, s43
    s_addc_u32 s17, s39, 0
    s_mov_b32 s18, 98304
    s_mov_b32 s19, 0x20000
    s_mov_b32 s48, 8192
    s_mov_b32 s49, 16384
    v_and_b32 v252, 15, v251
    v_lshrrev_b32 v241, 4, v251
    v_lshrrev_b32 v254, 5, v251
    v_and_b32 v255, 31, v251
    v_lshlrev_b32 v255, 4, v255
    v_lshl_add_u32 v223, v254, 10, v255
    s_lshl_b32 s24, s20, 13
    v_and_b32 v254, 3, v252
    v_lshrrev_b32 v255, 3, v252
    v_lshl_or_b32 v247, v255, 2, v254
    v_bfe_u32 v246, v252, 2, 1
    v_mul_u32_u24 v254, 2080, v247
    v_lshl_add_u32 v254, v246, 9, v254
    v_lshl_add_u32 v220, v241, 4, v254
    v_add_u32 v248, s22, v220
    v_add_u32 v248, 33280, v248
    v_and_b32 v246, 1, v241
    v_lshrrev_b32 v245, 2, v252
    v_lshrrev_b32 v244, 1, v241
    v_and_b32 v243, 3, v252
    v_lshl_add_u32 v254, v245, 1, v244
    v_lshl_add_u32 v254, v246, 3, v254
    v_mul_u32_u24 v254, 1040, v254
    v_lshl_add_u32 v254, v243, 3, v254
    v_add_u32 v221, 66560, v254
    v_mov_b32 v207, v254
    v_mul_u32_u24 v254, 4352, v250
    v_add_u32 v254, 33280, v254
    v_mul_u32_u24 v255, 1088, v241
    v_add_u32 v224, v254, v255
    v_lshl_add_u32 v224, v252, 2, v224
    v_lshrrev_b32 v255, 3, v251
    v_mul_u32_u24 v225, 272, v255
    v_add_u32 v225, v225, v254
    v_and_b32 v254, 7, v251
    v_lshl_add_u32 v225, v254, 5, v225
    v_and_b32 v247, 3, v255
    v_lshrrev_b32 v255, 2, v255
    v_lshl_add_u32 v255, v247, 1, v255
    v_mul_u32_u24 v226, 48, v250
    v_add_u32 v226, v226, v255
    v_lshlrev_b32 v226, 9, v226
    v_lshl_add_u32 v226, v254, 4, v226
    v_add_u32 v227, 4096, v226
    s_mov_b32 s26, 0x3db8aa3b
    s_mov_b32 s27, 0x49800000
    s_mov_b32 s29, s27
    s_mov_b32 s28, 14
    s_mov_b32 s52, 0xffff0000
    s_mov_b32 s55, 0
    s_mov_b32 s57, 1
    s_lshl_b32 s58, s41, 2
    s_add_u32 s58, s58, s20
    s_lshl_b32 s58, s58, 11
    s_add_u32 s59, s58, 163840
    s_add_u32 s51, s58, 180224
    s_add_u32 s44, s4, 983040
    s_addc_u32 s45, s5, 0
    s_mov_b32 s46, 65536
    s_mov_b32 s47, 0x20000
    s_add_u32 s53, s22, 33280
    s_mov_b32 m0, s22
    s_movk_i32 s54, 2080
    s_movk_i32 s56, 4160
    s_movk_i32 s62, 8320
    s_movk_i32 s63, 1024
    v_mov_b32 v240, v222
    v_mov_b32 v238, s26
    v_mov_b32 v239, s26
    s_bitcmp1_b32 s2, 0
    s_cbranch_scc1 L_sg1
    s_waitcnt vmcnt(0)
L_sg1:
    buffer_load_dwordx4 v222, s[12:15], s50 offen offset:0 nt lds
    s_add_u32 m0, m0, 1056
    s_nop 0
    buffer_load_dwordx4 v222, s[12:15], s50 offen offset:1024 nt lds
    s_add_u32 m0, m0, 1056
    s_nop 0
    buffer_load_dwordx4 v222, s[12:15], s50 offen offset:2048 nt lds
    s_add_u32 m0, m0, 1056
    s_nop 0
    buffer_load_dwordx4 v222, s[12:15], s50 offen offset:3072 nt lds
    s_add_u32 m0, m0, 5152
    s_add_u32 s50, s50, 4096
    buffer_load_dwordx4 v222, s[12:15], s50 offen offset:0 nt lds
    s_add_u32 m0, m0, 1056
    s_nop 0
    buffer_load_dwordx4 v222, s[12:15], s50 offen offset:1024 nt lds
    s_add_u32 m0, m0, 1056
    s_nop 0
    buffer_load_dwordx4 v222, s[12:15], s50 offen offset:2048 nt lds
    s_add_u32 m0, m0, 1056
    s_nop 0
    buffer_load_dwordx4 v222, s[12:15], s50 offen offset:3072 nt lds
    s_add_u32 s50, s50, 4096
    s_waitcnt vmcnt(16)
    s_barrier
    ds_read_b128 a[192:195], v220 offset:0
    ds_read_b128 a[196:199], v220 offset:64
    ds_read_b128 a[200:203], v220 offset:128
    ds_read_b128 a[204:207], v220 offset:192
    ds_read_b128 a[208:211], v220 offset:256
    ds_read_b128 a[212:215], v220 offset:320
    ds_read_b128 a[216:219], v220 offset:384
    ds_read_b128 a[220:223], v220 offset:448
    ds_read_b128 a[224:227], v220 offset:1040
    ds_read_b128 a[228:231], v220 offset:1104
    ds_read_b128 a[232:235], v220 offset:1168
    ds_read_b128 a[236:239], v220 offset:1232
    ds_read_b128 a[240:243], v220 offset:1296
    ds_read_b128 a[244:247], v220 offset:1360
    ds_read_b128 a[248:251], v220 offset:1424
    ds_read_b128 a[252:255], v220 offset:1488
    ds_read_b128 a[0:3], v220 offset:16640
    ds_read_b128 a[4:7], v220 offset:16704
    ds_read_b128 a[8:11], v220 offset:16768
    ds_read_b128 a[12:15], v220 offset:16832
    ds_read_b128 a[16:19], v220 offset:16896
    ds_read_b128 a[20:23], v220 offset:16960
    ds_read_b128 a[24:27], v220 offset:17024
    ds_read_b128 a[28:31], v220 offset:17088
    ds_read_b128 a[32:35], v220 offset:17680
    ds_read_b128 a[36:39], v220 offset:17744
    ds_read_b128 a[40:43], v220 offset:17808
    ds_read_b128 a[44:47], v220 offset:17872
    ds_read_b128 a[48:51], v220 offset:17936
    ds_read_b128 a[52:55], v220 offset:18000
    ds_read_b128 a[56:59], v220 offset:18064
    ds_read_b128 a[60:63], v220 offset:18128
    s_waitcnt vmcnt(8)
L_q:
    ds_read_b128 v[168:171], v248 offset:0
    ds_read_b128 v[172:175], v248 offset:64
    ds_read_b128 v[176:179], v248 offset:128
    ds_read_b128 v[180:183], v248 offset:192
    ds_read_b128 v[184:187], v248 offset:256
    ds_read_b128 v[188:191], v248 offset:320
    ds_read_b128 v[192:195], v248 offset:384
    ds_read_b128 v[196:199], v248 offset:448
    s_mov_b32 m0, s53
    s_waitcnt lgkmcnt(0)
    v_mfma_f32_16x16x32_bf16 v[104:107], a[192:195], v[168:171], 0
    v_lshlrev_b32 v0, 16, v168
    v_and_b32 v1, s52, v168
    v_mfma_f32_16x16x32_bf16 v[104:107], a[196:199], v[172:175], v[104:107]
    v_lshlrev_b32 v2, 16, v169
    v_and_b32 v3, s52, v169
    v_mfma_f32_16x16x32_bf16 v[104:107], a[200:203], v[176:179], v[104:107]
    v_lshlrev_b32 v4, 16, v170
    v_and_b32 v5, s52, v170
    v_mfma_f32_16x16x32_bf16 v[104:107], a[204:207], v[180:183], v[104:107]
    v_lshlrev_b32 v6, 16, v171
    v_and_b32 v7, s52, v171
    v_mfma_f32_16x16x32_bf16 v[104:107], a[208:211], v[184:187], v[104:107]
    v_lshlrev_b32 v8, 16, v172
    v_and_b32 v9, s52, v172
    v_mfma_f32_16x16x32_bf16 v[104:107], a[212:215], v[188:191], v[104:107]
    v_lshlrev_b32 v10, 16, v173
    v_and_b32 v11, s52, v173
    v_mfma_f32_16x16x32_bf16 v[104:107], a[216:219], v[192:195], v[104:107]
    v_lshlrev_b32 v12, 16, v174
    v_and_b32 v13, s52, v174
    v_mfma_f32_16x16x32_bf16 v[104:107], a[220:223], v[196:199], v[104:107]
    v_lshlrev_b32 v14, 16, v175
    v_and_b32 v15, s52, v175
    v_mfma_f32_16x16x32_bf16 v[116:119], a[224:227], v[168:171], 0
    v_lshlrev_b32 v16, 16, v176
    v_and_b32 v17, s52, v176
    v_mfma_f32_16x16x32_bf16 v[116:119], a[228:231], v[172:175], v[116:119]
    v_lshlrev_b32 v18, 16, v177
    v_and_b32 v19, s52, v177
    v_mfma_f32_16x16x32_bf16 v[116:119], a[232:235], v[176:179], v[116:119]
    v_lshlrev_b32 v20, 16, v178
    v_and_b32 v21, s52, v178
    v_mfma_f32_16x16x32_bf16 v[116:119], a[236:239], v[180:183], v[116:119]
    v_lshlrev_b32 v22, 16, v179
    v_and_b32 v23, s52, v179
    v_mfma_f32_16x16x32_bf16 v[116:119], a[240:243], v[184:187], v[116:119]
    v_lshlrev_b32 v24, 16, v180
    v_and_b32 v25, s52, v180
    v_mfma_f32_16x16x32_bf16 v[116:119], a[244:247], v[188:191], v[116:119]
    v_lshlrev_b32 v26, 16, v181
    v_and_b32 v27, s52, v181
    v_mfma_f32_16x16x32_bf16 v[116:119], a[248:251], v[192:195], v[116:119]
    s_barrier
    v_lshlrev_b32 v28, 16, v182
    v_and_b32 v29, s52, v182
    v_mfma_f32_16x16x32_bf16 v[116:119], a[252:255], v[196:199], v[116:119]
    buffer_load_dwordx4 v240, s[12:15], s50 offen nt lds
    s_add_u32 m0, m0, s54
    s_add_u32 s50, s50, s63
    v_lshlrev_b32 v30, 16, v183
    v_and_b32 v31, s52, v183
    v_mfma_f32_16x16x32_bf16 v[128:131], a[0:3], v[168:171], 0
    v_lshlrev_b32 v32, 16, v184
    v_and_b32 v33, s52, v184
    v_mfma_f32_16x16x32_bf16 v[128:131], a[4:7], v[172:175], v[128:131]
    v_lshlrev_b32 v34, 16, v185
    v_and_b32 v35, s52, v185
    v_mfma_f32_16x16x32_bf16 v[128:131], a[8:11], v[176:179], v[128:131]
    v_lshlrev_b32 v36, 16, v186
    v_and_b32 v37, s52, v186
    v_mfma_f32_16x16x32_bf16 v[128:131], a[12:15], v[180:183], v[128:131]
    buffer_load_dwordx4 v240, s[12:15], s50 offen nt lds
    s_add_u32 m0, m0, s56
    s_add_u32 s50, s50, 2048
    v_lshlrev_b32 v38, 16, v187
    v_and_b32 v39, s52, v187
    v_mfma_f32_16x16x32_bf16 v[128:131], a[16:19], v[184:187], v[128:131]
    v_lshlrev_b32 v40, 16, v188
    v_and_b32 v41, s52, v188
    v_mfma_f32_16x16x32_bf16 v[128:131], a[20:23], v[188:191], v[128:131]
    v_lshlrev_b32 v42, 16, v189
    v_and_b32 v43, s52, v189
    v_mfma_f32_16x16x32_bf16 v[128:131], a[24:27], v[192:195], v[128:131]
    v_lshlrev_b32 v44, 16, v190
    v_and_b32 v45, s52, v190
    v_mfma_f32_16x16x32_bf16 v[128:131], a[28:31], v[196:199], v[128:131]
    buffer_load_dwordx4 v240, s[12:15], s50 offen nt lds
    s_sub_u32 m0, m0, s54
    s_sub_u32 s50, s50, s63
    v_lshlrev_b32 v46, 16, v191
    v_and_b32 v47, s52, v191
    v_mfma_f32_16x16x32_bf16 v[140:143], a[32:35], v[168:171], 0
    v_lshlrev_b32 v48, 16, v192
    v_and_b32 v49, s52, v192
    v_mfma_f32_16x16x32_bf16 v[140:143], a[36:39], v[172:175], v[140:143]
    v_lshlrev_b32 v50, 16, v193
    v_and_b32 v51, s52, v193
    v_mfma_f32_16x16x32_bf16 v[140:143], a[40:43], v[176:179], v[140:143]
    v_lshlrev_b32 v52, 16, v194
    v_and_b32 v53, s52, v194
    v_mfma_f32_16x16x32_bf16 v[140:143], a[44:47], v[180:183], v[140:143]
    buffer_load_dwordx4 v240, s[12:15], s50 offen nt lds
    s_add_u32 m0, m0, s62
    s_add_u32 s50, s50, 4096
    v_lshlrev_b32 v54, 16, v195
    v_and_b32 v55, s52, v195
    v_mfma_f32_16x16x32_bf16 v[140:143], a[48:51], v[184:187], v[140:143]
    v_lshlrev_b32 v56, 16, v196
    v_and_b32 v57, s52, v196
    v_mfma_f32_16x16x32_bf16 v[140:143], a[52:55], v[188:191], v[140:143]
    v_lshlrev_b32 v58, 16, v197
    v_and_b32 v59, s52, v197
    v_mfma_f32_16x16x32_bf16 v[140:143], a[56:59], v[192:195], v[140:143]
    v_lshlrev_b32 v60, 16, v198
    v_and_b32 v61, s52, v198
    v_mfma_f32_16x16x32_bf16 v[140:143], a[60:63], v[196:199], v[140:143]
    buffer_load_dwordx4 v240, s[12:15], s50 offen nt lds
    s_add_u32 m0, m0, s54
    s_add_u32 s50, s50, s63
    v_lshlrev_b32 v62, 16, v199
    v_and_b32 v63, s52, v199
    v_max3_f32 v236, v104, v105, v106
    v_max3_f32 v236, v236, v107, v116
    v_max3_f32 v236, v236, v117, v118
    v_max3_f32 v236, v236, v119, v128
    v_max3_f32 v236, v236, v129, v130
    v_pk_mul_f32 v[0:1], v[0:1], v[238:239]
    v_pk_mul_f32 v[2:3], v[2:3], v[238:239]
    v_pk_mul_f32 v[4:5], v[4:5], v[238:239]
    v_pk_mul_f32 v[6:7], v[6:7], v[238:239]
    v_max3_f32 v236, v236, v131, v140
    v_max3_f32 v236, v236, v141, v142
    v_max_f32 v236, v236, v143
    v_mov_b32 v237, v236
    v_pk_mul_f32 v[8:9], v[8:9], v[238:239]
    v_pk_mul_f32 v[10:11], v[10:11], v[238:239]
    v_permlane32_swap_b32 v236, v237
    v_pk_mul_f32 v[12:13], v[12:13], v[238:239]
    v_pk_mul_f32 v[14:15], v[14:15], v[238:239]
    v_max_f32 v236, v236, v237
    v_mov_b32 v237, v236
    v_pk_mul_f32 v[16:17], v[16:17], v[238:239]
    v_pk_mul_f32 v[18:19], v[18:19], v[238:239]
    v_permlane16_swap_b32 v236, v237
    v_pk_mul_f32 v[20:21], v[20:21], v[238:239]
    v_pk_mul_f32 v[22:23], v[22:23], v[238:239]
    v_max_f32 v236, v236, v237
    v_mul_f32 v236, s26, v236
    v_sub_f32 v216, 0xc2080000, v236
    v_sub_f32 v217, 0xc2080000, v236
    v_sub_f32 v218, 0xc2080000, v236
    v_sub_f32 v219, 0xc2080000, v236
    v_pk_fma_f32 v[104:105], v[104:105], v[238:239], v[216:217]
    v_pk_fma_f32 v[106:107], v[106:107], v[238:239], v[216:217]
    v_pk_fma_f32 v[116:117], v[116:117], v[238:239], v[216:217]
    v_pk_fma_f32 v[118:119], v[118:119], v[238:239], v[216:217]
    v_pk_fma_f32 v[128:129], v[128:129], v[238:239], v[216:217]
    v_pk_fma_f32 v[130:131], v[130:131], v[238:239], v[216:217]
    v_pk_fma_f32 v[140:141], v[140:141], v[238:239], v[216:217]
    v_pk_fma_f32 v[142:143], v[142:143], v[238:239], v[216:217]
    v_exp_f32 v104, v104
    buffer_load_dwordx4 v240, s[12:15], s50 offen nt lds
    s_sub_u32 m0, m0, s56
    s_sub_u32 s50, s50, 2048
    v_exp_f32 v105, v105
    v_exp_f32 v106, v106
    v_exp_f32 v107, v107
    v_exp_f32 v116, v116
    buffer_load_dwordx4 v240, s[12:15], s50 offen nt lds
    s_sub_u32 m0, m0, s54
    s_sub_u32 s50, s50, s63
    v_exp_f32 v117, v117
    v_exp_f32 v118, v118
    v_exp_f32 v119, v119
    v_exp_f32 v128, v128
    buffer_load_dwordx4 v240, s[12:15], s50 offen nt lds
    v_exp_f32 v129, v129
    v_exp_f32 v130, v130
    v_exp_f32 v131, v131
    v_exp_f32 v140, v140
    v_exp_f32 v141, v141
    v_exp_f32 v142, v142
    v_exp_f32 v143, v143
    v_pk_mul_f32 v[24:25], v[24:25], v[238:239]
    v_pk_mul_f32 v[26:27], v[26:27], v[238:239]
    v_pk_mul_f32 v[28:29], v[28:29], v[238:239]
    v_pk_mul_f32 v[30:31], v[30:31], v[238:239]
    v_pk_mul_f32 v[32:33], v[32:33], v[238:239]
    v_pk_mul_f32 v[34:35], v[34:35], v[238:239]
    v_pk_mul_f32 v[36:37], v[36:37], v[238:239]
    v_pk_mul_f32 v[38:39], v[38:39], v[238:239]
    v_pk_mul_f32 v[40:41], v[40:41], v[238:239]
    v_pk_mul_f32 v[42:43], v[42:43], v[238:239]
    v_pk_mul_f32 v[44:45], v[44:45], v[238:239]
    v_pk_mul_f32 v[46:47], v[46:47], v[238:239]
    v_pk_mul_f32 v[48:49], v[48:49], v[238:239]
    v_pk_mul_f32 v[50:51], v[50:51], v[238:239]
    v_pk_mul_f32 v[52:53], v[52:53], v[238:239]
    v_pk_mul_f32 v[54:55], v[54:55], v[238:239]
    v_pk_mul_f32 v[56:57], v[56:57], v[238:239]
    v_pk_mul_f32 v[58:59], v[58:59], v[238:239]
    v_pk_mul_f32 v[60:61], v[60:61], v[238:239]
    v_pk_mul_f32 v[62:63], v[62:63], v[238:239]
    v_cvt_pk_bf16_f32 v64, v0, v1
    v_cvt_pk_bf16_f32 v65, v2, v3
    v_cvt_pk_bf16_f32 v66, v4, v5
    v_cvt_pk_bf16_f32 v67, v6, v7
    v_cvt_pk_bf16_f32 v68, v8, v9
    v_cvt_pk_bf16_f32 v69, v10, v11
    v_cvt_pk_bf16_f32 v70, v12, v13
    v_cvt_pk_bf16_f32 v71, v14, v15
    v_cvt_pk_bf16_f32 v72, v16, v17
    v_cvt_pk_bf16_f32 v73, v18, v19
    v_cvt_pk_bf16_f32 v74, v20, v21
    v_cvt_pk_bf16_f32 v75, v22, v23
    v_cvt_pk_bf16_f32 v76, v24, v25
    v_cvt_pk_bf16_f32 v77, v26, v27
    v_cvt_pk_bf16_f32 v78, v28, v29
    v_cvt_pk_bf16_f32 v79, v30, v31
    v_cvt_pk_bf16_f32 v80, v32, v33
    v_cvt_pk_bf16_f32 v81, v34, v35
    v_cvt_pk_bf16_f32 v82, v36, v37
    v_cvt_pk_bf16_f32 v83, v38, v39
    v_cvt_pk_bf16_f32 v84, v40, v41
    v_cvt_pk_bf16_f32 v85, v42, v43
    v_cvt_pk_bf16_f32 v86, v44, v45
    v_cvt_pk_bf16_f32 v87, v46, v47
    v_cvt_pk_bf16_f32 v88, v48, v49
    v_cvt_pk_bf16_f32 v89, v50, v51
    v_cvt_pk_bf16_f32 v90, v52, v53
    v_cvt_pk_bf16_f32 v91, v54, v55
    v_cvt_pk_bf16_f32 v92, v56, v57
    v_cvt_pk_bf16_f32 v93, v58, v59
    v_cvt_pk_bf16_f32 v94, v60, v61
    v_cvt_pk_bf16_f32 v95, v62, v63
    v_pk_add_f32 v[236:237], v[104:105], v[106:107]
    v_cvt_pk_bf16_f32 v152, v104, v105
    v_pk_add_f32 v[236:237], v[236:237], v[116:117]
    v_cvt_pk_bf16_f32 v153, v106, v107
    v_pk_add_f32 v[236:237], v[236:237], v[118:119]
    v_cvt_pk_bf16_f32 v154, v116, v117
    v_pk_add_f32 v[236:237], v[236:237], v[128:129]
    v_cvt_pk_bf16_f32 v155, v118, v119
    v_pk_add_f32 v[236:237], v[236:237], v[130:131]
    v_cvt_pk_bf16_f32 v164, v128, v129
    v_pk_add_f32 v[236:237], v[236:237], v[140:141]
    v_cvt_pk_bf16_f32 v165, v130, v131
    v_pk_add_f32 v[236:237], v[236:237], v[142:143]
    v_cvt_pk_bf16_f32 v166, v140, v141
    v_cvt_pk_bf16_f32 v167, v142, v143
    v_add_f32 v205, v236, v237
    s_cmp_eq_u32 s55, 2
    s_cbranch_scc1 L_qdone
    s_cmp_eq_u32 s55, 1
    s_cbranch_scc1 L_q1
    v_accvgpr_write_b32 a128, v64
    v_accvgpr_write_b32 a129, v65
    v_accvgpr_write_b32 a130, v66
    v_accvgpr_write_b32 a131, v67
    v_accvgpr_write_b32 a132, v68
    v_accvgpr_write_b32 a133, v69
    v_accvgpr_write_b32 a134, v70
    v_accvgpr_write_b32 a135, v71
    v_accvgpr_write_b32 a136, v72
    v_accvgpr_write_b32 a137, v73
    v_accvgpr_write_b32 a138, v74
    v_accvgpr_write_b32 a139, v75
    v_accvgpr_write_b32 a140, v76
    v_accvgpr_write_b32 a141, v77
    v_accvgpr_write_b32 a142, v78
    v_accvgpr_write_b32 a143, v79
    v_accvgpr_write_b32 a144, v80
    v_accvgpr_write_b32 a145, v81
    v_accvgpr_write_b32 a146, v82
    v_accvgpr_write_b32 a147, v83
    v_accvgpr_write_b32 a148, v84
    v_accvgpr_write_b32 a149, v85
    v_accvgpr_write_b32 a150, v86
    v_accvgpr_write_b32 a151, v87
    v_accvgpr_write_b32 a152, v88
    v_accvgpr_write_b32 a153, v89
    v_accvgpr_write_b32 a154, v90
    v_accvgpr_write_b32 a155, v91
    v_accvgpr_write_b32 a156, v92
    v_accvgpr_write_b32 a157, v93
    v_accvgpr_write_b32 a158, v94
    v_accvgpr_write_b32 a159, v95
    v_mov_b32 v144, v152
    v_mov_b32 v145, v153
    v_mov_b32 v146, v154
    v_mov_b32 v147, v155
    v_mov_b32 v156, v164
    v_mov_b32 v157, v165
    v_mov_b32 v158, v166
    v_mov_b32 v159, v167
    v_mov_b32 v208, v216
    v_mov_b32 v209, v216
    v_mov_b32 v210, v216
    v_mov_b32 v211, v216
    v_mov_b32 v203, v205
    s_mov_b32 s12, s4
    s_mov_b32 s13, s5
    s_mov_b32 s14, s6
    s_add_u32 s50, s23, 28672
    s_add_u32 s53, s21, 33280
    s_movk_i32 s54, 1040
    s_movk_i32 s56, 2080
    s_movk_i32 s62, 4160
    s_movk_i32 s63, 1024
    v_subrev_u32 v248, 33280, v248
    s_mov_b32 s55, 1
    s_waitcnt vmcnt(8)
    s_branch L_q
L_q1:
    v_accvgpr_write_b32 a160, v64
    v_accvgpr_write_b32 a161, v65
    v_accvgpr_write_b32 a162, v66
    v_accvgpr_write_b32 a163, v67
    v_accvgpr_write_b32 a164, v68
    v_accvgpr_write_b32 a165, v69
    v_accvgpr_write_b32 a166, v70
    v_accvgpr_write_b32 a167, v71
    v_accvgpr_write_b32 a168, v72
    v_accvgpr_write_b32 a169, v73
    v_accvgpr_write_b32 a170, v74
    v_accvgpr_write_b32 a171, v75
    v_accvgpr_write_b32 a172, v76
    v_accvgpr_write_b32 a173, v77
    v_accvgpr_write_b32 a174, v78
    v_accvgpr_write_b32 a175, v79
    v_accvgpr_write_b32 a176, v80
    v_accvgpr_write_b32 a177, v81
    v_accvgpr_write_b32 a178, v82
    v_accvgpr_write_b32 a179, v83
    v_accvgpr_write_b32 a180, v84
    v_accvgpr_write_b32 a181, v85
    v_accvgpr_write_b32 a182, v86
    v_accvgpr_write_b32 a183, v87
    v_accvgpr_write_b32 a184, v88
    v_accvgpr_write_b32 a185, v89
    v_accvgpr_write_b32 a186, v90
    v_accvgpr_write_b32 a187, v91
    v_accvgpr_write_b32 a188, v92
    v_accvgpr_write_b32 a189, v93
    v_accvgpr_write_b32 a190, v94
    v_accvgpr_write_b32 a191, v95
    v_mov_b32 v148, v152
    v_mov_b32 v149, v153
    v_mov_b32 v150, v154
    v_mov_b32 v151, v155
    v_mov_b32 v160, v164
    v_mov_b32 v161, v165
    v_mov_b32 v162, v166
    v_mov_b32 v163, v167
    v_mov_b32 v212, v216
    v_mov_b32 v213, v216
    v_mov_b32 v214, v216
    v_mov_b32 v215, v216
    v_mov_b32 v204, v205
    s_mov_b32 s12, s8
    s_mov_b32 s13, s9
    s_mov_b32 s50, s24
    s_mov_b32 s53, s22
    s_movk_i32 s54, 8320
    s_movk_i32 s56, 2080
    s_movk_i32 s62, 4160
    s_movk_i32 s63, 512
    v_mov_b32 v240, v223
    s_add_u32 s24, s24, 32768
    s_add_u32 s23, s23, 61440
    v_add_u32 v248, 33280, v248
    s_mov_b32 s55, 2
    s_waitcnt vmcnt(8)
    s_branch L_q
L_qdone:
    s_waitcnt vmcnt(8)
    s_barrier
    ds_read_b128 a[192:195], v220 offset:33280
    ds_read_b128 a[196:199], v220 offset:33344
    ds_read_b128 a[200:203], v220 offset:33408
    ds_read_b128 a[204:207], v220 offset:33472
    ds_read_b128 a[208:211], v220 offset:33536
    ds_read_b128 a[212:215], v220 offset:33600
    ds_read_b128 a[216:219], v220 offset:33664
    ds_read_b128 a[220:223], v220 offset:33728
    v_lshlrev_b32 v254, 1, v222
    s_add_u32 s12, s8, 950272
    s_addc_u32 s13, s9, 0
    s_mov_b32 s14, 98304
    s_waitcnt lgkmcnt(3)
    v_mfma_f32_16x16x32_bf16 v[96:99], a[192:195], a[128:131], v[208:211]
    s_add_u32 m0, s21, 0
    v_mfma_f32_16x16x32_bf16 v[96:99], a[196:199], a[132:135], v[96:99]
    buffer_load_dwordx4 v222, s[4:7], s23 offen offset:0 nt lds
    v_mfma_f32_16x16x32_bf16 v[96:99], a[200:203], a[136:139], v[96:99]
    ds_read_b128 a[224:227], v220 offset:34768
    v_mfma_f32_16x16x32_bf16 v[96:99], a[204:207], a[140:143], v[96:99]
    v_mfma_f32_16x16x32_bf16 v[96:99], a[208:211], a[144:147], v[96:99]
    s_waitcnt lgkmcnt(1)
    s_add_u32 m0, s21, 16
    ds_read_b128 a[228:231], v220 offset:34704
    v_mfma_f32_16x16x32_bf16 v[96:99], a[212:215], a[148:151], v[96:99]
    buffer_load_dwordx4 v222, s[4:7], s23 offen offset:1024 nt lds
    v_mfma_f32_16x16x32_bf16 v[96:99], a[216:219], a[152:155], v[96:99]
    ds_read_b128 a[232:235], v220 offset:34640
    v_mfma_f32_16x16x32_bf16 v[96:99], a[220:223], a[156:159], v[96:99]
    v_mfma_f32_16x16x32_bf16 v[100:103], a[220:223], a[188:191], v[212:215]
    s_add_u32 m0, s21, 32
    ds_read_b128 a[236:239], v220 offset:34576
    v_mfma_f32_16x16x32_bf16 v[100:103], a[216:219], a[184:187], v[100:103]
    buffer_load_dwordx4 v222, s[4:7], s23 offen offset:2048 nt lds
    v_mfma_f32_16x16x32_bf16 v[100:103], a[212:215], a[180:183], v[100:103]
    ds_read_b128 a[240:243], v220 offset:34512
    v_mfma_f32_16x16x32_bf16 v[100:103], a[208:211], a[176:179], v[100:103]
    v_mfma_f32_16x16x32_bf16 v[100:103], a[204:207], a[172:175], v[100:103]
    s_add_u32 m0, s21, 48
    ds_read_b128 a[244:247], v220 offset:34448
    v_mfma_f32_16x16x32_bf16 v[100:103], a[200:203], a[168:171], v[100:103]
    buffer_load_dwordx4 v222, s[4:7], s23 offen offset:3072 nt lds
    v_mfma_f32_16x16x32_bf16 v[100:103], a[196:199], a[164:167], v[100:103]
    s_add_u32 s23, s23, 4096
    ds_read_b128 a[248:251], v220 offset:34384
    v_mfma_f32_16x16x32_bf16 v[100:103], a[192:195], a[160:163], v[100:103]
    v_exp_f32 v192, v96
    v_mfma_f32_16x16x32_bf16 v[104:107], a[192:195], v[64:67], v[216:219]
    ds_read_b128 a[252:255], v220 offset:34320
    v_add_f32 v200, v203, v192
    v_mfma_f32_16x16x32_bf16 v[104:107], a[196:199], v[68:71], v[104:107]
    s_add_u32 m0, s21, 4160
    v_mfma_f32_16x16x32_bf16 v[104:107], a[200:203], v[72:75], v[104:107]
    buffer_load_dwordx4 v222, s[4:7], s23 offen offset:0 nt lds
    v_mfma_f32_16x16x32_bf16 v[104:107], a[204:207], v[76:79], v[104:107]
    v_exp_f32 v193, v97
    v_mfma_f32_16x16x32_bf16 v[104:107], a[208:211], v[80:83], v[104:107]
    v_exp_f32 v194, v98
    v_mfma_f32_16x16x32_bf16 v[104:107], a[212:215], v[84:87], v[104:107]
    v_exp_f32 v195, v99
    v_mfma_f32_16x16x32_bf16 v[104:107], a[216:219], v[88:91], v[104:107]
    s_add_u32 m0, s21, 4176
    v_cvt_pk_bf16_f32 v168, v192, v193
    v_mfma_f32_16x16x32_bf16 v[104:107], a[220:223], v[92:95], v[104:107]
    s_waitcnt lgkmcnt(0)
    buffer_load_dwordx4 v222, s[4:7], s23 offen offset:1024 nt lds
    v_mfma_f32_16x16x32_bf16 v[116:119], a[224:227], v[92:95], v[216:219]
    v_exp_f32 v196, v100
    v_mfma_f32_16x16x32_bf16 v[116:119], a[228:231], v[88:91], v[116:119]
    v_exp_f32 v197, v101
    v_mfma_f32_16x16x32_bf16 v[116:119], a[232:235], v[84:87], v[116:119]
    ds_read_b128 a[192:195], v220 offset:49920
    v_add_f32 v200, v200, v193
    v_mfma_f32_16x16x32_bf16 v[116:119], a[236:239], v[80:83], v[116:119]
    v_exp_f32 v198, v102
    v_mfma_f32_16x16x32_bf16 v[116:119], a[240:243], v[76:79], v[116:119]
    s_add_u32 m0, s21, 4192
    ds_read_b128 a[196:199], v220 offset:49984
    v_mfma_f32_16x16x32_bf16 v[116:119], a[244:247], v[72:75], v[116:119]
    buffer_load_dwordx4 v222, s[4:7], s23 offen offset:2048 nt lds
    v_mfma_f32_16x16x32_bf16 v[116:119], a[248:251], v[68:71], v[116:119]
    ds_read_b128 a[200:203], v220 offset:50048
    v_add_f32 v200, v200, v194
    v_mfma_f32_16x16x32_bf16 v[116:119], a[252:255], v[64:67], v[116:119]
    v_exp_f32 v199, v103
    v_mfma_f32_16x16x32_bf16 v[112:115], a[252:255], a[160:163], v[212:215]
    ds_read_b128 a[204:207], v220 offset:50112
    v_cvt_pk_bf16_f32 v169, v194, v195
    v_mfma_f32_16x16x32_bf16 v[112:115], a[248:251], a[164:167], v[112:115]
    v_exp_f32 v192, v104
    v_mfma_f32_16x16x32_bf16 v[112:115], a[244:247], a[168:171], v[112:115]
    s_add_u32 m0, s21, 4208
    ds_read_b128 a[208:211], v220 offset:50176
    v_mfma_f32_16x16x32_bf16 v[112:115], a[240:243], a[172:175], v[112:115]
    buffer_load_dwordx4 v222, s[4:7], s23 offen offset:3072 nt lds
    v_mfma_f32_16x16x32_bf16 v[112:115], a[236:239], a[176:179], v[112:115]
    s_add_u32 s23, s23, 28672
    ds_read_b128 a[212:215], v220 offset:50240
    v_add_f32 v200, v200, v195
    v_mfma_f32_16x16x32_bf16 v[112:115], a[232:235], a[180:183], v[112:115]
    v_exp_f32 v193, v105
    v_mfma_f32_16x16x32_bf16 v[112:115], a[228:231], a[184:187], v[112:115]
    ds_read_b128 a[216:219], v220 offset:50304
    v_add_f32 v201, v204, v196
    v_mfma_f32_16x16x32_bf16 v[112:115], a[224:227], a[188:191], v[112:115]
    v_exp_f32 v194, v106
    v_mfma_f32_16x16x32_bf16 v[108:111], a[224:227], a[156:159], v[208:211]
    ds_read_b128 a[220:223], v220 offset:50368
    v_cvt_pk_bf16_f32 v172, v196, v197
    v_mfma_f32_16x16x32_bf16 v[108:111], a[228:231], a[152:155], v[108:111]
    v_exp_f32 v195, v107
    v_mfma_f32_16x16x32_bf16 v[108:111], a[232:235], a[148:151], v[108:111]
    s_add_u32 m0, s22, 33280
    v_add_f32 v201, v201, v197
    v_mfma_f32_16x16x32_bf16 v[108:111], a[236:239], a[144:147], v[108:111]
    buffer_load_dwordx4 v223, s[8:11], s24 offen offset:0 nt lds
    v_mfma_f32_16x16x32_bf16 v[108:111], a[240:243], a[140:143], v[108:111]
    v_exp_f32 v196, v116
    v_mfma_f32_16x16x32_bf16 v[108:111], a[244:247], a[136:139], v[108:111]
    v_exp_f32 v197, v117
    v_mfma_f32_16x16x32_bf16 v[108:111], a[248:251], a[132:135], v[108:111]
    ds_read_b128 a[224:227], v220 offset:51408
    v_add_f32 v201, v201, v198
    v_mfma_f32_16x16x32_bf16 v[108:111], a[252:255], a[128:131], v[108:111]
    s_waitcnt lgkmcnt(1)
    v_cvt_pk_bf16_f32 v173, v198, v199
    v_add_f32 v201, v201, v199
    v_mfma_f32_16x16x32_bf16 v[120:123], a[192:195], a[128:131], v[208:211]
    ds_read_b128 a[228:231], v220 offset:51344
    v_add_f32 v202, v205, v192
    v_mfma_f32_16x16x32_bf16 v[120:123], a[196:199], a[132:135], v[120:123]
    v_exp_f32 v198, v118
    v_mfma_f32_16x16x32_bf16 v[120:123], a[200:203], a[136:139], v[120:123]
    ds_read_b128 a[232:235], v220 offset:51280
    v_cvt_pk_bf16_f32 v176, v192, v193
    v_mfma_f32_16x16x32_bf16 v[120:123], a[204:207], a[140:143], v[120:123]
    v_exp_f32 v199, v119
    v_mfma_f32_16x16x32_bf16 v[120:123], a[208:211], a[144:147], v[120:123]
    s_add_u32 m0, s22, 41088
    ds_read_b128 a[236:239], v220 offset:51216
    v_mfma_f32_16x16x32_bf16 v[120:123], a[212:215], a[148:151], v[120:123]
    buffer_load_dwordx4 v223, s[8:11], s24 offen offset:512 nt lds
    v_mfma_f32_16x16x32_bf16 v[120:123], a[216:219], a[152:155], v[120:123]
    ds_read_b128 a[240:243], v220 offset:51152
    v_add_f32 v202, v202, v193
    v_mfma_f32_16x16x32_bf16 v[120:123], a[220:223], a[156:159], v[120:123]
    v_exp_f32 v192, v112
    v_mfma_f32_16x16x32_bf16 v[124:127], a[220:223], a[188:191], v[212:215]
    ds_read_b128 a[244:247], v220 offset:51088
    v_add_f32 v202, v202, v194
    v_mfma_f32_16x16x32_bf16 v[124:127], a[216:219], a[184:187], v[124:127]
    v_exp_f32 v193, v113
    v_mfma_f32_16x16x32_bf16 v[124:127], a[212:215], a[180:183], v[124:127]
    ds_read_b128 a[248:251], v220 offset:51024
    v_cvt_pk_bf16_f32 v177, v194, v195
    v_mfma_f32_16x16x32_bf16 v[124:127], a[208:211], a[176:179], v[124:127]
    v_exp_f32 v194, v114
    v_mfma_f32_16x16x32_bf16 v[124:127], a[204:207], a[172:175], v[124:127]
    ds_read_b128 a[252:255], v220 offset:50960
    v_add_f32 v202, v202, v195
    v_mfma_f32_16x16x32_bf16 v[124:127], a[200:203], a[168:171], v[124:127]
    v_exp_f32 v195, v115
    v_mfma_f32_16x16x32_bf16 v[124:127], a[196:199], a[164:167], v[124:127]
    s_add_u32 m0, s22, 33312
    v_add_f32 v202, v202, v196
    v_mfma_f32_16x16x32_bf16 v[124:127], a[192:195], a[160:163], v[124:127]
    buffer_load_dwordx4 v223, s[8:11], s24 offen offset:2048 nt lds
    v_mfma_f32_16x16x32_bf16 v[128:131], a[192:195], v[64:67], v[216:219]
    v_cvt_pk_bf16_f32 v178, v196, v197
    v_add_f32 v202, v202, v197
    v_mfma_f32_16x16x32_bf16 v[128:131], a[196:199], v[68:71], v[128:131]
    v_exp_f32 v196, v108
    v_mfma_f32_16x16x32_bf16 v[128:131], a[200:203], v[72:75], v[128:131]
    v_exp_f32 v197, v109
    v_mfma_f32_16x16x32_bf16 v[128:131], a[204:207], v[76:79], v[128:131]
    s_waitcnt vmcnt(11) lgkmcnt(0)
    v_mfma_f32_16x16x32_bf16 v[128:131], a[208:211], v[80:83], v[128:131]
    s_barrier
    v_mfma_f32_16x16x32_bf16 v[128:131], a[212:215], v[84:87], v[128:131]
    v_add_f32 v202, v202, v198
    v_cvt_pk_bf16_f32 v179, v198, v199
    v_mfma_f32_16x16x32_bf16 v[128:131], a[216:219], v[88:91], v[128:131]
    v_exp_f32 v198, v110
    v_mfma_f32_16x16x32_bf16 v[128:131], a[220:223], v[92:95], v[128:131]
    v_add_f32 v202, v202, v199
    v_add_f32 v201, v201, v192
    v_mfma_f32_16x16x32_bf16 v[140:143], a[224:227], v[92:95], v[216:219]
    ds_read_b64_tr_b16 a[192:193], v221 offset:0
    v_cvt_pk_bf16_f32 v174, v192, v193
    v_mfma_f32_16x16x32_bf16 v[140:143], a[228:231], v[88:91], v[140:143]
    s_add_u32 m0, s22, 41120
    ds_read_b64_tr_b16 a[194:195], v221 offset:512
    v_mfma_f32_16x16x32_bf16 v[140:143], a[232:235], v[84:87], v[140:143]
    buffer_load_dwordx4 v223, s[8:11], s24 offen offset:2560 nt lds
    v_mfma_f32_16x16x32_bf16 v[140:143], a[236:239], v[80:83], v[140:143]
    s_add_u32 s24, s24, 4096
    ds_read_b64_tr_b16 a[196:197], v221 offset:16640
    v_add_f32 v201, v201, v193
    v_mfma_f32_16x16x32_bf16 v[140:143], a[240:243], v[76:79], v[140:143]
    ds_read_b64_tr_b16 a[198:199], v221 offset:17152
    v_add_f32 v201, v201, v194
    v_mfma_f32_16x16x32_bf16 v[140:143], a[244:247], v[72:75], v[140:143]
    v_exp_f32 v199, v111
    v_mfma_f32_16x16x32_bf16 v[140:143], a[248:251], v[68:71], v[140:143]
    ds_read_b64_tr_b16 a[200:201], v221 offset:16672
    v_cvt_pk_bf16_f32 v175, v194, v195
    v_mfma_f32_16x16x32_bf16 v[140:143], a[252:255], v[64:67], v[140:143]
    s_add_u32 m0, s22, 37440
    ds_read_b64_tr_b16 a[202:203], v221 offset:17184
    v_mfma_f32_16x16x32_bf16 v[136:139], a[252:255], a[160:163], v[212:215]
    buffer_load_dwordx4 v223, s[8:11], s24 offen offset:0 nt lds
    v_mfma_f32_16x16x32_bf16 v[136:139], a[248:251], a[164:167], v[136:139]
    ds_read_b64_tr_b16 a[204:205], v221 offset:32
    v_add_f32 v201, v201, v195
    v_mfma_f32_16x16x32_bf16 v[136:139], a[244:247], a[168:171], v[136:139]
    ds_read_b64_tr_b16 a[206:207], v221 offset:544
    v_add_f32 v200, v200, v196
    v_mfma_f32_16x16x32_bf16 v[136:139], a[240:243], a[172:175], v[136:139]
    v_exp_f32 v192, v120
    v_mfma_f32_16x16x32_bf16 v[136:139], a[236:239], a[176:179], v[136:139]
    ds_read_b64_tr_b16 a[208:209], v221 offset:64
    v_cvt_pk_bf16_f32 v170, v196, v197
    v_mfma_f32_16x16x32_bf16 v[136:139], a[232:235], a[180:183], v[136:139]
    s_add_u32 m0, s22, 45248
    ds_read_b64_tr_b16 a[210:211], v221 offset:576
    v_mfma_f32_16x16x32_bf16 v[136:139], a[228:231], a[184:187], v[136:139]
    buffer_load_dwordx4 v223, s[8:11], s24 offen offset:512 nt lds
    v_mfma_f32_16x16x32_bf16 v[136:139], a[224:227], a[188:191], v[136:139]
    ds_read_b64_tr_b16 a[212:213], v221 offset:16704
    v_add_f32 v200, v200, v197
    v_mfma_f32_16x16x32_bf16 v[132:135], a[224:227], a[156:159], v[208:211]
    ds_read_b64_tr_b16 a[214:215], v221 offset:17216
    v_add_f32 v200, v200, v198
    v_mfma_f32_16x16x32_bf16 v[132:135], a[228:231], a[152:155], v[132:135]
    v_exp_f32 v193, v121
    v_mfma_f32_16x16x32_bf16 v[132:135], a[232:235], a[148:151], v[132:135]
    ds_read_b64_tr_b16 a[216:217], v221 offset:16736
    v_cvt_pk_bf16_f32 v171, v198, v199
    v_mfma_f32_16x16x32_bf16 v[132:135], a[236:239], a[144:147], v[132:135]
    s_add_u32 m0, s22, 37472
    ds_read_b64_tr_b16 a[218:219], v221 offset:17248
    v_mfma_f32_16x16x32_bf16 v[132:135], a[240:243], a[140:143], v[132:135]
    buffer_load_dwordx4 v223, s[8:11], s24 offen offset:2048 nt lds
    v_mfma_f32_16x16x32_bf16 v[132:135], a[244:247], a[136:139], v[132:135]
    ds_read_b64_tr_b16 a[220:221], v221 offset:96
    v_add_f32 v200, v200, v199
    v_mfma_f32_16x16x32_bf16 v[132:135], a[248:251], a[132:135], v[132:135]
    ds_read_b64_tr_b16 a[222:223], v221 offset:608
    v_add_f32 v200, v200, v192
    v_mfma_f32_16x16x32_bf16 v[132:135], a[252:255], a[128:131], v[132:135]
    s_waitcnt lgkmcnt(4)
    v_exp_f32 v194, v122
    v_mfma_f32_16x16x32_bf16 v[0:3], v[144:147], a[192:195], 0
    ds_read_b64_tr_b16 a[224:225], v221 offset:128
    v_cvt_pk_bf16_f32 v180, v192, v193
    v_mfma_f32_16x16x32_bf16 v[0:3], v[156:159], a[196:199], v[0:3]
    s_add_u32 m0, s22, 45280
    ds_read_b64_tr_b16 a[226:227], v221 offset:640
    v_mfma_f32_16x16x32_bf16 v[4:7], v[160:163], a[196:199], 0
    buffer_load_dwordx4 v223, s[8:11], s24 offen offset:2560 nt lds
    v_mfma_f32_16x16x32_bf16 v[4:7], v[148:151], a[192:195], v[4:7]
    s_add_u32 s24, s24, 28672
    ds_read_b64_tr_b16 a[228:229], v221 offset:16768
    v_add_f32 v200, v200, v193
    v_mfma_f32_16x16x32_bf16 v[8:11], v[152:155], a[192:195], 0
    ds_read_b64_tr_b16 a[230:231], v221 offset:17280
    v_add_f32 v200, v200, v194
    v_mfma_f32_16x16x32_bf16 v[8:11], v[164:167], a[196:199], v[8:11]
    v_exp_f32 v195, v123
    v_mfma_f32_16x16x32_bf16 v[20:23], v[164:167], a[200:203], 0
    ds_read_b64_tr_b16 a[232:233], v221 offset:16800
    v_cvt_pk_bf16_f32 v181, v194, v195
    v_mfma_f32_16x16x32_bf16 v[20:23], v[152:155], a[204:207], v[20:23]
    ds_read_b64_tr_b16 a[234:235], v221 offset:17312
    v_add_f32 v200, v200, v195
    v_mfma_f32_16x16x32_bf16 v[16:19], v[148:151], a[204:207], 0
    v_exp_f32 v196, v124
    v_mfma_f32_16x16x32_bf16 v[16:19], v[160:163], a[200:203], v[16:19]
    ds_read_b64_tr_b16 a[236:237], v221 offset:160
    v_add_f32 v201, v201, v196
    v_mfma_f32_16x16x32_bf16 v[12:15], v[156:159], a[200:203], 0
    s_add_u32 m0, s21, 33280
    ds_read_b64_tr_b16 a[238:239], v221 offset:672
    v_mfma_f32_16x16x32_bf16 v[12:15], v[144:147], a[204:207], v[12:15]
    buffer_load_dwordx4 v222, s[4:7], s23 offen offset:0 nt lds
    v_mfma_f32_16x16x32_bf16 v[24:27], v[144:147], a[208:211], 0
    ds_read_b64_tr_b16 a[240:241], v221 offset:192
    v_mfma_f32_16x16x32_bf16 v[24:27], v[156:159], a[212:215], v[24:27]
    ds_read_b64_tr_b16 a[242:243], v221 offset:704
    v_mfma_f32_16x16x32_bf16 v[28:31], v[160:163], a[212:215], 0
    v_exp_f32 v197, v125
    v_mfma_f32_16x16x32_bf16 v[28:31], v[148:151], a[208:211], v[28:31]
    ds_read_b64_tr_b16 a[244:245], v221 offset:16832
    v_cvt_pk_bf16_f32 v184, v196, v197
    v_mfma_f32_16x16x32_bf16 v[32:35], v[152:155], a[208:211], 0
    ds_read_b64_tr_b16 a[246:247], v221 offset:17344
    v_add_f32 v201, v201, v197
    v_mfma_f32_16x16x32_bf16 v[32:35], v[164:167], a[212:215], v[32:35]
    s_waitcnt lgkmcnt(4)
    v_exp_f32 v198, v126
    v_mfma_f32_16x16x32_bf16 v[44:47], v[164:167], a[216:219], 0
    ds_read_b64_tr_b16 a[248:249], v221 offset:16864
    v_add_f32 v201, v201, v198
    v_mfma_f32_16x16x32_bf16 v[44:47], v[152:155], a[220:223], v[44:47]
    s_add_u32 m0, s21, 33296
    ds_read_b64_tr_b16 a[250:251], v221 offset:17376
    v_mfma_f32_16x16x32_bf16 v[40:43], v[148:151], a[220:223], 0
    buffer_load_dwordx4 v222, s[4:7], s23 offen offset:1024 nt lds
    v_mfma_f32_16x16x32_bf16 v[40:43], v[160:163], a[216:219], v[40:43]
    ds_read_b64_tr_b16 a[252:253], v221 offset:224
    v_mfma_f32_16x16x32_bf16 v[36:39], v[156:159], a[216:219], 0
    ds_read_b64_tr_b16 a[254:255], v221 offset:736
    v_mfma_f32_16x16x32_bf16 v[36:39], v[144:147], a[220:223], v[36:39]
    v_exp_f32 v199, v127
    v_mfma_f32_16x16x32_bf16 v[48:51], v[144:147], a[224:227], 0
    ds_read_b64_tr_b16 a[192:193], v221 offset:256
    v_cvt_pk_bf16_f32 v185, v198, v199
    v_mfma_f32_16x16x32_bf16 v[48:51], v[156:159], a[228:231], v[48:51]
    ds_read_b64_tr_b16 a[194:195], v221 offset:768
    v_add_f32 v201, v201, v199
    v_mfma_f32_16x16x32_bf16 v[52:55], v[160:163], a[228:231], 0
    v_exp_f32 v192, v128
    v_mfma_f32_16x16x32_bf16 v[52:55], v[148:151], a[224:227], v[52:55]
    ds_read_b64_tr_b16 a[196:197], v221 offset:16896
    v_add_f32 v202, v202, v192
    v_mfma_f32_16x16x32_bf16 v[56:59], v[152:155], a[224:227], 0
    s_add_u32 m0, s21, 33312
    ds_read_b64_tr_b16 a[198:199], v221 offset:17408
    v_mfma_f32_16x16x32_bf16 v[56:59], v[164:167], a[228:231], v[56:59]
    buffer_load_dwordx4 v222, s[4:7], s23 offen offset:2048 nt lds
    v_mfma_f32_16x16x32_bf16 a[4:7], v[164:167], a[232:235], 0
    ds_read_b64_tr_b16 a[200:201], v221 offset:16928
    v_mfma_f32_16x16x32_bf16 a[4:7], v[152:155], a[236:239], a[4:7]
    ds_read_b64_tr_b16 a[202:203], v221 offset:17440
    v_mfma_f32_16x16x32_bf16 a[0:3], v[148:151], a[236:239], 0
    v_exp_f32 v193, v129
    v_mfma_f32_16x16x32_bf16 a[0:3], v[160:163], a[232:235], a[0:3]
    ds_read_b64_tr_b16 a[204:205], v221 offset:288
    v_cvt_pk_bf16_f32 v188, v192, v193
    v_mfma_f32_16x16x32_bf16 v[60:63], v[156:159], a[232:235], 0
    ds_read_b64_tr_b16 a[206:207], v221 offset:800
    v_add_f32 v202, v202, v193
    v_mfma_f32_16x16x32_bf16 v[60:63], v[144:147], a[236:239], v[60:63]
    s_waitcnt lgkmcnt(4)
    v_exp_f32 v194, v130
    v_mfma_f32_16x16x32_bf16 a[8:11], v[144:147], a[240:243], 0
    ds_read_b64_tr_b16 a[208:209], v221 offset:320
    v_add_f32 v202, v202, v194
    v_mfma_f32_16x16x32_bf16 a[8:11], v[156:159], a[244:247], a[8:11]
    s_add_u32 m0, s21, 33328
    ds_read_b64_tr_b16 a[210:211], v221 offset:832
    v_mfma_f32_16x16x32_bf16 a[12:15], v[160:163], a[244:247], 0
    buffer_load_dwordx4 v222, s[4:7], s23 offen offset:3072 nt lds
    v_mfma_f32_16x16x32_bf16 a[12:15], v[148:151], a[240:243], a[12:15]
    s_add_u32 s23, s23, 4096
    ds_read_b64_tr_b16 a[212:213], v221 offset:16960
    v_mfma_f32_16x16x32_bf16 a[16:19], v[152:155], a[240:243], 0
    ds_read_b64_tr_b16 a[214:215], v221 offset:17472
    v_mfma_f32_16x16x32_bf16 a[16:19], v[164:167], a[244:247], a[16:19]
    v_exp_f32 v195, v131
    v_mfma_f32_16x16x32_bf16 a[28:31], v[164:167], a[248:251], 0
    ds_read_b64_tr_b16 a[216:217], v221 offset:16992
    v_cvt_pk_bf16_f32 v189, v194, v195
    v_mfma_f32_16x16x32_bf16 a[28:31], v[152:155], a[252:255], a[28:31]
    ds_read_b64_tr_b16 a[218:219], v221 offset:17504
    v_add_f32 v202, v202, v195
    v_mfma_f32_16x16x32_bf16 a[24:27], v[148:151], a[252:255], 0
    v_exp_f32 v196, v140
    v_mfma_f32_16x16x32_bf16 a[24:27], v[160:163], a[248:251], a[24:27]
    ds_read_b64_tr_b16 a[220:221], v221 offset:352
    v_add_f32 v202, v202, v196
    v_mfma_f32_16x16x32_bf16 a[20:23], v[156:159], a[248:251], 0
    s_add_u32 m0, s21, 37440
    ds_read_b64_tr_b16 a[222:223], v221 offset:864
    v_mfma_f32_16x16x32_bf16 a[20:23], v[144:147], a[252:255], a[20:23]
    buffer_load_dwordx4 v222, s[4:7], s23 offen offset:0 nt lds
    v_mfma_f32_16x16x32_bf16 a[32:35], v[144:147], a[192:195], 0
    ds_read_b64_tr_b16 a[224:225], v221 offset:384
    v_mfma_f32_16x16x32_bf16 a[32:35], v[156:159], a[196:199], a[32:35]
    ds_read_b64_tr_b16 a[226:227], v221 offset:896
    v_mfma_f32_16x16x32_bf16 a[36:39], v[160:163], a[196:199], 0
    v_exp_f32 v197, v141
    v_mfma_f32_16x16x32_bf16 a[36:39], v[148:151], a[192:195], a[36:39]
    ds_read_b64_tr_b16 a[228:229], v221 offset:17024
    v_cvt_pk_bf16_f32 v190, v196, v197
    v_mfma_f32_16x16x32_bf16 a[40:43], v[152:155], a[192:195], 0
    ds_read_b64_tr_b16 a[230:231], v221 offset:17536
    v_add_f32 v202, v202, v197
    v_mfma_f32_16x16x32_bf16 a[40:43], v[164:167], a[196:199], a[40:43]
    s_waitcnt lgkmcnt(4)
    v_exp_f32 v198, v142
    v_mfma_f32_16x16x32_bf16 a[52:55], v[164:167], a[200:203], 0
    ds_read_b64_tr_b16 a[232:233], v221 offset:17056
    v_add_f32 v202, v202, v198
    v_mfma_f32_16x16x32_bf16 a[52:55], v[152:155], a[204:207], a[52:55]
    s_add_u32 m0, s21, 37456
    ds_read_b64_tr_b16 a[234:235], v221 offset:17568
    v_mfma_f32_16x16x32_bf16 a[48:51], v[148:151], a[204:207], 0
    buffer_load_dwordx4 v222, s[4:7], s23 offen offset:1024 nt lds
    v_mfma_f32_16x16x32_bf16 a[48:51], v[160:163], a[200:203], a[48:51]
    ds_read_b64_tr_b16 a[236:237], v221 offset:416
    v_mfma_f32_16x16x32_bf16 a[44:47], v[156:159], a[200:203], 0
    ds_read_b64_tr_b16 a[238:239], v221 offset:928
    v_mfma_f32_16x16x32_bf16 a[44:47], v[144:147], a[204:207], a[44:47]
    v_exp_f32 v199, v143
    v_mfma_f32_16x16x32_bf16 a[56:59], v[144:147], a[208:211], 0
    ds_read_b64_tr_b16 a[240:241], v221 offset:448
    v_cvt_pk_bf16_f32 v191, v198, v199
    v_mfma_f32_16x16x32_bf16 a[56:59], v[156:159], a[212:215], a[56:59]
    ds_read_b64_tr_b16 a[242:243], v221 offset:960
    v_add_f32 v202, v202, v199
    v_mfma_f32_16x16x32_bf16 a[60:63], v[160:163], a[212:215], 0
    v_exp_f32 v192, v136
    v_mfma_f32_16x16x32_bf16 a[60:63], v[148:151], a[208:211], a[60:63]
    ds_read_b64_tr_b16 a[244:245], v221 offset:17088
    v_add_f32 v201, v201, v192
    v_mfma_f32_16x16x32_bf16 a[64:67], v[152:155], a[208:211], 0
    s_add_u32 m0, s21, 37472
    ds_read_b64_tr_b16 a[246:247], v221 offset:17600
    v_mfma_f32_16x16x32_bf16 a[64:67], v[164:167], a[212:215], a[64:67]
    buffer_load_dwordx4 v222, s[4:7], s23 offen offset:2048 nt lds
    v_mfma_f32_16x16x32_bf16 a[76:79], v[164:167], a[216:219], 0
    ds_read_b64_tr_b16 a[248:249], v221 offset:17120
    v_mfma_f32_16x16x32_bf16 a[76:79], v[152:155], a[220:223], a[76:79]
    ds_read_b64_tr_b16 a[250:251], v221 offset:17632
    v_mfma_f32_16x16x32_bf16 a[72:75], v[148:151], a[220:223], 0
    v_exp_f32 v193, v137
    v_mfma_f32_16x16x32_bf16 a[72:75], v[160:163], a[216:219], a[72:75]
    ds_read_b64_tr_b16 a[252:253], v221 offset:480
    v_cvt_pk_bf16_f32 v186, v192, v193
    v_mfma_f32_16x16x32_bf16 a[68:71], v[156:159], a[216:219], 0
    s_add_u32 m0, s21, 37488
    ds_read_b64_tr_b16 a[254:255], v221 offset:992
    v_mfma_f32_16x16x32_bf16 a[68:71], v[144:147], a[220:223], a[68:71]
    s_waitcnt lgkmcnt(4)
    buffer_load_dwordx4 v222, s[4:7], s23 offen offset:3072 nt lds
    v_mfma_f32_16x16x32_bf16 a[80:83], v[144:147], a[224:227], 0
    s_add_u32 s23, s23, 28672
    v_exp_f32 v194, v138
    v_mfma_f32_16x16x32_bf16 a[80:83], v[156:159], a[228:231], a[80:83]
    v_exp_f32 v195, v139
    v_mfma_f32_16x16x32_bf16 a[84:87], v[160:163], a[228:231], 0
    v_exp_f32 v196, v132
    v_mfma_f32_16x16x32_bf16 a[84:87], v[148:151], a[224:227], a[84:87]
    v_exp_f32 v197, v133
    v_mfma_f32_16x16x32_bf16 a[88:91], v[152:155], a[224:227], 0
    v_exp_f32 v198, v134
    v_mfma_f32_16x16x32_bf16 a[88:91], v[164:167], a[228:231], a[88:91]
    s_waitcnt vmcnt(16) lgkmcnt(0)
    v_mfma_f32_16x16x32_bf16 a[100:103], v[164:167], a[232:235], 0
    s_barrier
    v_mfma_f32_16x16x32_bf16 a[100:103], v[152:155], a[236:239], a[100:103]
    ds_read_b128 a[192:195], v220 offset:0
    v_add_f32 v201, v201, v193
    v_mfma_f32_16x16x32_bf16 a[96:99], v[148:151], a[236:239], 0
    v_exp_f32 v199, v135
    v_mfma_f32_16x16x32_bf16 a[96:99], v[160:163], a[232:235], a[96:99]
    ds_read_b128 a[196:199], v220 offset:64
    v_add_f32 v201, v201, v194
    v_mfma_f32_16x16x32_bf16 a[92:95], v[156:159], a[232:235], 0
    v_cvt_pk_bf16_f32 v187, v194, v195
    v_add_f32 v201, v201, v195
    v_mfma_f32_16x16x32_bf16 a[92:95], v[144:147], a[236:239], a[92:95]
    s_add_u32 m0, s22, 0
    ds_read_b128 a[200:203], v220 offset:128
    v_mfma_f32_16x16x32_bf16 a[104:107], v[144:147], a[240:243], 0
    buffer_load_dwordx4 v223, s[8:11], s24 offen offset:0 nt lds
    v_mfma_f32_16x16x32_bf16 a[104:107], v[156:159], a[244:247], a[104:107]
    ds_read_b128 a[204:207], v220 offset:192
    v_add_f32 v200, v200, v196
    v_mfma_f32_16x16x32_bf16 a[108:111], v[160:163], a[244:247], 0
    v_cvt_pk_bf16_f32 v182, v196, v197
    v_add_f32 v200, v200, v197
    v_mfma_f32_16x16x32_bf16 a[108:111], v[148:151], a[240:243], a[108:111]
    ds_read_b128 a[208:211], v220 offset:256
    v_add_f32 v200, v200, v198
    v_mfma_f32_16x16x32_bf16 a[112:115], v[152:155], a[240:243], 0
    v_cvt_pk_bf16_f32 v183, v198, v199
    v_add_f32 v200, v200, v199
    v_mfma_f32_16x16x32_bf16 a[112:115], v[164:167], a[244:247], a[112:115]
    s_add_u32 m0, s22, 7808
    ds_read_b128 a[212:215], v220 offset:320
    v_mfma_f32_16x16x32_bf16 a[124:127], v[164:167], a[248:251], 0
    buffer_load_dwordx4 v223, s[8:11], s24 offen offset:512 nt lds
    v_mfma_f32_16x16x32_bf16 a[124:127], v[152:155], a[252:255], a[124:127]
    ds_read_b128 a[216:219], v220 offset:384
    v_max3_f32 v206, v200, v201, v202
    v_mfma_f32_16x16x32_bf16 a[120:123], v[148:151], a[252:255], 0
    v_cmp_nge_f32 vcc, s29, v206
    v_mfma_f32_16x16x32_bf16 a[120:123], v[160:163], a[248:251], a[120:123]
    ds_read_b128 a[220:223], v220 offset:448
    v_mfma_f32_16x16x32_bf16 a[116:119], v[156:159], a[248:251], 0
    s_waitcnt lgkmcnt(3)
    v_mfma_f32_16x16x32_bf16 a[116:119], v[144:147], a[252:255], a[116:119]
    s_cmp_ge_u32 s20, 2
    s_cbranch_vccnz L_tr_first
L_ret_first:
    s_cbranch_scc1 L_ret1
    s_branch L_ret0
.p2align 6
L_loop0:
    v_mfma_f32_16x16x32_bf16 v[96:99], a[192:195], a[128:131], v[208:211]
    v_mfma_f32_16x16x32_bf16 v[96:99], a[196:199], a[132:135], v[96:99]
    v_mfma_f32_16x16x32_bf16 v[96:99], a[200:203], a[136:139], v[96:99]
    s_add_u32 m0, s22, 33312
    ds_read_b128 a[224:227], v220 offset:34768
    v_mfma_f32_16x16x32_bf16 v[96:99], a[204:207], a[140:143], v[96:99]
    buffer_load_dwordx4 v223, s[8:11], s24 offen offset:2048 nt lds
    v_mfma_f32_16x16x32_bf16 v[96:99], a[208:211], a[144:147], v[96:99]
    s_waitcnt lgkmcnt(1)
    ds_read_b128 a[228:231], v220 offset:34704
    v_mfma_f32_16x16x32_bf16 v[96:99], a[212:215], a[148:151], v[96:99]
    v_mfma_f32_16x16x32_bf16 v[96:99], a[216:219], a[152:155], v[96:99]
    ds_read_b128 a[232:235], v220 offset:34640
    v_mfma_f32_16x16x32_bf16 v[96:99], a[220:223], a[156:159], v[96:99]
    v_mfma_f32_16x16x32_bf16 v[100:103], a[220:223], a[188:191], v[212:215]
    ds_read_b128 a[236:239], v220 offset:34576
    v_mfma_f32_16x16x32_bf16 v[100:103], a[216:219], a[184:187], v[100:103]
    v_mfma_f32_16x16x32_bf16 v[100:103], a[212:215], a[180:183], v[100:103]
    s_add_u32 m0, s22, 41120
    ds_read_b128 a[240:243], v220 offset:34512
    v_mfma_f32_16x16x32_bf16 v[100:103], a[208:211], a[176:179], v[100:103]
    buffer_load_dwordx4 v223, s[8:11], s24 offen offset:2560 nt lds
    v_mfma_f32_16x16x32_bf16 v[100:103], a[204:207], a[172:175], v[100:103]
    s_add_u32 s24, s24, 4096
    ds_read_b128 a[244:247], v220 offset:34448
    v_mfma_f32_16x16x32_bf16 v[100:103], a[200:203], a[168:171], v[100:103]
    v_exp_f32 v192, v96
    v_mfma_f32_16x16x32_bf16 v[100:103], a[196:199], a[164:167], v[100:103]
    ds_read_b128 a[248:251], v220 offset:34384
    v_add_f32 v200, v203, v192
    v_mfma_f32_16x16x32_bf16 v[100:103], a[192:195], a[160:163], v[100:103]
    v_exp_f32 v193, v97
    v_mfma_f32_16x16x32_bf16 v[104:107], a[192:195], v[64:67], v[216:219]
    ds_read_b128 a[252:255], v220 offset:34320
    v_cvt_pk_bf16_f32 v168, v192, v193
    v_mfma_f32_16x16x32_bf16 v[104:107], a[196:199], v[68:71], v[104:107]
    v_exp_f32 v194, v98
    v_mfma_f32_16x16x32_bf16 v[104:107], a[200:203], v[72:75], v[104:107]
    s_add_u32 m0, s22, 37440
    v_add_f32 v200, v200, v193
    v_mfma_f32_16x16x32_bf16 v[104:107], a[204:207], v[76:79], v[104:107]
    buffer_load_dwordx4 v223, s[8:11], s24 offen offset:0 nt lds
    v_mfma_f32_16x16x32_bf16 v[104:107], a[208:211], v[80:83], v[104:107]
    v_exp_f32 v195, v99
    v_mfma_f32_16x16x32_bf16 v[104:107], a[212:215], v[84:87], v[104:107]
    v_exp_f32 v196, v100
    v_mfma_f32_16x16x32_bf16 v[104:107], a[216:219], v[88:91], v[104:107]
    v_exp_f32 v197, v101
    v_mfma_f32_16x16x32_bf16 v[104:107], a[220:223], v[92:95], v[104:107]
    s_waitcnt lgkmcnt(0)
    v_exp_f32 v198, v102
    v_mfma_f32_16x16x32_bf16 v[116:119], a[224:227], v[92:95], v[216:219]
    v_exp_f32 v199, v103
    v_mfma_f32_16x16x32_bf16 v[116:119], a[228:231], v[88:91], v[116:119]
    v_add_f32 v200, v200, v194
    v_cvt_pk_bf16_f32 v169, v194, v195
    v_mfma_f32_16x16x32_bf16 v[116:119], a[232:235], v[84:87], v[116:119]
    s_add_u32 m0, s22, 45248
    ds_read_b128 a[192:195], v220 offset:49920
    v_mfma_f32_16x16x32_bf16 v[116:119], a[236:239], v[80:83], v[116:119]
    buffer_load_dwordx4 v223, s[8:11], s24 offen offset:512 nt lds
    v_mfma_f32_16x16x32_bf16 v[116:119], a[240:243], v[76:79], v[116:119]
    ds_read_b128 a[196:199], v220 offset:49984
    v_add_f32 v200, v200, v195
    v_mfma_f32_16x16x32_bf16 v[116:119], a[244:247], v[72:75], v[116:119]
    v_exp_f32 v192, v104
    v_mfma_f32_16x16x32_bf16 v[116:119], a[248:251], v[68:71], v[116:119]
    ds_read_b128 a[200:203], v220 offset:50048
    v_mfma_f32_16x16x32_bf16 v[116:119], a[252:255], v[64:67], v[116:119]
    v_exp_f32 v193, v105
    v_mfma_f32_16x16x32_bf16 v[112:115], a[252:255], a[160:163], v[212:215]
    ds_read_b128 a[204:207], v220 offset:50112
    v_add_f32 v201, v204, v196
    v_mfma_f32_16x16x32_bf16 v[112:115], a[248:251], a[164:167], v[112:115]
    v_exp_f32 v194, v106
    v_mfma_f32_16x16x32_bf16 v[112:115], a[244:247], a[168:171], v[112:115]
    s_add_u32 m0, s22, 37472
    ds_read_b128 a[208:211], v220 offset:50176
    v_mfma_f32_16x16x32_bf16 v[112:115], a[240:243], a[172:175], v[112:115]
    buffer_load_dwordx4 v223, s[8:11], s24 offen offset:2048 nt lds
    v_mfma_f32_16x16x32_bf16 v[112:115], a[236:239], a[176:179], v[112:115]
    ds_read_b128 a[212:215], v220 offset:50240
    v_mfma_f32_16x16x32_bf16 v[112:115], a[232:235], a[180:183], v[112:115]
    v_exp_f32 v195, v107
    v_mfma_f32_16x16x32_bf16 v[112:115], a[228:231], a[184:187], v[112:115]
    ds_read_b128 a[216:219], v220 offset:50304
    v_cvt_pk_bf16_f32 v172, v196, v197
    v_mfma_f32_16x16x32_bf16 v[112:115], a[224:227], a[188:191], v[112:115]
    v_exp_f32 v196, v116
    v_mfma_f32_16x16x32_bf16 v[108:111], a[224:227], a[156:159], v[208:211]
    ds_read_b128 a[220:223], v220 offset:50368
    v_mfma_f32_16x16x32_bf16 v[108:111], a[228:231], a[152:155], v[108:111]
    v_add_f32 v201, v201, v197
    v_add_f32 v201, v201, v198
    v_mfma_f32_16x16x32_bf16 v[108:111], a[232:235], a[148:151], v[108:111]
    s_add_u32 m0, s22, 45280
    v_cvt_pk_bf16_f32 v173, v198, v199
    v_mfma_f32_16x16x32_bf16 v[108:111], a[236:239], a[144:147], v[108:111]
    buffer_load_dwordx4 v223, s[8:11], s24 offen offset:2560 nt lds
    v_mfma_f32_16x16x32_bf16 v[108:111], a[240:243], a[140:143], v[108:111]
    s_add_u32 s24, s24, 28672
    v_exp_f32 v197, v117
    v_mfma_f32_16x16x32_bf16 v[108:111], a[244:247], a[136:139], v[108:111]
    v_exp_f32 v198, v118
    v_mfma_f32_16x16x32_bf16 v[108:111], a[248:251], a[132:135], v[108:111]
    ds_read_b128 a[224:227], v220 offset:51408
    v_mfma_f32_16x16x32_bf16 v[108:111], a[252:255], a[128:131], v[108:111]
    s_waitcnt lgkmcnt(1)
    v_add_f32 v201, v201, v199
    v_add_f32 v202, v205, v192
    v_mfma_f32_16x16x32_bf16 v[120:123], a[192:195], a[128:131], v[208:211]
    ds_read_b128 a[228:231], v220 offset:51344
    v_mfma_f32_16x16x32_bf16 v[120:123], a[196:199], a[132:135], v[120:123]
    v_exp_f32 v199, v119
    v_mfma_f32_16x16x32_bf16 v[120:123], a[200:203], a[136:139], v[120:123]
    ds_read_b128 a[232:235], v220 offset:51280
    v_cvt_pk_bf16_f32 v176, v192, v193
    v_mfma_f32_16x16x32_bf16 v[120:123], a[204:207], a[140:143], v[120:123]
    v_exp_f32 v192, v112
    v_mfma_f32_16x16x32_bf16 v[120:123], a[208:211], a[144:147], v[120:123]
    ds_read_b128 a[236:239], v220 offset:51216
    v_add_f32 v202, v202, v193
    v_mfma_f32_16x16x32_bf16 v[120:123], a[212:215], a[148:151], v[120:123]
    v_exp_f32 v193, v113
    v_mfma_f32_16x16x32_bf16 v[120:123], a[216:219], a[152:155], v[120:123]
    ds_read_b128 a[240:243], v220 offset:51152
    v_mfma_f32_16x16x32_bf16 v[120:123], a[220:223], a[156:159], v[120:123]
    v_add_f32 v202, v202, v194
    v_cvt_pk_bf16_f32 v177, v194, v195
    v_mfma_f32_16x16x32_bf16 v[124:127], a[220:223], a[188:191], v[212:215]
    ds_read_b128 a[244:247], v220 offset:51088
    v_add_f32 v202, v202, v195
    v_mfma_f32_16x16x32_bf16 v[124:127], a[216:219], a[184:187], v[124:127]
    v_exp_f32 v194, v114
    v_mfma_f32_16x16x32_bf16 v[124:127], a[212:215], a[180:183], v[124:127]
    ds_read_b128 a[248:251], v220 offset:51024
    v_mfma_f32_16x16x32_bf16 v[124:127], a[208:211], a[176:179], v[124:127]
    v_exp_f32 v195, v115
    v_mfma_f32_16x16x32_bf16 v[124:127], a[204:207], a[172:175], v[124:127]
    ds_read_b128 a[252:255], v220 offset:50960
    v_add_f32 v202, v202, v196
    v_mfma_f32_16x16x32_bf16 v[124:127], a[200:203], a[168:171], v[124:127]
    v_cvt_pk_bf16_f32 v178, v196, v197
    v_mfma_f32_16x16x32_bf16 v[124:127], a[196:199], a[164:167], v[124:127]
    v_exp_f32 v196, v108
    v_mfma_f32_16x16x32_bf16 v[124:127], a[192:195], a[160:163], v[124:127]
    v_add_f32 v202, v202, v197
    v_add_f32 v202, v202, v198
    v_mfma_f32_16x16x32_bf16 v[128:131], a[192:195], v[64:67], v[216:219]
    v_exp_f32 v197, v109
    v_mfma_f32_16x16x32_bf16 v[128:131], a[196:199], v[68:71], v[128:131]
    v_cvt_pk_bf16_f32 v179, v198, v199
    v_mfma_f32_16x16x32_bf16 v[128:131], a[200:203], v[72:75], v[128:131]
    v_exp_f32 v198, v110
    v_mfma_f32_16x16x32_bf16 v[128:131], a[204:207], v[76:79], v[128:131]
    s_waitcnt vmcnt(16) lgkmcnt(0)
    v_mfma_f32_16x16x32_bf16 v[128:131], a[208:211], v[80:83], v[128:131]
    s_barrier
    v_mfma_f32_16x16x32_bf16 v[128:131], a[212:215], v[84:87], v[128:131]
    v_add_f32 v202, v202, v199
    v_mfma_f32_16x16x32_bf16 v[128:131], a[216:219], v[88:91], v[128:131]
    v_exp_f32 v199, v111
    v_mfma_f32_16x16x32_bf16 v[128:131], a[220:223], v[92:95], v[128:131]
    v_add_f32 v201, v201, v192
    v_cvt_pk_bf16_f32 v174, v192, v193
    v_mfma_f32_16x16x32_bf16 v[140:143], a[224:227], v[92:95], v[216:219]
    ds_read_b64_tr_b16 a[192:193], v221 offset:0
    v_mfma_f32_16x16x32_bf16 v[140:143], a[228:231], v[88:91], v[140:143]
    s_add_u32 m0, s21, 33280
    ds_read_b64_tr_b16 a[194:195], v221 offset:512
    v_mfma_f32_16x16x32_bf16 v[140:143], a[232:235], v[84:87], v[140:143]
    buffer_load_dwordx4 v222, s[4:7], s23 offen offset:0 nt lds
    v_mfma_f32_16x16x32_bf16 v[140:143], a[236:239], v[80:83], v[140:143]
    ds_read_b64_tr_b16 a[196:197], v221 offset:16640
    v_add_f32 v201, v201, v193
    v_mfma_f32_16x16x32_bf16 v[140:143], a[240:243], v[76:79], v[140:143]
    ds_read_b64_tr_b16 a[198:199], v221 offset:17152
    v_add_f32 v201, v201, v194
    v_mfma_f32_16x16x32_bf16 v[140:143], a[244:247], v[72:75], v[140:143]
    v_exp_f32 v192, v120
    v_mfma_f32_16x16x32_bf16 v[140:143], a[248:251], v[68:71], v[140:143]
    ds_read_b64_tr_b16 a[200:201], v221 offset:16672
    v_cvt_pk_bf16_f32 v175, v194, v195
    v_mfma_f32_16x16x32_bf16 v[140:143], a[252:255], v[64:67], v[140:143]
    ds_read_b64_tr_b16 a[202:203], v221 offset:17184
    v_mfma_f32_16x16x32_bf16 v[136:139], a[252:255], a[160:163], v[212:215]
    v_exp_f32 v193, v121
    v_mfma_f32_16x16x32_bf16 v[136:139], a[248:251], a[164:167], v[136:139]
    ds_read_b64_tr_b16 a[204:205], v221 offset:32
    v_add_f32 v201, v201, v195
    v_mfma_f32_16x16x32_bf16 v[136:139], a[244:247], a[168:171], v[136:139]
    s_add_u32 m0, s21, 33296
    ds_read_b64_tr_b16 a[206:207], v221 offset:544
    v_mfma_f32_16x16x32_bf16 v[136:139], a[240:243], a[172:175], v[136:139]
    buffer_load_dwordx4 v222, s[4:7], s23 offen offset:1024 nt lds
    v_mfma_f32_16x16x32_bf16 v[136:139], a[236:239], a[176:179], v[136:139]
    ds_read_b64_tr_b16 a[208:209], v221 offset:64
    v_add_f32 v200, v200, v196
    v_mfma_f32_16x16x32_bf16 v[136:139], a[232:235], a[180:183], v[136:139]
    ds_read_b64_tr_b16 a[210:211], v221 offset:576
    v_cvt_pk_bf16_f32 v170, v196, v197
    v_mfma_f32_16x16x32_bf16 v[136:139], a[228:231], a[184:187], v[136:139]
    v_exp_f32 v194, v122
    v_mfma_f32_16x16x32_bf16 v[136:139], a[224:227], a[188:191], v[136:139]
    ds_read_b64_tr_b16 a[212:213], v221 offset:16704
    v_mfma_f32_16x16x32_bf16 v[132:135], a[224:227], a[156:159], v[208:211]
    ds_read_b64_tr_b16 a[214:215], v221 offset:17216
    v_add_f32 v200, v200, v197
    v_mfma_f32_16x16x32_bf16 v[132:135], a[228:231], a[152:155], v[132:135]
    v_exp_f32 v195, v123
    v_mfma_f32_16x16x32_bf16 v[132:135], a[232:235], a[148:151], v[132:135]
    ds_read_b64_tr_b16 a[216:217], v221 offset:16736
    v_mfma_f32_16x16x32_bf16 v[132:135], a[236:239], a[144:147], v[132:135]
    s_add_u32 m0, s21, 33312
    ds_read_b64_tr_b16 a[218:219], v221 offset:17248
    v_mfma_f32_16x16x32_bf16 v[132:135], a[240:243], a[140:143], v[132:135]
    buffer_load_dwordx4 v222, s[4:7], s23 offen offset:2048 nt lds
    v_mfma_f32_16x16x32_bf16 v[132:135], a[244:247], a[136:139], v[132:135]
    ds_read_b64_tr_b16 a[220:221], v221 offset:96
    v_add_f32 v200, v200, v198
    v_mfma_f32_16x16x32_bf16 v[132:135], a[248:251], a[132:135], v[132:135]
    ds_read_b64_tr_b16 a[222:223], v221 offset:608
    v_cvt_pk_bf16_f32 v171, v198, v199
    v_mfma_f32_16x16x32_bf16 v[132:135], a[252:255], a[128:131], v[132:135]
    s_waitcnt lgkmcnt(4)
    v_exp_f32 v196, v124
    v_mfma_f32_16x16x32_bf16 v[0:3], v[144:147], a[192:195], v[0:3]
    ds_read_b64_tr_b16 a[224:225], v221 offset:128
    v_add_f32 v200, v200, v199
    v_mfma_f32_16x16x32_bf16 v[0:3], v[156:159], a[196:199], v[0:3]
    ds_read_b64_tr_b16 a[226:227], v221 offset:640
    v_add_f32 v200, v200, v192
    v_mfma_f32_16x16x32_bf16 v[4:7], v[160:163], a[196:199], v[4:7]
    v_exp_f32 v197, v125
    v_mfma_f32_16x16x32_bf16 v[4:7], v[148:151], a[192:195], v[4:7]
    ds_read_b64_tr_b16 a[228:229], v221 offset:16768
    v_mfma_f32_16x16x32_bf16 v[8:11], v[152:155], a[192:195], v[8:11]
    s_add_u32 m0, s21, 33328
    ds_read_b64_tr_b16 a[230:231], v221 offset:17280
    v_mfma_f32_16x16x32_bf16 v[8:11], v[164:167], a[196:199], v[8:11]
    buffer_load_dwordx4 v222, s[4:7], s23 offen offset:3072 nt lds
    v_mfma_f32_16x16x32_bf16 v[20:23], v[164:167], a[200:203], v[20:23]
    s_add_u32 s23, s23, 4096
    ds_read_b64_tr_b16 a[232:233], v221 offset:16800
    v_cvt_pk_bf16_f32 v180, v192, v193
    v_mfma_f32_16x16x32_bf16 v[20:23], v[152:155], a[204:207], v[20:23]
    ds_read_b64_tr_b16 a[234:235], v221 offset:17312
    v_add_f32 v200, v200, v193
    v_mfma_f32_16x16x32_bf16 v[16:19], v[148:151], a[204:207], v[16:19]
    v_exp_f32 v198, v126
    v_mfma_f32_16x16x32_bf16 v[16:19], v[160:163], a[200:203], v[16:19]
    ds_read_b64_tr_b16 a[236:237], v221 offset:160
    v_mfma_f32_16x16x32_bf16 v[12:15], v[156:159], a[200:203], v[12:15]
    ds_read_b64_tr_b16 a[238:239], v221 offset:672
    v_add_f32 v200, v200, v194
    v_mfma_f32_16x16x32_bf16 v[12:15], v[144:147], a[204:207], v[12:15]
    v_exp_f32 v199, v127
    v_mfma_f32_16x16x32_bf16 v[24:27], v[144:147], a[208:211], v[24:27]
    ds_read_b64_tr_b16 a[240:241], v221 offset:192
    v_cvt_pk_bf16_f32 v181, v194, v195
    v_mfma_f32_16x16x32_bf16 v[24:27], v[156:159], a[212:215], v[24:27]
    s_add_u32 m0, s21, 37440
    ds_read_b64_tr_b16 a[242:243], v221 offset:704
    v_mfma_f32_16x16x32_bf16 v[28:31], v[160:163], a[212:215], v[28:31]
    buffer_load_dwordx4 v222, s[4:7], s23 offen offset:0 nt lds
    v_mfma_f32_16x16x32_bf16 v[28:31], v[148:151], a[208:211], v[28:31]
    ds_read_b64_tr_b16 a[244:245], v221 offset:16832
    v_mfma_f32_16x16x32_bf16 v[32:35], v[152:155], a[208:211], v[32:35]
    ds_read_b64_tr_b16 a[246:247], v221 offset:17344
    v_add_f32 v200, v200, v195
    v_mfma_f32_16x16x32_bf16 v[32:35], v[164:167], a[212:215], v[32:35]
    s_waitcnt lgkmcnt(4)
    v_exp_f32 v192, v128
    v_mfma_f32_16x16x32_bf16 v[44:47], v[164:167], a[216:219], v[44:47]
    ds_read_b64_tr_b16 a[248:249], v221 offset:16864
    v_add_f32 v201, v201, v196
    v_mfma_f32_16x16x32_bf16 v[44:47], v[152:155], a[220:223], v[44:47]
    ds_read_b64_tr_b16 a[250:251], v221 offset:17376
    v_cvt_pk_bf16_f32 v184, v196, v197
    v_mfma_f32_16x16x32_bf16 v[40:43], v[148:151], a[220:223], v[40:43]
    v_exp_f32 v193, v129
    v_mfma_f32_16x16x32_bf16 v[40:43], v[160:163], a[216:219], v[40:43]
    ds_read_b64_tr_b16 a[252:253], v221 offset:224
    v_mfma_f32_16x16x32_bf16 v[36:39], v[156:159], a[216:219], v[36:39]
    s_add_u32 m0, s21, 37456
    ds_read_b64_tr_b16 a[254:255], v221 offset:736
    v_mfma_f32_16x16x32_bf16 v[36:39], v[144:147], a[220:223], v[36:39]
    buffer_load_dwordx4 v222, s[4:7], s23 offen offset:1024 nt lds
    v_mfma_f32_16x16x32_bf16 v[48:51], v[144:147], a[224:227], v[48:51]
    ds_read_b64_tr_b16 a[192:193], v221 offset:256
    v_add_f32 v201, v201, v197
    v_mfma_f32_16x16x32_bf16 v[48:51], v[156:159], a[228:231], v[48:51]
    ds_read_b64_tr_b16 a[194:195], v221 offset:768
    v_add_f32 v201, v201, v198
    v_mfma_f32_16x16x32_bf16 v[52:55], v[160:163], a[228:231], v[52:55]
    v_exp_f32 v194, v130
    v_mfma_f32_16x16x32_bf16 v[52:55], v[148:151], a[224:227], v[52:55]
    ds_read_b64_tr_b16 a[196:197], v221 offset:16896
    v_mfma_f32_16x16x32_bf16 v[56:59], v[152:155], a[224:227], v[56:59]
    ds_read_b64_tr_b16 a[198:199], v221 offset:17408
    v_cvt_pk_bf16_f32 v185, v198, v199
    v_mfma_f32_16x16x32_bf16 v[56:59], v[164:167], a[228:231], v[56:59]
    v_exp_f32 v195, v131
    v_mfma_f32_16x16x32_bf16 a[4:7], v[164:167], a[232:235], a[4:7]
    ds_read_b64_tr_b16 a[200:201], v221 offset:16928
    v_add_f32 v201, v201, v199
    v_mfma_f32_16x16x32_bf16 a[4:7], v[152:155], a[236:239], a[4:7]
    s_add_u32 m0, s21, 37472
    ds_read_b64_tr_b16 a[202:203], v221 offset:17440
    v_mfma_f32_16x16x32_bf16 a[0:3], v[148:151], a[236:239], a[0:3]
    buffer_load_dwordx4 v222, s[4:7], s23 offen offset:2048 nt lds
    v_mfma_f32_16x16x32_bf16 a[0:3], v[160:163], a[232:235], a[0:3]
    ds_read_b64_tr_b16 a[204:205], v221 offset:288
    v_mfma_f32_16x16x32_bf16 v[60:63], v[156:159], a[232:235], v[60:63]
    ds_read_b64_tr_b16 a[206:207], v221 offset:800
    v_add_f32 v202, v202, v192
    v_mfma_f32_16x16x32_bf16 v[60:63], v[144:147], a[236:239], v[60:63]
    s_waitcnt lgkmcnt(4)
    v_exp_f32 v196, v140
    v_mfma_f32_16x16x32_bf16 a[8:11], v[144:147], a[240:243], a[8:11]
    ds_read_b64_tr_b16 a[208:209], v221 offset:320
    v_cvt_pk_bf16_f32 v188, v192, v193
    v_mfma_f32_16x16x32_bf16 a[8:11], v[156:159], a[244:247], a[8:11]
    ds_read_b64_tr_b16 a[210:211], v221 offset:832
    v_add_f32 v202, v202, v193
    v_mfma_f32_16x16x32_bf16 a[12:15], v[160:163], a[244:247], a[12:15]
    v_exp_f32 v197, v141
    v_mfma_f32_16x16x32_bf16 a[12:15], v[148:151], a[240:243], a[12:15]
    ds_read_b64_tr_b16 a[212:213], v221 offset:16960
    v_mfma_f32_16x16x32_bf16 a[16:19], v[152:155], a[240:243], a[16:19]
    s_add_u32 m0, s21, 37488
    ds_read_b64_tr_b16 a[214:215], v221 offset:17472
    v_mfma_f32_16x16x32_bf16 a[16:19], v[164:167], a[244:247], a[16:19]
    buffer_load_dwordx4 v222, s[4:7], s23 offen offset:3072 nt lds
    v_mfma_f32_16x16x32_bf16 a[28:31], v[164:167], a[248:251], a[28:31]
    s_add_u32 s23, s23, 28672
    ds_read_b64_tr_b16 a[216:217], v221 offset:16992
    v_add_f32 v202, v202, v194
    v_mfma_f32_16x16x32_bf16 a[28:31], v[152:155], a[252:255], a[28:31]
    ds_read_b64_tr_b16 a[218:219], v221 offset:17504
    v_cvt_pk_bf16_f32 v189, v194, v195
    v_mfma_f32_16x16x32_bf16 a[24:27], v[148:151], a[252:255], a[24:27]
    v_exp_f32 v198, v142
    v_mfma_f32_16x16x32_bf16 a[24:27], v[160:163], a[248:251], a[24:27]
    ds_read_b64_tr_b16 a[220:221], v221 offset:352
    v_mfma_f32_16x16x32_bf16 a[20:23], v[156:159], a[248:251], a[20:23]
    ds_read_b64_tr_b16 a[222:223], v221 offset:864
    v_add_f32 v202, v202, v195
    v_mfma_f32_16x16x32_bf16 a[20:23], v[144:147], a[252:255], a[20:23]
    v_exp_f32 v199, v143
    v_mfma_f32_16x16x32_bf16 a[32:35], v[144:147], a[192:195], a[32:35]
    ds_read_b64_tr_b16 a[224:225], v221 offset:384
    v_add_f32 v202, v202, v196
    v_mfma_f32_16x16x32_bf16 a[32:35], v[156:159], a[196:199], a[32:35]
    ds_read_b64_tr_b16 a[226:227], v221 offset:896
    v_cvt_pk_bf16_f32 v190, v196, v197
    v_mfma_f32_16x16x32_bf16 a[36:39], v[160:163], a[196:199], a[36:39]
    v_exp_f32 v192, v136
    v_mfma_f32_16x16x32_bf16 a[36:39], v[148:151], a[192:195], a[36:39]
    ds_read_b64_tr_b16 a[228:229], v221 offset:17024
    v_mfma_f32_16x16x32_bf16 a[40:43], v[152:155], a[192:195], a[40:43]
    ds_read_b64_tr_b16 a[230:231], v221 offset:17536
    v_add_f32 v202, v202, v197
    v_mfma_f32_16x16x32_bf16 a[40:43], v[164:167], a[196:199], a[40:43]
    s_waitcnt lgkmcnt(4)
    v_exp_f32 v193, v137
    v_mfma_f32_16x16x32_bf16 a[52:55], v[164:167], a[200:203], a[52:55]
    ds_read_b64_tr_b16 a[232:233], v221 offset:17056
    v_mfma_f32_16x16x32_bf16 a[52:55], v[152:155], a[204:207], a[52:55]
    ds_read_b64_tr_b16 a[234:235], v221 offset:17568
    v_mfma_f32_16x16x32_bf16 a[48:51], v[148:151], a[204:207], a[48:51]
    buffer_load_dword v253, v254, s[12:15], s59 offen
    v_mfma_f32_16x16x32_bf16 a[48:51], v[160:163], a[200:203], a[48:51]
    s_sub_u32 s59, s59, 16384
    ds_read_b64_tr_b16 a[236:237], v221 offset:416
    v_add_f32 v202, v202, v198
    v_mfma_f32_16x16x32_bf16 a[44:47], v[156:159], a[200:203], a[44:47]
    s_cselect_b32 s59, 0x40000000, s59
    ds_read_b64_tr_b16 a[238:239], v221 offset:928
    v_cvt_pk_bf16_f32 v191, v198, v199
    v_mfma_f32_16x16x32_bf16 a[44:47], v[144:147], a[204:207], a[44:47]
    v_exp_f32 v194, v138
    v_mfma_f32_16x16x32_bf16 a[56:59], v[144:147], a[208:211], a[56:59]
    ds_read_b64_tr_b16 a[240:241], v221 offset:448
    v_add_f32 v202, v202, v199
    v_mfma_f32_16x16x32_bf16 a[56:59], v[156:159], a[212:215], a[56:59]
    ds_read_b64_tr_b16 a[242:243], v221 offset:960
    v_mfma_f32_16x16x32_bf16 a[60:63], v[160:163], a[212:215], a[60:63]
    v_exp_f32 v195, v139
    v_mfma_f32_16x16x32_bf16 a[60:63], v[148:151], a[208:211], a[60:63]
    ds_read_b64_tr_b16 a[244:245], v221 offset:17088
    v_add_f32 v201, v201, v192
    v_mfma_f32_16x16x32_bf16 a[64:67], v[152:155], a[208:211], a[64:67]
    ds_read_b64_tr_b16 a[246:247], v221 offset:17600
    v_cvt_pk_bf16_f32 v186, v192, v193
    v_mfma_f32_16x16x32_bf16 a[64:67], v[164:167], a[212:215], a[64:67]
    v_exp_f32 v196, v132
    v_mfma_f32_16x16x32_bf16 a[76:79], v[164:167], a[216:219], a[76:79]
    ds_read_b64_tr_b16 a[248:249], v221 offset:17120
    v_mfma_f32_16x16x32_bf16 a[76:79], v[152:155], a[220:223], a[76:79]
    ds_read_b64_tr_b16 a[250:251], v221 offset:17632
    v_add_f32 v201, v201, v193
    v_mfma_f32_16x16x32_bf16 a[72:75], v[148:151], a[220:223], a[72:75]
    v_exp_f32 v197, v133
    v_mfma_f32_16x16x32_bf16 a[72:75], v[160:163], a[216:219], a[72:75]
    ds_read_b64_tr_b16 a[252:253], v221 offset:480
    v_add_f32 v201, v201, v194
    v_mfma_f32_16x16x32_bf16 a[68:71], v[156:159], a[216:219], a[68:71]
    ds_read_b64_tr_b16 a[254:255], v221 offset:992
    v_mfma_f32_16x16x32_bf16 a[68:71], v[144:147], a[220:223], a[68:71]
    s_waitcnt lgkmcnt(4)
    v_exp_f32 v198, v134
    v_mfma_f32_16x16x32_bf16 a[80:83], v[144:147], a[224:227], a[80:83]
    s_sub_u32 s28, s28, 1
    v_exp_f32 v199, v135
    v_mfma_f32_16x16x32_bf16 a[80:83], v[156:159], a[228:231], a[80:83]
    s_bitcmp1_b32 s57, s28
    v_cvt_pk_bf16_f32 v187, v194, v195
    v_mfma_f32_16x16x32_bf16 a[84:87], v[160:163], a[228:231], a[84:87]
    s_cselect_b32 s29, -1.0, s27
    v_add_f32 v201, v201, v195
    v_add_f32 v200, v200, v196
    v_mfma_f32_16x16x32_bf16 a[84:87], v[148:151], a[224:227], a[84:87]
    v_cvt_pk_bf16_f32 v182, v196, v197
    v_add_f32 v200, v200, v197
    v_mfma_f32_16x16x32_bf16 a[88:91], v[152:155], a[224:227], a[88:91]
    v_add_f32 v200, v200, v198
    v_mfma_f32_16x16x32_bf16 a[88:91], v[164:167], a[228:231], a[88:91]
    s_waitcnt vmcnt(16) lgkmcnt(0)
    v_mfma_f32_16x16x32_bf16 a[100:103], v[164:167], a[232:235], a[100:103]
    s_barrier
    v_mfma_f32_16x16x32_bf16 a[100:103], v[152:155], a[236:239], a[100:103]
    ds_read_b128 a[192:195], v220 offset:0
    v_cvt_pk_bf16_f32 v183, v198, v199
    v_mfma_f32_16x16x32_bf16 a[96:99], v[148:151], a[236:239], a[96:99]
    v_add_f32 v200, v200, v199
    v_max3_f32 v206, v200, v201, v202
    v_mfma_f32_16x16x32_bf16 a[96:99], v[160:163], a[232:235], a[96:99]
    ds_read_b128 a[196:199], v220 offset:64
    v_cmp_nge_f32 vcc, s29, v206
    v_mfma_f32_16x16x32_bf16 a[92:95], v[156:159], a[232:235], a[92:95]
    v_mfma_f32_16x16x32_bf16 a[92:95], v[144:147], a[236:239], a[92:95]
    s_add_u32 m0, s22, 0
    ds_read_b128 a[200:203], v220 offset:128
    v_mfma_f32_16x16x32_bf16 a[104:107], v[144:147], a[240:243], a[104:107]
    buffer_load_dwordx4 v223, s[8:11], s24 offen offset:0 nt lds
    v_mfma_f32_16x16x32_bf16 a[104:107], v[156:159], a[244:247], a[104:107]
    ds_read_b128 a[204:207], v220 offset:192
    v_mfma_f32_16x16x32_bf16 a[108:111], v[160:163], a[244:247], a[108:111]
    v_mfma_f32_16x16x32_bf16 a[108:111], v[148:151], a[240:243], a[108:111]
    ds_read_b128 a[208:211], v220 offset:256
    v_mfma_f32_16x16x32_bf16 a[112:115], v[152:155], a[240:243], a[112:115]
    v_mfma_f32_16x16x32_bf16 a[112:115], v[164:167], a[244:247], a[112:115]
    s_add_u32 m0, s22, 7808
    ds_read_b128 a[212:215], v220 offset:320
    v_mfma_f32_16x16x32_bf16 a[124:127], v[164:167], a[248:251], a[124:127]
    buffer_load_dwordx4 v223, s[8:11], s24 offen offset:512 nt lds
    v_mfma_f32_16x16x32_bf16 a[124:127], v[152:155], a[252:255], a[124:127]
    ds_read_b128 a[216:219], v220 offset:384
    v_mfma_f32_16x16x32_bf16 a[120:123], v[148:151], a[252:255], a[120:123]
    v_mfma_f32_16x16x32_bf16 a[120:123], v[160:163], a[248:251], a[120:123]
    ds_read_b128 a[220:223], v220 offset:448
    v_mfma_f32_16x16x32_bf16 a[116:119], v[156:159], a[248:251], a[116:119]
    s_waitcnt lgkmcnt(3)
    v_mfma_f32_16x16x32_bf16 a[116:119], v[144:147], a[252:255], a[116:119]
    s_cbranch_vccnz L_tr0
L_ret0:
    v_mfma_f32_16x16x32_bf16 v[96:99], a[192:195], a[128:131], v[208:211]
    v_mfma_f32_16x16x32_bf16 v[96:99], a[196:199], a[132:135], v[96:99]
    v_mfma_f32_16x16x32_bf16 v[96:99], a[200:203], a[136:139], v[96:99]
    s_add_u32 m0, s22, 32
    ds_read_b128 a[224:227], v220 offset:1488
    v_mfma_f32_16x16x32_bf16 v[96:99], a[204:207], a[140:143], v[96:99]
    buffer_load_dwordx4 v223, s[8:11], s24 offen offset:2048 nt lds
    v_mfma_f32_16x16x32_bf16 v[96:99], a[208:211], a[144:147], v[96:99]
    s_waitcnt lgkmcnt(1)
    ds_read_b128 a[228:231], v220 offset:1424
    v_mfma_f32_16x16x32_bf16 v[96:99], a[212:215], a[148:151], v[96:99]
    v_mfma_f32_16x16x32_bf16 v[96:99], a[216:219], a[152:155], v[96:99]
    ds_read_b128 a[232:235], v220 offset:1360
    v_mfma_f32_16x16x32_bf16 v[96:99], a[220:223], a[156:159], v[96:99]
    v_mfma_f32_16x16x32_bf16 v[100:103], a[220:223], a[188:191], v[212:215]
    ds_read_b128 a[236:239], v220 offset:1296
    v_mfma_f32_16x16x32_bf16 v[100:103], a[216:219], a[184:187], v[100:103]
    v_mfma_f32_16x16x32_bf16 v[100:103], a[212:215], a[180:183], v[100:103]
    s_add_u32 m0, s22, 7840
    ds_read_b128 a[240:243], v220 offset:1232
    v_mfma_f32_16x16x32_bf16 v[100:103], a[208:211], a[176:179], v[100:103]
    buffer_load_dwordx4 v223, s[8:11], s24 offen offset:2560 nt lds
    v_mfma_f32_16x16x32_bf16 v[100:103], a[204:207], a[172:175], v[100:103]
    s_add_u32 s24, s24, 4096
    ds_read_b128 a[244:247], v220 offset:1168
    v_mfma_f32_16x16x32_bf16 v[100:103], a[200:203], a[168:171], v[100:103]
    v_exp_f32 v192, v96
    v_mfma_f32_16x16x32_bf16 v[100:103], a[196:199], a[164:167], v[100:103]
    ds_read_b128 a[248:251], v220 offset:1104
    v_add_f32 v203, v200, v192
    v_mfma_f32_16x16x32_bf16 v[100:103], a[192:195], a[160:163], v[100:103]
    v_exp_f32 v193, v97
    v_mfma_f32_16x16x32_bf16 v[104:107], a[192:195], v[64:67], v[216:219]
    ds_read_b128 a[252:255], v220 offset:1040
    v_cvt_pk_bf16_f32 v144, v192, v193
    v_mfma_f32_16x16x32_bf16 v[104:107], a[196:199], v[68:71], v[104:107]
    v_exp_f32 v194, v98
    v_mfma_f32_16x16x32_bf16 v[104:107], a[200:203], v[72:75], v[104:107]
    s_add_u32 m0, s22, 4160
    v_add_f32 v203, v203, v193
    v_mfma_f32_16x16x32_bf16 v[104:107], a[204:207], v[76:79], v[104:107]
    buffer_load_dwordx4 v223, s[8:11], s24 offen offset:0 nt lds
    v_mfma_f32_16x16x32_bf16 v[104:107], a[208:211], v[80:83], v[104:107]
    v_exp_f32 v195, v99
    v_mfma_f32_16x16x32_bf16 v[104:107], a[212:215], v[84:87], v[104:107]
    v_exp_f32 v196, v100
    v_mfma_f32_16x16x32_bf16 v[104:107], a[216:219], v[88:91], v[104:107]
    v_exp_f32 v197, v101
    v_mfma_f32_16x16x32_bf16 v[104:107], a[220:223], v[92:95], v[104:107]
    s_waitcnt lgkmcnt(0)
    v_exp_f32 v198, v102
    v_mfma_f32_16x16x32_bf16 v[116:119], a[224:227], v[92:95], v[216:219]
    v_exp_f32 v199, v103
    v_mfma_f32_16x16x32_bf16 v[116:119], a[228:231], v[88:91], v[116:119]
    v_add_f32 v203, v203, v194
    v_cvt_pk_bf16_f32 v145, v194, v195
    v_mfma_f32_16x16x32_bf16 v[116:119], a[232:235], v[84:87], v[116:119]
    s_add_u32 m0, s22, 11968
    ds_read_b128 a[192:195], v220 offset:16640
    v_mfma_f32_16x16x32_bf16 v[116:119], a[236:239], v[80:83], v[116:119]
    buffer_load_dwordx4 v223, s[8:11], s24 offen offset:512 nt lds
    v_mfma_f32_16x16x32_bf16 v[116:119], a[240:243], v[76:79], v[116:119]
    ds_read_b128 a[196:199], v220 offset:16704
    v_add_f32 v203, v203, v195
    v_mfma_f32_16x16x32_bf16 v[116:119], a[244:247], v[72:75], v[116:119]
    v_exp_f32 v192, v104
    v_mfma_f32_16x16x32_bf16 v[116:119], a[248:251], v[68:71], v[116:119]
    ds_read_b128 a[200:203], v220 offset:16768
    v_mfma_f32_16x16x32_bf16 v[116:119], a[252:255], v[64:67], v[116:119]
    v_exp_f32 v193, v105
    v_mfma_f32_16x16x32_bf16 v[112:115], a[252:255], a[160:163], v[212:215]
    ds_read_b128 a[204:207], v220 offset:16832
    v_add_f32 v204, v201, v196
    v_mfma_f32_16x16x32_bf16 v[112:115], a[248:251], a[164:167], v[112:115]
    v_exp_f32 v194, v106
    v_mfma_f32_16x16x32_bf16 v[112:115], a[244:247], a[168:171], v[112:115]
    s_add_u32 m0, s22, 4192
    ds_read_b128 a[208:211], v220 offset:16896
    v_mfma_f32_16x16x32_bf16 v[112:115], a[240:243], a[172:175], v[112:115]
    buffer_load_dwordx4 v223, s[8:11], s24 offen offset:2048 nt lds
    v_mfma_f32_16x16x32_bf16 v[112:115], a[236:239], a[176:179], v[112:115]
    ds_read_b128 a[212:215], v220 offset:16960
    v_mfma_f32_16x16x32_bf16 v[112:115], a[232:235], a[180:183], v[112:115]
    v_exp_f32 v195, v107
    v_mfma_f32_16x16x32_bf16 v[112:115], a[228:231], a[184:187], v[112:115]
    ds_read_b128 a[216:219], v220 offset:17024
    v_cvt_pk_bf16_f32 v148, v196, v197
    v_mfma_f32_16x16x32_bf16 v[112:115], a[224:227], a[188:191], v[112:115]
    v_exp_f32 v196, v116
    v_mfma_f32_16x16x32_bf16 v[108:111], a[224:227], a[156:159], v[208:211]
    ds_read_b128 a[220:223], v220 offset:17088
    v_mfma_f32_16x16x32_bf16 v[108:111], a[228:231], a[152:155], v[108:111]
    v_add_f32 v204, v204, v197
    v_add_f32 v204, v204, v198
    v_mfma_f32_16x16x32_bf16 v[108:111], a[232:235], a[148:151], v[108:111]
    s_add_u32 m0, s22, 12000
    v_cvt_pk_bf16_f32 v149, v198, v199
    v_mfma_f32_16x16x32_bf16 v[108:111], a[236:239], a[144:147], v[108:111]
    buffer_load_dwordx4 v223, s[8:11], s24 offen offset:2560 nt lds
    v_mfma_f32_16x16x32_bf16 v[108:111], a[240:243], a[140:143], v[108:111]
    s_add_u32 s24, s24, 28672
    v_exp_f32 v197, v117
    v_mfma_f32_16x16x32_bf16 v[108:111], a[244:247], a[136:139], v[108:111]
    v_exp_f32 v198, v118
    v_mfma_f32_16x16x32_bf16 v[108:111], a[248:251], a[132:135], v[108:111]
    ds_read_b128 a[224:227], v220 offset:18128
    v_mfma_f32_16x16x32_bf16 v[108:111], a[252:255], a[128:131], v[108:111]
    s_waitcnt lgkmcnt(1)
    v_add_f32 v204, v204, v199
    v_add_f32 v205, v202, v192
    v_mfma_f32_16x16x32_bf16 v[120:123], a[192:195], a[128:131], v[208:211]
    ds_read_b128 a[228:231], v220 offset:18064
    v_mfma_f32_16x16x32_bf16 v[120:123], a[196:199], a[132:135], v[120:123]
    v_exp_f32 v199, v119
    v_mfma_f32_16x16x32_bf16 v[120:123], a[200:203], a[136:139], v[120:123]
    ds_read_b128 a[232:235], v220 offset:18000
    v_cvt_pk_bf16_f32 v152, v192, v193
    v_mfma_f32_16x16x32_bf16 v[120:123], a[204:207], a[140:143], v[120:123]
    v_exp_f32 v192, v112
    v_mfma_f32_16x16x32_bf16 v[120:123], a[208:211], a[144:147], v[120:123]
    ds_read_b128 a[236:239], v220 offset:17936
    v_add_f32 v205, v205, v193
    v_mfma_f32_16x16x32_bf16 v[120:123], a[212:215], a[148:151], v[120:123]
    v_exp_f32 v193, v113
    v_mfma_f32_16x16x32_bf16 v[120:123], a[216:219], a[152:155], v[120:123]
    ds_read_b128 a[240:243], v220 offset:17872
    v_mfma_f32_16x16x32_bf16 v[120:123], a[220:223], a[156:159], v[120:123]
    v_add_f32 v205, v205, v194
    v_cvt_pk_bf16_f32 v153, v194, v195
    v_mfma_f32_16x16x32_bf16 v[124:127], a[220:223], a[188:191], v[212:215]
    ds_read_b128 a[244:247], v220 offset:17808
    v_add_f32 v205, v205, v195
    v_mfma_f32_16x16x32_bf16 v[124:127], a[216:219], a[184:187], v[124:127]
    v_exp_f32 v194, v114
    v_mfma_f32_16x16x32_bf16 v[124:127], a[212:215], a[180:183], v[124:127]
    ds_read_b128 a[248:251], v220 offset:17744
    v_mfma_f32_16x16x32_bf16 v[124:127], a[208:211], a[176:179], v[124:127]
    v_exp_f32 v195, v115
    v_mfma_f32_16x16x32_bf16 v[124:127], a[204:207], a[172:175], v[124:127]
    ds_read_b128 a[252:255], v220 offset:17680
    v_add_f32 v205, v205, v196
    v_mfma_f32_16x16x32_bf16 v[124:127], a[200:203], a[168:171], v[124:127]
    v_cvt_pk_bf16_f32 v154, v196, v197
    v_mfma_f32_16x16x32_bf16 v[124:127], a[196:199], a[164:167], v[124:127]
    v_exp_f32 v196, v108
    v_mfma_f32_16x16x32_bf16 v[124:127], a[192:195], a[160:163], v[124:127]
    v_add_f32 v205, v205, v197
    v_add_f32 v205, v205, v198
    v_mfma_f32_16x16x32_bf16 v[128:131], a[192:195], v[64:67], v[216:219]
    v_exp_f32 v197, v109
    v_mfma_f32_16x16x32_bf16 v[128:131], a[196:199], v[68:71], v[128:131]
    v_cvt_pk_bf16_f32 v155, v198, v199
    v_mfma_f32_16x16x32_bf16 v[128:131], a[200:203], v[72:75], v[128:131]
    v_exp_f32 v198, v110
    v_mfma_f32_16x16x32_bf16 v[128:131], a[204:207], v[76:79], v[128:131]
    s_waitcnt vmcnt(16) lgkmcnt(0)
    v_mfma_f32_16x16x32_bf16 v[128:131], a[208:211], v[80:83], v[128:131]
    s_barrier
    v_mfma_f32_16x16x32_bf16 v[128:131], a[212:215], v[84:87], v[128:131]
    v_add_f32 v205, v205, v199
    v_mfma_f32_16x16x32_bf16 v[128:131], a[216:219], v[88:91], v[128:131]
    v_exp_f32 v199, v111
    v_mfma_f32_16x16x32_bf16 v[128:131], a[220:223], v[92:95], v[128:131]
    v_add_f32 v204, v204, v192
    v_cvt_pk_bf16_f32 v150, v192, v193
    v_mfma_f32_16x16x32_bf16 v[140:143], a[224:227], v[92:95], v[216:219]
    ds_read_b64_tr_b16 a[192:193], v221 offset:33280
    v_mfma_f32_16x16x32_bf16 v[140:143], a[228:231], v[88:91], v[140:143]
    s_add_u32 m0, s21, 0
    ds_read_b64_tr_b16 a[194:195], v221 offset:33792
    v_mfma_f32_16x16x32_bf16 v[140:143], a[232:235], v[84:87], v[140:143]
    buffer_load_dwordx4 v222, s[4:7], s23 offen offset:0 nt lds
    v_mfma_f32_16x16x32_bf16 v[140:143], a[236:239], v[80:83], v[140:143]
    ds_read_b64_tr_b16 a[196:197], v221 offset:49920
    v_add_f32 v204, v204, v193
    v_mfma_f32_16x16x32_bf16 v[140:143], a[240:243], v[76:79], v[140:143]
    ds_read_b64_tr_b16 a[198:199], v221 offset:50432
    v_add_f32 v204, v204, v194
    v_mfma_f32_16x16x32_bf16 v[140:143], a[244:247], v[72:75], v[140:143]
    v_exp_f32 v192, v120
    v_mfma_f32_16x16x32_bf16 v[140:143], a[248:251], v[68:71], v[140:143]
    ds_read_b64_tr_b16 a[200:201], v221 offset:49952
    v_cvt_pk_bf16_f32 v151, v194, v195
    v_mfma_f32_16x16x32_bf16 v[140:143], a[252:255], v[64:67], v[140:143]
    ds_read_b64_tr_b16 a[202:203], v221 offset:50464
    v_mfma_f32_16x16x32_bf16 v[136:139], a[252:255], a[160:163], v[212:215]
    v_exp_f32 v193, v121
    v_mfma_f32_16x16x32_bf16 v[136:139], a[248:251], a[164:167], v[136:139]
    ds_read_b64_tr_b16 a[204:205], v221 offset:33312
    v_add_f32 v204, v204, v195
    v_mfma_f32_16x16x32_bf16 v[136:139], a[244:247], a[168:171], v[136:139]
    s_add_u32 m0, s21, 16
    ds_read_b64_tr_b16 a[206:207], v221 offset:33824
    v_mfma_f32_16x16x32_bf16 v[136:139], a[240:243], a[172:175], v[136:139]
    buffer_load_dwordx4 v222, s[4:7], s23 offen offset:1024 nt lds
    v_mfma_f32_16x16x32_bf16 v[136:139], a[236:239], a[176:179], v[136:139]
    ds_read_b64_tr_b16 a[208:209], v221 offset:33344
    v_add_f32 v203, v203, v196
    v_mfma_f32_16x16x32_bf16 v[136:139], a[232:235], a[180:183], v[136:139]
    ds_read_b64_tr_b16 a[210:211], v221 offset:33856
    v_cvt_pk_bf16_f32 v146, v196, v197
    v_mfma_f32_16x16x32_bf16 v[136:139], a[228:231], a[184:187], v[136:139]
    v_exp_f32 v194, v122
    v_mfma_f32_16x16x32_bf16 v[136:139], a[224:227], a[188:191], v[136:139]
    ds_read_b64_tr_b16 a[212:213], v221 offset:49984
    v_mfma_f32_16x16x32_bf16 v[132:135], a[224:227], a[156:159], v[208:211]
    ds_read_b64_tr_b16 a[214:215], v221 offset:50496
    v_add_f32 v203, v203, v197
    v_mfma_f32_16x16x32_bf16 v[132:135], a[228:231], a[152:155], v[132:135]
    v_exp_f32 v195, v123
    v_mfma_f32_16x16x32_bf16 v[132:135], a[232:235], a[148:151], v[132:135]
    ds_read_b64_tr_b16 a[216:217], v221 offset:50016
    v_mfma_f32_16x16x32_bf16 v[132:135], a[236:239], a[144:147], v[132:135]
    s_add_u32 m0, s21, 32
    ds_read_b64_tr_b16 a[218:219], v221 offset:50528
    v_mfma_f32_16x16x32_bf16 v[132:135], a[240:243], a[140:143], v[132:135]
    buffer_load_dwordx4 v222, s[4:7], s23 offen offset:2048 nt lds
    v_mfma_f32_16x16x32_bf16 v[132:135], a[244:247], a[136:139], v[132:135]
    ds_read_b64_tr_b16 a[220:221], v221 offset:33376
    v_add_f32 v203, v203, v198
    v_mfma_f32_16x16x32_bf16 v[132:135], a[248:251], a[132:135], v[132:135]
    ds_read_b64_tr_b16 a[222:223], v221 offset:33888
    v_cvt_pk_bf16_f32 v147, v198, v199
    v_mfma_f32_16x16x32_bf16 v[132:135], a[252:255], a[128:131], v[132:135]
    s_waitcnt lgkmcnt(4)
    v_exp_f32 v196, v124
    v_mfma_f32_16x16x32_bf16 v[0:3], v[168:171], a[192:195], v[0:3]
    ds_read_b64_tr_b16 a[224:225], v221 offset:33408
    v_add_f32 v203, v203, v199
    v_mfma_f32_16x16x32_bf16 v[0:3], v[180:183], a[196:199], v[0:3]
    ds_read_b64_tr_b16 a[226:227], v221 offset:33920
    v_add_f32 v203, v203, v192
    v_mfma_f32_16x16x32_bf16 v[4:7], v[184:187], a[196:199], v[4:7]
    v_exp_f32 v197, v125
    v_mfma_f32_16x16x32_bf16 v[4:7], v[172:175], a[192:195], v[4:7]
    ds_read_b64_tr_b16 a[228:229], v221 offset:50048
    v_mfma_f32_16x16x32_bf16 v[8:11], v[176:179], a[192:195], v[8:11]
    s_add_u32 m0, s21, 48
    ds_read_b64_tr_b16 a[230:231], v221 offset:50560
    v_mfma_f32_16x16x32_bf16 v[8:11], v[188:191], a[196:199], v[8:11]
    buffer_load_dwordx4 v222, s[4:7], s23 offen offset:3072 nt lds
    v_mfma_f32_16x16x32_bf16 v[20:23], v[188:191], a[200:203], v[20:23]
    s_add_u32 s23, s23, 4096
    ds_read_b64_tr_b16 a[232:233], v221 offset:50080
    v_cvt_pk_bf16_f32 v156, v192, v193
    v_mfma_f32_16x16x32_bf16 v[20:23], v[176:179], a[204:207], v[20:23]
    ds_read_b64_tr_b16 a[234:235], v221 offset:50592
    v_add_f32 v203, v203, v193
    v_mfma_f32_16x16x32_bf16 v[16:19], v[172:175], a[204:207], v[16:19]
    v_exp_f32 v198, v126
    v_mfma_f32_16x16x32_bf16 v[16:19], v[184:187], a[200:203], v[16:19]
    ds_read_b64_tr_b16 a[236:237], v221 offset:33440
    v_mfma_f32_16x16x32_bf16 v[12:15], v[180:183], a[200:203], v[12:15]
    ds_read_b64_tr_b16 a[238:239], v221 offset:33952
    v_add_f32 v203, v203, v194
    v_mfma_f32_16x16x32_bf16 v[12:15], v[168:171], a[204:207], v[12:15]
    v_exp_f32 v199, v127
    v_mfma_f32_16x16x32_bf16 v[24:27], v[168:171], a[208:211], v[24:27]
    ds_read_b64_tr_b16 a[240:241], v221 offset:33472
    v_cvt_pk_bf16_f32 v157, v194, v195
    v_mfma_f32_16x16x32_bf16 v[24:27], v[180:183], a[212:215], v[24:27]
    s_add_u32 m0, s21, 4160
    ds_read_b64_tr_b16 a[242:243], v221 offset:33984
    v_mfma_f32_16x16x32_bf16 v[28:31], v[184:187], a[212:215], v[28:31]
    buffer_load_dwordx4 v222, s[4:7], s23 offen offset:0 nt lds
    v_mfma_f32_16x16x32_bf16 v[28:31], v[172:175], a[208:211], v[28:31]
    ds_read_b64_tr_b16 a[244:245], v221 offset:50112
    v_mfma_f32_16x16x32_bf16 v[32:35], v[176:179], a[208:211], v[32:35]
    ds_read_b64_tr_b16 a[246:247], v221 offset:50624
    v_add_f32 v203, v203, v195
    v_mfma_f32_16x16x32_bf16 v[32:35], v[188:191], a[212:215], v[32:35]
    s_waitcnt lgkmcnt(4)
    v_exp_f32 v192, v128
    v_mfma_f32_16x16x32_bf16 v[44:47], v[188:191], a[216:219], v[44:47]
    ds_read_b64_tr_b16 a[248:249], v221 offset:50144
    v_add_f32 v204, v204, v196
    v_mfma_f32_16x16x32_bf16 v[44:47], v[176:179], a[220:223], v[44:47]
    ds_read_b64_tr_b16 a[250:251], v221 offset:50656
    v_cvt_pk_bf16_f32 v160, v196, v197
    v_mfma_f32_16x16x32_bf16 v[40:43], v[172:175], a[220:223], v[40:43]
    v_exp_f32 v193, v129
    v_mfma_f32_16x16x32_bf16 v[40:43], v[184:187], a[216:219], v[40:43]
    ds_read_b64_tr_b16 a[252:253], v221 offset:33504
    v_mfma_f32_16x16x32_bf16 v[36:39], v[180:183], a[216:219], v[36:39]
    s_add_u32 m0, s21, 4176
    ds_read_b64_tr_b16 a[254:255], v221 offset:34016
    v_mfma_f32_16x16x32_bf16 v[36:39], v[168:171], a[220:223], v[36:39]
    buffer_load_dwordx4 v222, s[4:7], s23 offen offset:1024 nt lds
    v_mfma_f32_16x16x32_bf16 v[48:51], v[168:171], a[224:227], v[48:51]
    ds_read_b64_tr_b16 a[192:193], v221 offset:33536
    v_add_f32 v204, v204, v197
    v_mfma_f32_16x16x32_bf16 v[48:51], v[180:183], a[228:231], v[48:51]
    ds_read_b64_tr_b16 a[194:195], v221 offset:34048
    v_add_f32 v204, v204, v198
    v_mfma_f32_16x16x32_bf16 v[52:55], v[184:187], a[228:231], v[52:55]
    v_exp_f32 v194, v130
    v_mfma_f32_16x16x32_bf16 v[52:55], v[172:175], a[224:227], v[52:55]
    ds_read_b64_tr_b16 a[196:197], v221 offset:50176
    v_mfma_f32_16x16x32_bf16 v[56:59], v[176:179], a[224:227], v[56:59]
    ds_read_b64_tr_b16 a[198:199], v221 offset:50688
    v_cvt_pk_bf16_f32 v161, v198, v199
    v_mfma_f32_16x16x32_bf16 v[56:59], v[188:191], a[228:231], v[56:59]
    v_exp_f32 v195, v131
    v_mfma_f32_16x16x32_bf16 a[4:7], v[188:191], a[232:235], a[4:7]
    ds_read_b64_tr_b16 a[200:201], v221 offset:50208
    v_add_f32 v204, v204, v199
    v_mfma_f32_16x16x32_bf16 a[4:7], v[176:179], a[236:239], a[4:7]
    s_add_u32 m0, s21, 4192
    ds_read_b64_tr_b16 a[202:203], v221 offset:50720
    v_mfma_f32_16x16x32_bf16 a[0:3], v[172:175], a[236:239], a[0:3]
    buffer_load_dwordx4 v222, s[4:7], s23 offen offset:2048 nt lds
    v_mfma_f32_16x16x32_bf16 a[0:3], v[184:187], a[232:235], a[0:3]
    ds_read_b64_tr_b16 a[204:205], v221 offset:33568
    v_mfma_f32_16x16x32_bf16 v[60:63], v[180:183], a[232:235], v[60:63]
    ds_read_b64_tr_b16 a[206:207], v221 offset:34080
    v_add_f32 v205, v205, v192
    v_mfma_f32_16x16x32_bf16 v[60:63], v[168:171], a[236:239], v[60:63]
    s_waitcnt lgkmcnt(4)
    v_exp_f32 v196, v140
    v_mfma_f32_16x16x32_bf16 a[8:11], v[168:171], a[240:243], a[8:11]
    ds_read_b64_tr_b16 a[208:209], v221 offset:33600
    v_cvt_pk_bf16_f32 v164, v192, v193
    v_mfma_f32_16x16x32_bf16 a[8:11], v[180:183], a[244:247], a[8:11]
    ds_read_b64_tr_b16 a[210:211], v221 offset:34112
    v_add_f32 v205, v205, v193
    v_mfma_f32_16x16x32_bf16 a[12:15], v[184:187], a[244:247], a[12:15]
    v_exp_f32 v197, v141
    v_mfma_f32_16x16x32_bf16 a[12:15], v[172:175], a[240:243], a[12:15]
    ds_read_b64_tr_b16 a[212:213], v221 offset:50240
    v_mfma_f32_16x16x32_bf16 a[16:19], v[176:179], a[240:243], a[16:19]
    s_add_u32 m0, s21, 4208
    ds_read_b64_tr_b16 a[214:215], v221 offset:50752
    v_mfma_f32_16x16x32_bf16 a[16:19], v[188:191], a[244:247], a[16:19]
    buffer_load_dwordx4 v222, s[4:7], s23 offen offset:3072 nt lds
    v_mfma_f32_16x16x32_bf16 a[28:31], v[188:191], a[248:251], a[28:31]
    s_add_u32 s23, s23, 28672
    ds_read_b64_tr_b16 a[216:217], v221 offset:50272
    v_add_f32 v205, v205, v194
    v_mfma_f32_16x16x32_bf16 a[28:31], v[176:179], a[252:255], a[28:31]
    ds_read_b64_tr_b16 a[218:219], v221 offset:50784
    v_cvt_pk_bf16_f32 v165, v194, v195
    v_mfma_f32_16x16x32_bf16 a[24:27], v[172:175], a[252:255], a[24:27]
    v_exp_f32 v198, v142
    v_mfma_f32_16x16x32_bf16 a[24:27], v[184:187], a[248:251], a[24:27]
    ds_read_b64_tr_b16 a[220:221], v221 offset:33632
    v_mfma_f32_16x16x32_bf16 a[20:23], v[180:183], a[248:251], a[20:23]
    ds_read_b64_tr_b16 a[222:223], v221 offset:34144
    v_add_f32 v205, v205, v195
    v_mfma_f32_16x16x32_bf16 a[20:23], v[168:171], a[252:255], a[20:23]
    v_exp_f32 v199, v143
    v_mfma_f32_16x16x32_bf16 a[32:35], v[168:171], a[192:195], a[32:35]
    ds_read_b64_tr_b16 a[224:225], v221 offset:33664
    v_add_f32 v205, v205, v196
    v_mfma_f32_16x16x32_bf16 a[32:35], v[180:183], a[196:199], a[32:35]
    ds_read_b64_tr_b16 a[226:227], v221 offset:34176
    v_cvt_pk_bf16_f32 v166, v196, v197
    v_mfma_f32_16x16x32_bf16 a[36:39], v[184:187], a[196:199], a[36:39]
    v_exp_f32 v192, v136
    v_mfma_f32_16x16x32_bf16 a[36:39], v[172:175], a[192:195], a[36:39]
    ds_read_b64_tr_b16 a[228:229], v221 offset:50304
    v_mfma_f32_16x16x32_bf16 a[40:43], v[176:179], a[192:195], a[40:43]
    ds_read_b64_tr_b16 a[230:231], v221 offset:50816
    v_add_f32 v205, v205, v197
    v_mfma_f32_16x16x32_bf16 a[40:43], v[188:191], a[196:199], a[40:43]
    s_waitcnt lgkmcnt(4)
    v_exp_f32 v193, v137
    v_mfma_f32_16x16x32_bf16 a[52:55], v[188:191], a[200:203], a[52:55]
    ds_read_b64_tr_b16 a[232:233], v221 offset:50336
    v_mfma_f32_16x16x32_bf16 a[52:55], v[176:179], a[204:207], a[52:55]
    ds_read_b64_tr_b16 a[234:235], v221 offset:50848
    v_mfma_f32_16x16x32_bf16 a[48:51], v[172:175], a[204:207], a[48:51]
    buffer_load_dword v253, v254, s[44:47], s51 offen
    v_mfma_f32_16x16x32_bf16 a[48:51], v[184:187], a[200:203], a[48:51]
    s_sub_u32 s51, s51, 16384
    ds_read_b64_tr_b16 a[236:237], v221 offset:33696
    v_add_f32 v205, v205, v198
    v_mfma_f32_16x16x32_bf16 a[44:47], v[180:183], a[200:203], a[44:47]
    s_cselect_b32 s51, 0x40000000, s51
    ds_read_b64_tr_b16 a[238:239], v221 offset:34208
    v_cvt_pk_bf16_f32 v167, v198, v199
    v_mfma_f32_16x16x32_bf16 a[44:47], v[168:171], a[204:207], a[44:47]
    v_exp_f32 v194, v138
    v_mfma_f32_16x16x32_bf16 a[56:59], v[168:171], a[208:211], a[56:59]
    ds_read_b64_tr_b16 a[240:241], v221 offset:33728
    v_add_f32 v205, v205, v199
    v_mfma_f32_16x16x32_bf16 a[56:59], v[180:183], a[212:215], a[56:59]
    ds_read_b64_tr_b16 a[242:243], v221 offset:34240
    v_mfma_f32_16x16x32_bf16 a[60:63], v[184:187], a[212:215], a[60:63]
    v_exp_f32 v195, v139
    v_mfma_f32_16x16x32_bf16 a[60:63], v[172:175], a[208:211], a[60:63]
    ds_read_b64_tr_b16 a[244:245], v221 offset:50368
    v_add_f32 v204, v204, v192
    v_mfma_f32_16x16x32_bf16 a[64:67], v[176:179], a[208:211], a[64:67]
    ds_read_b64_tr_b16 a[246:247], v221 offset:50880
    v_cvt_pk_bf16_f32 v162, v192, v193
    v_mfma_f32_16x16x32_bf16 a[64:67], v[188:191], a[212:215], a[64:67]
    v_exp_f32 v196, v132
    v_mfma_f32_16x16x32_bf16 a[76:79], v[188:191], a[216:219], a[76:79]
    ds_read_b64_tr_b16 a[248:249], v221 offset:50400
    v_mfma_f32_16x16x32_bf16 a[76:79], v[176:179], a[220:223], a[76:79]
    ds_read_b64_tr_b16 a[250:251], v221 offset:50912
    v_add_f32 v204, v204, v193
    v_mfma_f32_16x16x32_bf16 a[72:75], v[172:175], a[220:223], a[72:75]
    v_exp_f32 v197, v133
    v_mfma_f32_16x16x32_bf16 a[72:75], v[184:187], a[216:219], a[72:75]
    ds_read_b64_tr_b16 a[252:253], v221 offset:33760
    v_add_f32 v204, v204, v194
    v_mfma_f32_16x16x32_bf16 a[68:71], v[180:183], a[216:219], a[68:71]
    ds_read_b64_tr_b16 a[254:255], v221 offset:34272
    v_mfma_f32_16x16x32_bf16 a[68:71], v[168:171], a[220:223], a[68:71]
    s_waitcnt lgkmcnt(4)
    v_exp_f32 v198, v134
    v_mfma_f32_16x16x32_bf16 a[80:83], v[168:171], a[224:227], a[80:83]
    v_exp_f32 v199, v135
    v_mfma_f32_16x16x32_bf16 a[80:83], v[180:183], a[228:231], a[80:83]
    v_cvt_pk_bf16_f32 v163, v194, v195
    v_mfma_f32_16x16x32_bf16 a[84:87], v[184:187], a[228:231], a[84:87]
    v_add_f32 v204, v204, v195
    v_add_f32 v203, v203, v196
    v_mfma_f32_16x16x32_bf16 a[84:87], v[172:175], a[224:227], a[84:87]
    v_cvt_pk_bf16_f32 v158, v196, v197
    v_add_f32 v203, v203, v197
    v_mfma_f32_16x16x32_bf16 a[88:91], v[176:179], a[224:227], a[88:91]
    v_add_f32 v203, v203, v198
    v_mfma_f32_16x16x32_bf16 a[88:91], v[188:191], a[228:231], a[88:91]
    s_waitcnt vmcnt(16) lgkmcnt(0)
    v_mfma_f32_16x16x32_bf16 a[100:103], v[188:191], a[232:235], a[100:103]
    s_barrier
    v_mfma_f32_16x16x32_bf16 a[100:103], v[176:179], a[236:239], a[100:103]
    ds_read_b128 a[192:195], v220 offset:33280
    v_cvt_pk_bf16_f32 v159, v198, v199
    v_mfma_f32_16x16x32_bf16 a[96:99], v[172:175], a[236:239], a[96:99]
    v_add_f32 v203, v203, v199
    v_max3_f32 v206, v203, v204, v205
    v_mfma_f32_16x16x32_bf16 a[96:99], v[184:187], a[232:235], a[96:99]
    ds_read_b128 a[196:199], v220 offset:33344
    v_cmp_lt_f32 vcc, s27, v206
    v_mfma_f32_16x16x32_bf16 a[92:95], v[180:183], a[232:235], a[92:95]
    v_mfma_f32_16x16x32_bf16 a[92:95], v[168:171], a[236:239], a[92:95]
    s_add_u32 m0, s22, 33280
    ds_read_b128 a[200:203], v220 offset:33408
    v_mfma_f32_16x16x32_bf16 a[104:107], v[168:171], a[240:243], a[104:107]
    buffer_load_dwordx4 v223, s[8:11], s24 offen offset:0 nt lds
    v_mfma_f32_16x16x32_bf16 a[104:107], v[180:183], a[244:247], a[104:107]
    ds_read_b128 a[204:207], v220 offset:33472
    v_mfma_f32_16x16x32_bf16 a[108:111], v[184:187], a[244:247], a[108:111]
    v_mfma_f32_16x16x32_bf16 a[108:111], v[172:175], a[240:243], a[108:111]
    ds_read_b128 a[208:211], v220 offset:33536
    v_mfma_f32_16x16x32_bf16 a[112:115], v[176:179], a[240:243], a[112:115]
    v_mfma_f32_16x16x32_bf16 a[112:115], v[188:191], a[244:247], a[112:115]
    s_add_u32 m0, s22, 41088
    ds_read_b128 a[212:215], v220 offset:33600
    v_mfma_f32_16x16x32_bf16 a[124:127], v[188:191], a[248:251], a[124:127]
    buffer_load_dwordx4 v223, s[8:11], s24 offen offset:512 nt lds
    v_mfma_f32_16x16x32_bf16 a[124:127], v[176:179], a[252:255], a[124:127]
    ds_read_b128 a[216:219], v220 offset:33664
    v_mfma_f32_16x16x32_bf16 a[120:123], v[172:175], a[252:255], a[120:123]
    v_mfma_f32_16x16x32_bf16 a[120:123], v[184:187], a[248:251], a[120:123]
    ds_read_b128 a[220:223], v220 offset:33728
    v_mfma_f32_16x16x32_bf16 a[116:119], v[180:183], a[248:251], a[116:119]
    s_waitcnt lgkmcnt(3)
    v_mfma_f32_16x16x32_bf16 a[116:119], v[168:171], a[252:255], a[116:119]
    s_cbranch_vccz L_loop0
    s_call_b64 s[30:31], L_slow_1
    s_branch L_loop0
L_tr0:
    v_cmp_lt_f32 vcc, s27, v206
    s_nop 4
    s_cbranch_vccz L_nos0_0
    s_call_b64 s[30:31], L_slow_0
L_nos0_0:
    s_cmp_lg_u32 s28, 0
    s_cbranch_scc1 L_ret0
    s_branch L_final
.p2align 6
L_loop1:
    v_mfma_f32_16x16x32_bf16 v[96:99], a[192:195], a[128:131], v[208:211]
    v_mfma_f32_16x16x32_bf16 v[96:99], a[196:199], a[132:135], v[96:99]
    v_mfma_f32_16x16x32_bf16 v[96:99], a[200:203], a[136:139], v[96:99]
    ds_read_b128 a[224:227], v220 offset:34768
    v_mfma_f32_16x16x32_bf16 v[96:99], a[204:207], a[140:143], v[96:99]
    v_mfma_f32_16x16x32_bf16 v[96:99], a[208:211], a[144:147], v[96:99]
    s_waitcnt lgkmcnt(1)
    s_add_u32 m0, s22, 33312
    ds_read_b128 a[228:231], v220 offset:34704
    v_mfma_f32_16x16x32_bf16 v[96:99], a[212:215], a[148:151], v[96:99]
    buffer_load_dwordx4 v223, s[8:11], s24 offen offset:2048 nt lds
    v_mfma_f32_16x16x32_bf16 v[96:99], a[216:219], a[152:155], v[96:99]
    ds_read_b128 a[232:235], v220 offset:34640
    v_mfma_f32_16x16x32_bf16 v[96:99], a[220:223], a[156:159], v[96:99]
    v_mfma_f32_16x16x32_bf16 v[100:103], a[220:223], a[188:191], v[212:215]
    ds_read_b128 a[236:239], v220 offset:34576
    v_mfma_f32_16x16x32_bf16 v[100:103], a[216:219], a[184:187], v[100:103]
    v_mfma_f32_16x16x32_bf16 v[100:103], a[212:215], a[180:183], v[100:103]
    ds_read_b128 a[240:243], v220 offset:34512
    v_mfma_f32_16x16x32_bf16 v[100:103], a[208:211], a[176:179], v[100:103]
    v_mfma_f32_16x16x32_bf16 v[100:103], a[204:207], a[172:175], v[100:103]
    s_add_u32 m0, s22, 41120
    ds_read_b128 a[244:247], v220 offset:34448
    v_mfma_f32_16x16x32_bf16 v[100:103], a[200:203], a[168:171], v[100:103]
    buffer_load_dwordx4 v223, s[8:11], s24 offen offset:2560 nt lds
    v_mfma_f32_16x16x32_bf16 v[100:103], a[196:199], a[164:167], v[100:103]
    s_add_u32 s24, s24, 4096
    ds_read_b128 a[248:251], v220 offset:34384
    v_mfma_f32_16x16x32_bf16 v[100:103], a[192:195], a[160:163], v[100:103]
    v_exp_f32 v192, v96
    v_mfma_f32_16x16x32_bf16 v[104:107], a[192:195], v[64:67], v[216:219]
    ds_read_b128 a[252:255], v220 offset:34320
    v_add_f32 v200, v203, v192
    v_mfma_f32_16x16x32_bf16 v[104:107], a[196:199], v[68:71], v[104:107]
    v_exp_f32 v193, v97
    v_mfma_f32_16x16x32_bf16 v[104:107], a[200:203], v[72:75], v[104:107]
    v_exp_f32 v194, v98
    v_mfma_f32_16x16x32_bf16 v[104:107], a[204:207], v[76:79], v[104:107]
    v_exp_f32 v195, v99
    v_mfma_f32_16x16x32_bf16 v[104:107], a[208:211], v[80:83], v[104:107]
    s_add_u32 m0, s22, 37440
    v_cvt_pk_bf16_f32 v168, v192, v193
    v_mfma_f32_16x16x32_bf16 v[104:107], a[212:215], v[84:87], v[104:107]
    buffer_load_dwordx4 v223, s[8:11], s24 offen offset:0 nt lds
    v_mfma_f32_16x16x32_bf16 v[104:107], a[216:219], v[88:91], v[104:107]
    v_exp_f32 v196, v100
    v_mfma_f32_16x16x32_bf16 v[104:107], a[220:223], v[92:95], v[104:107]
    s_waitcnt lgkmcnt(0)
    v_exp_f32 v197, v101
    v_mfma_f32_16x16x32_bf16 v[116:119], a[224:227], v[92:95], v[216:219]
    v_exp_f32 v198, v102
    v_mfma_f32_16x16x32_bf16 v[116:119], a[228:231], v[88:91], v[116:119]
    v_exp_f32 v199, v103
    v_mfma_f32_16x16x32_bf16 v[116:119], a[232:235], v[84:87], v[116:119]
    ds_read_b128 a[192:195], v220 offset:49920
    v_add_f32 v200, v200, v193
    v_mfma_f32_16x16x32_bf16 v[116:119], a[236:239], v[80:83], v[116:119]
    v_add_f32 v200, v200, v194
    v_cvt_pk_bf16_f32 v169, v194, v195
    v_mfma_f32_16x16x32_bf16 v[116:119], a[240:243], v[76:79], v[116:119]
    s_add_u32 m0, s22, 45248
    ds_read_b128 a[196:199], v220 offset:49984
    v_mfma_f32_16x16x32_bf16 v[116:119], a[244:247], v[72:75], v[116:119]
    buffer_load_dwordx4 v223, s[8:11], s24 offen offset:512 nt lds
    v_mfma_f32_16x16x32_bf16 v[116:119], a[248:251], v[68:71], v[116:119]
    ds_read_b128 a[200:203], v220 offset:50048
    v_add_f32 v200, v200, v195
    v_mfma_f32_16x16x32_bf16 v[116:119], a[252:255], v[64:67], v[116:119]
    v_exp_f32 v192, v104
    v_mfma_f32_16x16x32_bf16 v[112:115], a[252:255], a[160:163], v[212:215]
    ds_read_b128 a[204:207], v220 offset:50112
    v_mfma_f32_16x16x32_bf16 v[112:115], a[248:251], a[164:167], v[112:115]
    v_exp_f32 v193, v105
    v_mfma_f32_16x16x32_bf16 v[112:115], a[244:247], a[168:171], v[112:115]
    ds_read_b128 a[208:211], v220 offset:50176
    v_add_f32 v201, v204, v196
    v_mfma_f32_16x16x32_bf16 v[112:115], a[240:243], a[172:175], v[112:115]
    v_exp_f32 v194, v106
    v_mfma_f32_16x16x32_bf16 v[112:115], a[236:239], a[176:179], v[112:115]
    s_add_u32 m0, s22, 37472
    ds_read_b128 a[212:215], v220 offset:50240
    v_mfma_f32_16x16x32_bf16 v[112:115], a[232:235], a[180:183], v[112:115]
    buffer_load_dwordx4 v223, s[8:11], s24 offen offset:2048 nt lds
    v_mfma_f32_16x16x32_bf16 v[112:115], a[228:231], a[184:187], v[112:115]
    ds_read_b128 a[216:219], v220 offset:50304
    v_mfma_f32_16x16x32_bf16 v[112:115], a[224:227], a[188:191], v[112:115]
    v_exp_f32 v195, v107
    v_mfma_f32_16x16x32_bf16 v[108:111], a[224:227], a[156:159], v[208:211]
    ds_read_b128 a[220:223], v220 offset:50368
    v_cvt_pk_bf16_f32 v172, v196, v197
    v_mfma_f32_16x16x32_bf16 v[108:111], a[228:231], a[152:155], v[108:111]
    v_exp_f32 v196, v116
    v_mfma_f32_16x16x32_bf16 v[108:111], a[232:235], a[148:151], v[108:111]
    v_add_f32 v201, v201, v197
    v_mfma_f32_16x16x32_bf16 v[108:111], a[236:239], a[144:147], v[108:111]
    v_exp_f32 v197, v117
    v_mfma_f32_16x16x32_bf16 v[108:111], a[240:243], a[140:143], v[108:111]
    s_add_u32 m0, s22, 45280
    v_add_f32 v201, v201, v198
    v_mfma_f32_16x16x32_bf16 v[108:111], a[244:247], a[136:139], v[108:111]
    buffer_load_dwordx4 v223, s[8:11], s24 offen offset:2560 nt lds
    v_mfma_f32_16x16x32_bf16 v[108:111], a[248:251], a[132:135], v[108:111]
    s_add_u32 s24, s24, 28672
    ds_read_b128 a[224:227], v220 offset:51408
    v_mfma_f32_16x16x32_bf16 v[108:111], a[252:255], a[128:131], v[108:111]
    s_waitcnt lgkmcnt(1)
    v_cvt_pk_bf16_f32 v173, v198, v199
    v_add_f32 v201, v201, v199
    v_mfma_f32_16x16x32_bf16 v[120:123], a[192:195], a[128:131], v[208:211]
    ds_read_b128 a[228:231], v220 offset:51344
    v_add_f32 v202, v205, v192
    v_mfma_f32_16x16x32_bf16 v[120:123], a[196:199], a[132:135], v[120:123]
    v_exp_f32 v198, v118
    v_mfma_f32_16x16x32_bf16 v[120:123], a[200:203], a[136:139], v[120:123]
    ds_read_b128 a[232:235], v220 offset:51280
    v_mfma_f32_16x16x32_bf16 v[120:123], a[204:207], a[140:143], v[120:123]
    v_exp_f32 v199, v119
    v_mfma_f32_16x16x32_bf16 v[120:123], a[208:211], a[144:147], v[120:123]
    ds_read_b128 a[236:239], v220 offset:51216
    v_cvt_pk_bf16_f32 v176, v192, v193
    v_mfma_f32_16x16x32_bf16 v[120:123], a[212:215], a[148:151], v[120:123]
    v_exp_f32 v192, v112
    v_mfma_f32_16x16x32_bf16 v[120:123], a[216:219], a[152:155], v[120:123]
    ds_read_b128 a[240:243], v220 offset:51152
    v_add_f32 v202, v202, v193
    v_mfma_f32_16x16x32_bf16 v[120:123], a[220:223], a[156:159], v[120:123]
    v_exp_f32 v193, v113
    v_mfma_f32_16x16x32_bf16 v[124:127], a[220:223], a[188:191], v[212:215]
    ds_read_b128 a[244:247], v220 offset:51088
    v_mfma_f32_16x16x32_bf16 v[124:127], a[216:219], a[184:187], v[124:127]
    v_add_f32 v202, v202, v194
    v_cvt_pk_bf16_f32 v177, v194, v195
    v_mfma_f32_16x16x32_bf16 v[124:127], a[212:215], a[180:183], v[124:127]
    ds_read_b128 a[248:251], v220 offset:51024
    v_add_f32 v202, v202, v195
    v_mfma_f32_16x16x32_bf16 v[124:127], a[208:211], a[176:179], v[124:127]
    v_exp_f32 v194, v114
    v_mfma_f32_16x16x32_bf16 v[124:127], a[204:207], a[172:175], v[124:127]
    ds_read_b128 a[252:255], v220 offset:50960
    v_mfma_f32_16x16x32_bf16 v[124:127], a[200:203], a[168:171], v[124:127]
    v_exp_f32 v195, v115
    v_mfma_f32_16x16x32_bf16 v[124:127], a[196:199], a[164:167], v[124:127]
    v_add_f32 v202, v202, v196
    v_mfma_f32_16x16x32_bf16 v[124:127], a[192:195], a[160:163], v[124:127]
    v_cvt_pk_bf16_f32 v178, v196, v197
    v_add_f32 v202, v202, v197
    v_mfma_f32_16x16x32_bf16 v[128:131], a[192:195], v[64:67], v[216:219]
    v_exp_f32 v196, v108
    v_mfma_f32_16x16x32_bf16 v[128:131], a[196:199], v[68:71], v[128:131]
    v_exp_f32 v197, v109
    v_mfma_f32_16x16x32_bf16 v[128:131], a[200:203], v[72:75], v[128:131]
    v_add_f32 v202, v202, v198
    v_mfma_f32_16x16x32_bf16 v[128:131], a[204:207], v[76:79], v[128:131]
    s_waitcnt vmcnt(16) lgkmcnt(0)
    v_mfma_f32_16x16x32_bf16 v[128:131], a[208:211], v[80:83], v[128:131]
    s_barrier
    v_mfma_f32_16x16x32_bf16 v[128:131], a[212:215], v[84:87], v[128:131]
    v_cvt_pk_bf16_f32 v179, v198, v199
    v_add_f32 v202, v202, v199
    v_mfma_f32_16x16x32_bf16 v[128:131], a[216:219], v[88:91], v[128:131]
    v_exp_f32 v198, v110
    v_mfma_f32_16x16x32_bf16 v[128:131], a[220:223], v[92:95], v[128:131]
    v_exp_f32 v199, v111
    v_mfma_f32_16x16x32_bf16 v[140:143], a[224:227], v[92:95], v[216:219]
    ds_read_b64_tr_b16 a[192:193], v221 offset:0
    v_mfma_f32_16x16x32_bf16 v[140:143], a[228:231], v[88:91], v[140:143]
    ds_read_b64_tr_b16 a[194:195], v221 offset:512
    v_add_f32 v201, v201, v192
    v_mfma_f32_16x16x32_bf16 v[140:143], a[232:235], v[84:87], v[140:143]
    v_cvt_pk_bf16_f32 v174, v192, v193
    v_mfma_f32_16x16x32_bf16 v[140:143], a[236:239], v[80:83], v[140:143]
    ds_read_b64_tr_b16 a[196:197], v221 offset:16640
    v_add_f32 v201, v201, v193
    v_mfma_f32_16x16x32_bf16 v[140:143], a[240:243], v[76:79], v[140:143]
    s_add_u32 m0, s21, 33280
    ds_read_b64_tr_b16 a[198:199], v221 offset:17152
    v_mfma_f32_16x16x32_bf16 v[140:143], a[244:247], v[72:75], v[140:143]
    buffer_load_dwordx4 v222, s[4:7], s23 offen offset:0 nt lds
    v_mfma_f32_16x16x32_bf16 v[140:143], a[248:251], v[68:71], v[140:143]
    ds_read_b64_tr_b16 a[200:201], v221 offset:16672
    v_add_f32 v201, v201, v194
    v_mfma_f32_16x16x32_bf16 v[140:143], a[252:255], v[64:67], v[140:143]
    ds_read_b64_tr_b16 a[202:203], v221 offset:17184
    v_cvt_pk_bf16_f32 v175, v194, v195
    v_mfma_f32_16x16x32_bf16 v[136:139], a[252:255], a[160:163], v[212:215]
    v_exp_f32 v192, v120
    v_mfma_f32_16x16x32_bf16 v[136:139], a[248:251], a[164:167], v[136:139]
    ds_read_b64_tr_b16 a[204:205], v221 offset:32
    v_mfma_f32_16x16x32_bf16 v[136:139], a[244:247], a[168:171], v[136:139]
    ds_read_b64_tr_b16 a[206:207], v221 offset:544
    v_add_f32 v201, v201, v195
    v_mfma_f32_16x16x32_bf16 v[136:139], a[240:243], a[172:175], v[136:139]
    v_exp_f32 v193, v121
    v_mfma_f32_16x16x32_bf16 v[136:139], a[236:239], a[176:179], v[136:139]
    ds_read_b64_tr_b16 a[208:209], v221 offset:64
    v_add_f32 v200, v200, v196
    v_mfma_f32_16x16x32_bf16 v[136:139], a[232:235], a[180:183], v[136:139]
    s_add_u32 m0, s21, 33296
    ds_read_b64_tr_b16 a[210:211], v221 offset:576
    v_mfma_f32_16x16x32_bf16 v[136:139], a[228:231], a[184:187], v[136:139]
    buffer_load_dwordx4 v222, s[4:7], s23 offen offset:1024 nt lds
    v_mfma_f32_16x16x32_bf16 v[136:139], a[224:227], a[188:191], v[136:139]
    ds_read_b64_tr_b16 a[212:213], v221 offset:16704
    v_cvt_pk_bf16_f32 v170, v196, v197
    v_mfma_f32_16x16x32_bf16 v[132:135], a[224:227], a[156:159], v[208:211]
    ds_read_b64_tr_b16 a[214:215], v221 offset:17216
    v_mfma_f32_16x16x32_bf16 v[132:135], a[228:231], a[152:155], v[132:135]
    v_exp_f32 v194, v122
    v_mfma_f32_16x16x32_bf16 v[132:135], a[232:235], a[148:151], v[132:135]
    ds_read_b64_tr_b16 a[216:217], v221 offset:16736
    v_add_f32 v200, v200, v197
    v_mfma_f32_16x16x32_bf16 v[132:135], a[236:239], a[144:147], v[132:135]
    ds_read_b64_tr_b16 a[218:219], v221 offset:17248
    v_add_f32 v200, v200, v198
    v_mfma_f32_16x16x32_bf16 v[132:135], a[240:243], a[140:143], v[132:135]
    v_exp_f32 v195, v123
    v_mfma_f32_16x16x32_bf16 v[132:135], a[244:247], a[136:139], v[132:135]
    ds_read_b64_tr_b16 a[220:221], v221 offset:96
    v_mfma_f32_16x16x32_bf16 v[132:135], a[248:251], a[132:135], v[132:135]
    s_add_u32 m0, s21, 33312
    ds_read_b64_tr_b16 a[222:223], v221 offset:608
    v_mfma_f32_16x16x32_bf16 v[132:135], a[252:255], a[128:131], v[132:135]
    s_waitcnt lgkmcnt(4)
    buffer_load_dwordx4 v222, s[4:7], s23 offen offset:2048 nt lds
    v_mfma_f32_16x16x32_bf16 v[0:3], v[144:147], a[192:195], v[0:3]
    ds_read_b64_tr_b16 a[224:225], v221 offset:128
    v_cvt_pk_bf16_f32 v171, v198, v199
    v_mfma_f32_16x16x32_bf16 v[0:3], v[156:159], a[196:199], v[0:3]
    ds_read_b64_tr_b16 a[226:227], v221 offset:640
    v_add_f32 v200, v200, v199
    v_mfma_f32_16x16x32_bf16 v[4:7], v[160:163], a[196:199], v[4:7]
    v_exp_f32 v196, v124
    v_mfma_f32_16x16x32_bf16 v[4:7], v[148:151], a[192:195], v[4:7]
    ds_read_b64_tr_b16 a[228:229], v221 offset:16768
    v_add_f32 v200, v200, v192
    v_mfma_f32_16x16x32_bf16 v[8:11], v[152:155], a[192:195], v[8:11]
    ds_read_b64_tr_b16 a[230:231], v221 offset:17280
    v_mfma_f32_16x16x32_bf16 v[8:11], v[164:167], a[196:199], v[8:11]
    v_exp_f32 v197, v125
    v_mfma_f32_16x16x32_bf16 v[20:23], v[164:167], a[200:203], v[20:23]
    ds_read_b64_tr_b16 a[232:233], v221 offset:16800
    v_cvt_pk_bf16_f32 v180, v192, v193
    v_mfma_f32_16x16x32_bf16 v[20:23], v[152:155], a[204:207], v[20:23]
    s_add_u32 m0, s21, 33328
    ds_read_b64_tr_b16 a[234:235], v221 offset:17312
    v_mfma_f32_16x16x32_bf16 v[16:19], v[148:151], a[204:207], v[16:19]
    buffer_load_dwordx4 v222, s[4:7], s23 offen offset:3072 nt lds
    v_mfma_f32_16x16x32_bf16 v[16:19], v[160:163], a[200:203], v[16:19]
    s_add_u32 s23, s23, 4096
    ds_read_b64_tr_b16 a[236:237], v221 offset:160
    v_add_f32 v200, v200, v193
    v_mfma_f32_16x16x32_bf16 v[12:15], v[156:159], a[200:203], v[12:15]
    ds_read_b64_tr_b16 a[238:239], v221 offset:672
    v_add_f32 v200, v200, v194
    v_mfma_f32_16x16x32_bf16 v[12:15], v[144:147], a[204:207], v[12:15]
    v_exp_f32 v198, v126
    v_mfma_f32_16x16x32_bf16 v[24:27], v[144:147], a[208:211], v[24:27]
    ds_read_b64_tr_b16 a[240:241], v221 offset:192
    v_mfma_f32_16x16x32_bf16 v[24:27], v[156:159], a[212:215], v[24:27]
    ds_read_b64_tr_b16 a[242:243], v221 offset:704
    v_cvt_pk_bf16_f32 v181, v194, v195
    v_mfma_f32_16x16x32_bf16 v[28:31], v[160:163], a[212:215], v[28:31]
    v_exp_f32 v199, v127
    v_mfma_f32_16x16x32_bf16 v[28:31], v[148:151], a[208:211], v[28:31]
    ds_read_b64_tr_b16 a[244:245], v221 offset:16832
    v_mfma_f32_16x16x32_bf16 v[32:35], v[152:155], a[208:211], v[32:35]
    s_add_u32 m0, s21, 37440
    ds_read_b64_tr_b16 a[246:247], v221 offset:17344
    v_mfma_f32_16x16x32_bf16 v[32:35], v[164:167], a[212:215], v[32:35]
    s_waitcnt lgkmcnt(4)
    buffer_load_dwordx4 v222, s[4:7], s23 offen offset:0 nt lds
    v_mfma_f32_16x16x32_bf16 v[44:47], v[164:167], a[216:219], v[44:47]
    ds_read_b64_tr_b16 a[248:249], v221 offset:16864
    v_add_f32 v200, v200, v195
    v_mfma_f32_16x16x32_bf16 v[44:47], v[152:155], a[220:223], v[44:47]
    ds_read_b64_tr_b16 a[250:251], v221 offset:17376
    v_add_f32 v201, v201, v196
    v_mfma_f32_16x16x32_bf16 v[40:43], v[148:151], a[220:223], v[40:43]
    v_exp_f32 v192, v128
    v_mfma_f32_16x16x32_bf16 v[40:43], v[160:163], a[216:219], v[40:43]
    ds_read_b64_tr_b16 a[252:253], v221 offset:224
    v_cvt_pk_bf16_f32 v184, v196, v197
    v_mfma_f32_16x16x32_bf16 v[36:39], v[156:159], a[216:219], v[36:39]
    ds_read_b64_tr_b16 a[254:255], v221 offset:736
    v_mfma_f32_16x16x32_bf16 v[36:39], v[144:147], a[220:223], v[36:39]
    v_exp_f32 v193, v129
    v_mfma_f32_16x16x32_bf16 v[48:51], v[144:147], a[224:227], v[48:51]
    ds_read_b64_tr_b16 a[192:193], v221 offset:256
    v_add_f32 v201, v201, v197
    v_mfma_f32_16x16x32_bf16 v[48:51], v[156:159], a[228:231], v[48:51]
    s_add_u32 m0, s21, 37456
    ds_read_b64_tr_b16 a[194:195], v221 offset:768
    v_mfma_f32_16x16x32_bf16 v[52:55], v[160:163], a[228:231], v[52:55]
    buffer_load_dwordx4 v222, s[4:7], s23 offen offset:1024 nt lds
    v_mfma_f32_16x16x32_bf16 v[52:55], v[148:151], a[224:227], v[52:55]
    ds_read_b64_tr_b16 a[196:197], v221 offset:16896
    v_add_f32 v201, v201, v198
    v_mfma_f32_16x16x32_bf16 v[56:59], v[152:155], a[224:227], v[56:59]
    ds_read_b64_tr_b16 a[198:199], v221 offset:17408
    v_cvt_pk_bf16_f32 v185, v198, v199
    v_mfma_f32_16x16x32_bf16 v[56:59], v[164:167], a[228:231], v[56:59]
    v_exp_f32 v194, v130
    v_mfma_f32_16x16x32_bf16 a[4:7], v[164:167], a[232:235], a[4:7]
    ds_read_b64_tr_b16 a[200:201], v221 offset:16928
    v_mfma_f32_16x16x32_bf16 a[4:7], v[152:155], a[236:239], a[4:7]
    ds_read_b64_tr_b16 a[202:203], v221 offset:17440
    v_add_f32 v201, v201, v199
    v_mfma_f32_16x16x32_bf16 a[0:3], v[148:151], a[236:239], a[0:3]
    v_exp_f32 v195, v131
    v_mfma_f32_16x16x32_bf16 a[0:3], v[160:163], a[232:235], a[0:3]
    ds_read_b64_tr_b16 a[204:205], v221 offset:288
    v_mfma_f32_16x16x32_bf16 v[60:63], v[156:159], a[232:235], v[60:63]
    s_add_u32 m0, s21, 37472
    ds_read_b64_tr_b16 a[206:207], v221 offset:800
    v_mfma_f32_16x16x32_bf16 v[60:63], v[144:147], a[236:239], v[60:63]
    s_waitcnt lgkmcnt(4)
    buffer_load_dwordx4 v222, s[4:7], s23 offen offset:2048 nt lds
    v_mfma_f32_16x16x32_bf16 a[8:11], v[144:147], a[240:243], a[8:11]
    ds_read_b64_tr_b16 a[208:209], v221 offset:320
    v_add_f32 v202, v202, v192
    v_mfma_f32_16x16x32_bf16 a[8:11], v[156:159], a[244:247], a[8:11]
    ds_read_b64_tr_b16 a[210:211], v221 offset:832
    v_cvt_pk_bf16_f32 v188, v192, v193
    v_mfma_f32_16x16x32_bf16 a[12:15], v[160:163], a[244:247], a[12:15]
    v_exp_f32 v196, v140
    v_mfma_f32_16x16x32_bf16 a[12:15], v[148:151], a[240:243], a[12:15]
    ds_read_b64_tr_b16 a[212:213], v221 offset:16960
    v_add_f32 v202, v202, v193
    v_mfma_f32_16x16x32_bf16 a[16:19], v[152:155], a[240:243], a[16:19]
    ds_read_b64_tr_b16 a[214:215], v221 offset:17472
    v_mfma_f32_16x16x32_bf16 a[16:19], v[164:167], a[244:247], a[16:19]
    v_exp_f32 v197, v141
    v_mfma_f32_16x16x32_bf16 a[28:31], v[164:167], a[248:251], a[28:31]
    ds_read_b64_tr_b16 a[216:217], v221 offset:16992
    v_add_f32 v202, v202, v194
    v_mfma_f32_16x16x32_bf16 a[28:31], v[152:155], a[252:255], a[28:31]
    s_add_u32 m0, s21, 37488
    ds_read_b64_tr_b16 a[218:219], v221 offset:17504
    v_mfma_f32_16x16x32_bf16 a[24:27], v[148:151], a[252:255], a[24:27]
    buffer_load_dwordx4 v222, s[4:7], s23 offen offset:3072 nt lds
    v_mfma_f32_16x16x32_bf16 a[24:27], v[160:163], a[248:251], a[24:27]
    s_add_u32 s23, s23, 28672
    ds_read_b64_tr_b16 a[220:221], v221 offset:352
    v_cvt_pk_bf16_f32 v189, v194, v195
    v_mfma_f32_16x16x32_bf16 a[20:23], v[156:159], a[248:251], a[20:23]
    ds_read_b64_tr_b16 a[222:223], v221 offset:864
    v_add_f32 v202, v202, v195
    v_mfma_f32_16x16x32_bf16 a[20:23], v[144:147], a[252:255], a[20:23]
    v_exp_f32 v198, v142
    v_mfma_f32_16x16x32_bf16 a[32:35], v[144:147], a[192:195], a[32:35]
    ds_read_b64_tr_b16 a[224:225], v221 offset:384
    v_mfma_f32_16x16x32_bf16 a[32:35], v[156:159], a[196:199], a[32:35]
    ds_read_b64_tr_b16 a[226:227], v221 offset:896
    v_add_f32 v202, v202, v196
    v_mfma_f32_16x16x32_bf16 a[36:39], v[160:163], a[196:199], a[36:39]
    v_exp_f32 v199, v143
    v_mfma_f32_16x16x32_bf16 a[36:39], v[148:151], a[192:195], a[36:39]
    ds_read_b64_tr_b16 a[228:229], v221 offset:17024
    v_cvt_pk_bf16_f32 v190, v196, v197
    v_mfma_f32_16x16x32_bf16 a[40:43], v[152:155], a[192:195], a[40:43]
    ds_read_b64_tr_b16 a[230:231], v221 offset:17536
    v_mfma_f32_16x16x32_bf16 a[40:43], v[164:167], a[196:199], a[40:43]
    s_waitcnt lgkmcnt(4)
    v_exp_f32 v192, v136
    v_mfma_f32_16x16x32_bf16 a[52:55], v[164:167], a[200:203], a[52:55]
    ds_read_b64_tr_b16 a[232:233], v221 offset:17056
    v_add_f32 v202, v202, v197
    v_mfma_f32_16x16x32_bf16 a[52:55], v[152:155], a[204:207], a[52:55]
    ds_read_b64_tr_b16 a[234:235], v221 offset:17568
    v_add_f32 v202, v202, v198
    v_mfma_f32_16x16x32_bf16 a[48:51], v[148:151], a[204:207], a[48:51]
    v_exp_f32 v193, v137
    v_mfma_f32_16x16x32_bf16 a[48:51], v[160:163], a[200:203], a[48:51]
    ds_read_b64_tr_b16 a[236:237], v221 offset:416
    v_mfma_f32_16x16x32_bf16 a[44:47], v[156:159], a[200:203], a[44:47]
    ds_read_b64_tr_b16 a[238:239], v221 offset:928
    v_mfma_f32_16x16x32_bf16 a[44:47], v[144:147], a[204:207], a[44:47]
    buffer_load_dword v253, v254, s[12:15], s59 offen
    v_mfma_f32_16x16x32_bf16 a[56:59], v[144:147], a[208:211], a[56:59]
    s_sub_u32 s59, s59, 16384
    ds_read_b64_tr_b16 a[240:241], v221 offset:448
    v_cvt_pk_bf16_f32 v191, v198, v199
    v_mfma_f32_16x16x32_bf16 a[56:59], v[156:159], a[212:215], a[56:59]
    s_cselect_b32 s59, 0x40000000, s59
    ds_read_b64_tr_b16 a[242:243], v221 offset:960
    v_add_f32 v202, v202, v199
    v_mfma_f32_16x16x32_bf16 a[60:63], v[160:163], a[212:215], a[60:63]
    v_exp_f32 v194, v138
    v_mfma_f32_16x16x32_bf16 a[60:63], v[148:151], a[208:211], a[60:63]
    ds_read_b64_tr_b16 a[244:245], v221 offset:17088
    v_mfma_f32_16x16x32_bf16 a[64:67], v[152:155], a[208:211], a[64:67]
    ds_read_b64_tr_b16 a[246:247], v221 offset:17600
    v_add_f32 v201, v201, v192
    v_mfma_f32_16x16x32_bf16 a[64:67], v[164:167], a[212:215], a[64:67]
    v_exp_f32 v195, v139
    v_mfma_f32_16x16x32_bf16 a[76:79], v[164:167], a[216:219], a[76:79]
    ds_read_b64_tr_b16 a[248:249], v221 offset:17120
    v_cvt_pk_bf16_f32 v186, v192, v193
    v_mfma_f32_16x16x32_bf16 a[76:79], v[152:155], a[220:223], a[76:79]
    ds_read_b64_tr_b16 a[250:251], v221 offset:17632
    v_add_f32 v201, v201, v193
    v_mfma_f32_16x16x32_bf16 a[72:75], v[148:151], a[220:223], a[72:75]
    v_exp_f32 v196, v132
    v_mfma_f32_16x16x32_bf16 a[72:75], v[160:163], a[216:219], a[72:75]
    ds_read_b64_tr_b16 a[252:253], v221 offset:480
    v_mfma_f32_16x16x32_bf16 a[68:71], v[156:159], a[216:219], a[68:71]
    ds_read_b64_tr_b16 a[254:255], v221 offset:992
    v_add_f32 v201, v201, v194
    v_mfma_f32_16x16x32_bf16 a[68:71], v[144:147], a[220:223], a[68:71]
    s_waitcnt lgkmcnt(4)
    v_exp_f32 v197, v133
    v_mfma_f32_16x16x32_bf16 a[80:83], v[144:147], a[224:227], a[80:83]
    s_sub_u32 s28, s28, 1
    v_exp_f32 v198, v134
    v_mfma_f32_16x16x32_bf16 a[80:83], v[156:159], a[228:231], a[80:83]
    s_bitcmp1_b32 s57, s28
    v_exp_f32 v199, v135
    v_mfma_f32_16x16x32_bf16 a[84:87], v[160:163], a[228:231], a[84:87]
    s_cselect_b32 s29, -1.0, s27
    v_cvt_pk_bf16_f32 v187, v194, v195
    v_mfma_f32_16x16x32_bf16 a[84:87], v[148:151], a[224:227], a[84:87]
    v_add_f32 v201, v201, v195
    v_mfma_f32_16x16x32_bf16 a[88:91], v[152:155], a[224:227], a[88:91]
    v_add_f32 v200, v200, v196
    v_cvt_pk_bf16_f32 v182, v196, v197
    v_mfma_f32_16x16x32_bf16 a[88:91], v[164:167], a[228:231], a[88:91]
    s_waitcnt vmcnt(16) lgkmcnt(0)
    v_mfma_f32_16x16x32_bf16 a[100:103], v[164:167], a[232:235], a[100:103]
    s_barrier
    v_mfma_f32_16x16x32_bf16 a[100:103], v[152:155], a[236:239], a[100:103]
    ds_read_b128 a[192:195], v220 offset:0
    v_add_f32 v200, v200, v197
    v_mfma_f32_16x16x32_bf16 a[96:99], v[148:151], a[236:239], a[96:99]
    v_add_f32 v200, v200, v198
    v_mfma_f32_16x16x32_bf16 a[96:99], v[160:163], a[232:235], a[96:99]
    ds_read_b128 a[196:199], v220 offset:64
    v_cvt_pk_bf16_f32 v183, v198, v199
    v_mfma_f32_16x16x32_bf16 a[92:95], v[156:159], a[232:235], a[92:95]
    v_add_f32 v200, v200, v199
    v_max3_f32 v206, v200, v201, v202
    v_mfma_f32_16x16x32_bf16 a[92:95], v[144:147], a[236:239], a[92:95]
    ds_read_b128 a[200:203], v220 offset:128
    v_cmp_nge_f32 vcc, s29, v206
    v_mfma_f32_16x16x32_bf16 a[104:107], v[144:147], a[240:243], a[104:107]
    v_mfma_f32_16x16x32_bf16 a[104:107], v[156:159], a[244:247], a[104:107]
    s_add_u32 m0, s22, 0
    ds_read_b128 a[204:207], v220 offset:192
    v_mfma_f32_16x16x32_bf16 a[108:111], v[160:163], a[244:247], a[108:111]
    buffer_load_dwordx4 v223, s[8:11], s24 offen offset:0 nt lds
    v_mfma_f32_16x16x32_bf16 a[108:111], v[148:151], a[240:243], a[108:111]
    ds_read_b128 a[208:211], v220 offset:256
    v_mfma_f32_16x16x32_bf16 a[112:115], v[152:155], a[240:243], a[112:115]
    v_mfma_f32_16x16x32_bf16 a[112:115], v[164:167], a[244:247], a[112:115]
    ds_read_b128 a[212:215], v220 offset:320
    v_mfma_f32_16x16x32_bf16 a[124:127], v[164:167], a[248:251], a[124:127]
    v_mfma_f32_16x16x32_bf16 a[124:127], v[152:155], a[252:255], a[124:127]
    s_add_u32 m0, s22, 7808
    ds_read_b128 a[216:219], v220 offset:384
    v_mfma_f32_16x16x32_bf16 a[120:123], v[148:151], a[252:255], a[120:123]
    buffer_load_dwordx4 v223, s[8:11], s24 offen offset:512 nt lds
    v_mfma_f32_16x16x32_bf16 a[120:123], v[160:163], a[248:251], a[120:123]
    ds_read_b128 a[220:223], v220 offset:448
    v_mfma_f32_16x16x32_bf16 a[116:119], v[156:159], a[248:251], a[116:119]
    s_waitcnt lgkmcnt(3)
    v_mfma_f32_16x16x32_bf16 a[116:119], v[144:147], a[252:255], a[116:119]
    s_cbranch_vccnz L_tr1
L_ret1:
    v_mfma_f32_16x16x32_bf16 v[96:99], a[192:195], a[128:131], v[208:211]
    v_mfma_f32_16x16x32_bf16 v[96:99], a[196:199], a[132:135], v[96:99]
    v_mfma_f32_16x16x32_bf16 v[96:99], a[200:203], a[136:139], v[96:99]
    ds_read_b128 a[224:227], v220 offset:1488
    v_mfma_f32_16x16x32_bf16 v[96:99], a[204:207], a[140:143], v[96:99]
    v_mfma_f32_16x16x32_bf16 v[96:99], a[208:211], a[144:147], v[96:99]
    s_waitcnt lgkmcnt(1)
    s_add_u32 m0, s22, 32
    ds_read_b128 a[228:231], v220 offset:1424
    v_mfma_f32_16x16x32_bf16 v[96:99], a[212:215], a[148:151], v[96:99]
    buffer_load_dwordx4 v223, s[8:11], s24 offen offset:2048 nt lds
    v_mfma_f32_16x16x32_bf16 v[96:99], a[216:219], a[152:155], v[96:99]
    ds_read_b128 a[232:235], v220 offset:1360
    v_mfma_f32_16x16x32_bf16 v[96:99], a[220:223], a[156:159], v[96:99]
    v_mfma_f32_16x16x32_bf16 v[100:103], a[220:223], a[188:191], v[212:215]
    ds_read_b128 a[236:239], v220 offset:1296
    v_mfma_f32_16x16x32_bf16 v[100:103], a[216:219], a[184:187], v[100:103]
    v_mfma_f32_16x16x32_bf16 v[100:103], a[212:215], a[180:183], v[100:103]
    ds_read_b128 a[240:243], v220 offset:1232
    v_mfma_f32_16x16x32_bf16 v[100:103], a[208:211], a[176:179], v[100:103]
    v_mfma_f32_16x16x32_bf16 v[100:103], a[204:207], a[172:175], v[100:103]
    s_add_u32 m0, s22, 7840
    ds_read_b128 a[244:247], v220 offset:1168
    v_mfma_f32_16x16x32_bf16 v[100:103], a[200:203], a[168:171], v[100:103]
    buffer_load_dwordx4 v223, s[8:11], s24 offen offset:2560 nt lds
    v_mfma_f32_16x16x32_bf16 v[100:103], a[196:199], a[164:167], v[100:103]
    s_add_u32 s24, s24, 4096
    ds_read_b128 a[248:251], v220 offset:1104
    v_mfma_f32_16x16x32_bf16 v[100:103], a[192:195], a[160:163], v[100:103]
    v_exp_f32 v192, v96
    v_mfma_f32_16x16x32_bf16 v[104:107], a[192:195], v[64:67], v[216:219]
    ds_read_b128 a[252:255], v220 offset:1040
    v_add_f32 v203, v200, v192
    v_mfma_f32_16x16x32_bf16 v[104:107], a[196:199], v[68:71], v[104:107]
    v_exp_f32 v193, v97
    v_mfma_f32_16x16x32_bf16 v[104:107], a[200:203], v[72:75], v[104:107]
    v_exp_f32 v194, v98
    v_mfma_f32_16x16x32_bf16 v[104:107], a[204:207], v[76:79], v[104:107]
    v_exp_f32 v195, v99
    v_mfma_f32_16x16x32_bf16 v[104:107], a[208:211], v[80:83], v[104:107]
    s_add_u32 m0, s22, 4160
    v_cvt_pk_bf16_f32 v144, v192, v193
    v_mfma_f32_16x16x32_bf16 v[104:107], a[212:215], v[84:87], v[104:107]
    buffer_load_dwordx4 v223, s[8:11], s24 offen offset:0 nt lds
    v_mfma_f32_16x16x32_bf16 v[104:107], a[216:219], v[88:91], v[104:107]
    v_exp_f32 v196, v100
    v_mfma_f32_16x16x32_bf16 v[104:107], a[220:223], v[92:95], v[104:107]
    s_waitcnt lgkmcnt(0)
    v_exp_f32 v197, v101
    v_mfma_f32_16x16x32_bf16 v[116:119], a[224:227], v[92:95], v[216:219]
    v_exp_f32 v198, v102
    v_mfma_f32_16x16x32_bf16 v[116:119], a[228:231], v[88:91], v[116:119]
    v_exp_f32 v199, v103
    v_mfma_f32_16x16x32_bf16 v[116:119], a[232:235], v[84:87], v[116:119]
    ds_read_b128 a[192:195], v220 offset:16640
    v_add_f32 v203, v203, v193
    v_mfma_f32_16x16x32_bf16 v[116:119], a[236:239], v[80:83], v[116:119]
    v_add_f32 v203, v203, v194
    v_cvt_pk_bf16_f32 v145, v194, v195
    v_mfma_f32_16x16x32_bf16 v[116:119], a[240:243], v[76:79], v[116:119]
    s_add_u32 m0, s22, 11968
    ds_read_b128 a[196:199], v220 offset:16704
    v_mfma_f32_16x16x32_bf16 v[116:119], a[244:247], v[72:75], v[116:119]
    buffer_load_dwordx4 v223, s[8:11], s24 offen offset:512 nt lds
    v_mfma_f32_16x16x32_bf16 v[116:119], a[248:251], v[68:71], v[116:119]
    ds_read_b128 a[200:203], v220 offset:16768
    v_add_f32 v203, v203, v195
    v_mfma_f32_16x16x32_bf16 v[116:119], a[252:255], v[64:67], v[116:119]
    v_exp_f32 v192, v104
    v_mfma_f32_16x16x32_bf16 v[112:115], a[252:255], a[160:163], v[212:215]
    ds_read_b128 a[204:207], v220 offset:16832
    v_mfma_f32_16x16x32_bf16 v[112:115], a[248:251], a[164:167], v[112:115]
    v_exp_f32 v193, v105
    v_mfma_f32_16x16x32_bf16 v[112:115], a[244:247], a[168:171], v[112:115]
    ds_read_b128 a[208:211], v220 offset:16896
    v_add_f32 v204, v201, v196
    v_mfma_f32_16x16x32_bf16 v[112:115], a[240:243], a[172:175], v[112:115]
    v_exp_f32 v194, v106
    v_mfma_f32_16x16x32_bf16 v[112:115], a[236:239], a[176:179], v[112:115]
    s_add_u32 m0, s22, 4192
    ds_read_b128 a[212:215], v220 offset:16960
    v_mfma_f32_16x16x32_bf16 v[112:115], a[232:235], a[180:183], v[112:115]
    buffer_load_dwordx4 v223, s[8:11], s24 offen offset:2048 nt lds
    v_mfma_f32_16x16x32_bf16 v[112:115], a[228:231], a[184:187], v[112:115]
    ds_read_b128 a[216:219], v220 offset:17024
    v_mfma_f32_16x16x32_bf16 v[112:115], a[224:227], a[188:191], v[112:115]
    v_exp_f32 v195, v107
    v_mfma_f32_16x16x32_bf16 v[108:111], a[224:227], a[156:159], v[208:211]
    ds_read_b128 a[220:223], v220 offset:17088
    v_cvt_pk_bf16_f32 v148, v196, v197
    v_mfma_f32_16x16x32_bf16 v[108:111], a[228:231], a[152:155], v[108:111]
    v_exp_f32 v196, v116
    v_mfma_f32_16x16x32_bf16 v[108:111], a[232:235], a[148:151], v[108:111]
    v_add_f32 v204, v204, v197
    v_mfma_f32_16x16x32_bf16 v[108:111], a[236:239], a[144:147], v[108:111]
    v_exp_f32 v197, v117
    v_mfma_f32_16x16x32_bf16 v[108:111], a[240:243], a[140:143], v[108:111]
    s_add_u32 m0, s22, 12000
    v_add_f32 v204, v204, v198
    v_mfma_f32_16x16x32_bf16 v[108:111], a[244:247], a[136:139], v[108:111]
    buffer_load_dwordx4 v223, s[8:11], s24 offen offset:2560 nt lds
    v_mfma_f32_16x16x32_bf16 v[108:111], a[248:251], a[132:135], v[108:111]
    s_add_u32 s24, s24, 28672
    ds_read_b128 a[224:227], v220 offset:18128
    v_mfma_f32_16x16x32_bf16 v[108:111], a[252:255], a[128:131], v[108:111]
    s_waitcnt lgkmcnt(1)
    v_cvt_pk_bf16_f32 v149, v198, v199
    v_add_f32 v204, v204, v199
    v_mfma_f32_16x16x32_bf16 v[120:123], a[192:195], a[128:131], v[208:211]
    ds_read_b128 a[228:231], v220 offset:18064
    v_add_f32 v205, v202, v192
    v_mfma_f32_16x16x32_bf16 v[120:123], a[196:199], a[132:135], v[120:123]
    v_exp_f32 v198, v118
    v_mfma_f32_16x16x32_bf16 v[120:123], a[200:203], a[136:139], v[120:123]
    ds_read_b128 a[232:235], v220 offset:18000
    v_mfma_f32_16x16x32_bf16 v[120:123], a[204:207], a[140:143], v[120:123]
    v_exp_f32 v199, v119
    v_mfma_f32_16x16x32_bf16 v[120:123], a[208:211], a[144:147], v[120:123]
    ds_read_b128 a[236:239], v220 offset:17936
    v_cvt_pk_bf16_f32 v152, v192, v193
    v_mfma_f32_16x16x32_bf16 v[120:123], a[212:215], a[148:151], v[120:123]
    v_exp_f32 v192, v112
    v_mfma_f32_16x16x32_bf16 v[120:123], a[216:219], a[152:155], v[120:123]
    ds_read_b128 a[240:243], v220 offset:17872
    v_add_f32 v205, v205, v193
    v_mfma_f32_16x16x32_bf16 v[120:123], a[220:223], a[156:159], v[120:123]
    v_exp_f32 v193, v113
    v_mfma_f32_16x16x32_bf16 v[124:127], a[220:223], a[188:191], v[212:215]
    ds_read_b128 a[244:247], v220 offset:17808
    v_mfma_f32_16x16x32_bf16 v[124:127], a[216:219], a[184:187], v[124:127]
    v_add_f32 v205, v205, v194
    v_cvt_pk_bf16_f32 v153, v194, v195
    v_mfma_f32_16x16x32_bf16 v[124:127], a[212:215], a[180:183], v[124:127]
    ds_read_b128 a[248:251], v220 offset:17744
    v_add_f32 v205, v205, v195
    v_mfma_f32_16x16x32_bf16 v[124:127], a[208:211], a[176:179], v[124:127]
    v_exp_f32 v194, v114
    v_mfma_f32_16x16x32_bf16 v[124:127], a[204:207], a[172:175], v[124:127]
    ds_read_b128 a[252:255], v220 offset:17680
    v_mfma_f32_16x16x32_bf16 v[124:127], a[200:203], a[168:171], v[124:127]
    v_exp_f32 v195, v115
    v_mfma_f32_16x16x32_bf16 v[124:127], a[196:199], a[164:167], v[124:127]
    v_add_f32 v205, v205, v196
    v_mfma_f32_16x16x32_bf16 v[124:127], a[192:195], a[160:163], v[124:127]
    v_cvt_pk_bf16_f32 v154, v196, v197
    v_add_f32 v205, v205, v197
    v_mfma_f32_16x16x32_bf16 v[128:131], a[192:195], v[64:67], v[216:219]
    v_exp_f32 v196, v108
    v_mfma_f32_16x16x32_bf16 v[128:131], a[196:199], v[68:71], v[128:131]
    v_exp_f32 v197, v109
    v_mfma_f32_16x16x32_bf16 v[128:131], a[200:203], v[72:75], v[128:131]
    v_add_f32 v205, v205, v198
    v_mfma_f32_16x16x32_bf16 v[128:131], a[204:207], v[76:79], v[128:131]
    s_waitcnt vmcnt(16) lgkmcnt(0)
    v_mfma_f32_16x16x32_bf16 v[128:131], a[208:211], v[80:83], v[128:131]
    s_barrier
    v_mfma_f32_16x16x32_bf16 v[128:131], a[212:215], v[84:87], v[128:131]
    v_cvt_pk_bf16_f32 v155, v198, v199
    v_add_f32 v205, v205, v199
    v_mfma_f32_16x16x32_bf16 v[128:131], a[216:219], v[88:91], v[128:131]
    v_exp_f32 v198, v110
    v_mfma_f32_16x16x32_bf16 v[128:131], a[220:223], v[92:95], v[128:131]
    v_exp_f32 v199, v111
    v_mfma_f32_16x16x32_bf16 v[140:143], a[224:227], v[92:95], v[216:219]
    ds_read_b64_tr_b16 a[192:193], v221 offset:33280
    v_mfma_f32_16x16x32_bf16 v[140:143], a[228:231], v[88:91], v[140:143]
    ds_read_b64_tr_b16 a[194:195], v221 offset:33792
    v_add_f32 v204, v204, v192
    v_mfma_f32_16x16x32_bf16 v[140:143], a[232:235], v[84:87], v[140:143]
    v_cvt_pk_bf16_f32 v150, v192, v193
    v_mfma_f32_16x16x32_bf16 v[140:143], a[236:239], v[80:83], v[140:143]
    ds_read_b64_tr_b16 a[196:197], v221 offset:49920
    v_add_f32 v204, v204, v193
    v_mfma_f32_16x16x32_bf16 v[140:143], a[240:243], v[76:79], v[140:143]
    s_add_u32 m0, s21, 0
    ds_read_b64_tr_b16 a[198:199], v221 offset:50432
    v_mfma_f32_16x16x32_bf16 v[140:143], a[244:247], v[72:75], v[140:143]
    buffer_load_dwordx4 v222, s[4:7], s23 offen offset:0 nt lds
    v_mfma_f32_16x16x32_bf16 v[140:143], a[248:251], v[68:71], v[140:143]
    ds_read_b64_tr_b16 a[200:201], v221 offset:49952
    v_add_f32 v204, v204, v194
    v_mfma_f32_16x16x32_bf16 v[140:143], a[252:255], v[64:67], v[140:143]
    ds_read_b64_tr_b16 a[202:203], v221 offset:50464
    v_cvt_pk_bf16_f32 v151, v194, v195
    v_mfma_f32_16x16x32_bf16 v[136:139], a[252:255], a[160:163], v[212:215]
    v_exp_f32 v192, v120
    v_mfma_f32_16x16x32_bf16 v[136:139], a[248:251], a[164:167], v[136:139]
    ds_read_b64_tr_b16 a[204:205], v221 offset:33312
    v_mfma_f32_16x16x32_bf16 v[136:139], a[244:247], a[168:171], v[136:139]
    ds_read_b64_tr_b16 a[206:207], v221 offset:33824
    v_add_f32 v204, v204, v195
    v_mfma_f32_16x16x32_bf16 v[136:139], a[240:243], a[172:175], v[136:139]
    v_exp_f32 v193, v121
    v_mfma_f32_16x16x32_bf16 v[136:139], a[236:239], a[176:179], v[136:139]
    ds_read_b64_tr_b16 a[208:209], v221 offset:33344
    v_add_f32 v203, v203, v196
    v_mfma_f32_16x16x32_bf16 v[136:139], a[232:235], a[180:183], v[136:139]
    s_add_u32 m0, s21, 16
    ds_read_b64_tr_b16 a[210:211], v221 offset:33856
    v_mfma_f32_16x16x32_bf16 v[136:139], a[228:231], a[184:187], v[136:139]
    buffer_load_dwordx4 v222, s[4:7], s23 offen offset:1024 nt lds
    v_mfma_f32_16x16x32_bf16 v[136:139], a[224:227], a[188:191], v[136:139]
    ds_read_b64_tr_b16 a[212:213], v221 offset:49984
    v_cvt_pk_bf16_f32 v146, v196, v197
    v_mfma_f32_16x16x32_bf16 v[132:135], a[224:227], a[156:159], v[208:211]
    ds_read_b64_tr_b16 a[214:215], v221 offset:50496
    v_mfma_f32_16x16x32_bf16 v[132:135], a[228:231], a[152:155], v[132:135]
    v_exp_f32 v194, v122
    v_mfma_f32_16x16x32_bf16 v[132:135], a[232:235], a[148:151], v[132:135]
    ds_read_b64_tr_b16 a[216:217], v221 offset:50016
    v_add_f32 v203, v203, v197
    v_mfma_f32_16x16x32_bf16 v[132:135], a[236:239], a[144:147], v[132:135]
    ds_read_b64_tr_b16 a[218:219], v221 offset:50528
    v_add_f32 v203, v203, v198
    v_mfma_f32_16x16x32_bf16 v[132:135], a[240:243], a[140:143], v[132:135]
    v_exp_f32 v195, v123
    v_mfma_f32_16x16x32_bf16 v[132:135], a[244:247], a[136:139], v[132:135]
    ds_read_b64_tr_b16 a[220:221], v221 offset:33376
    v_mfma_f32_16x16x32_bf16 v[132:135], a[248:251], a[132:135], v[132:135]
    s_add_u32 m0, s21, 32
    ds_read_b64_tr_b16 a[222:223], v221 offset:33888
    v_mfma_f32_16x16x32_bf16 v[132:135], a[252:255], a[128:131], v[132:135]
    s_waitcnt lgkmcnt(4)
    buffer_load_dwordx4 v222, s[4:7], s23 offen offset:2048 nt lds
    v_mfma_f32_16x16x32_bf16 v[0:3], v[168:171], a[192:195], v[0:3]
    ds_read_b64_tr_b16 a[224:225], v221 offset:33408
    v_cvt_pk_bf16_f32 v147, v198, v199
    v_mfma_f32_16x16x32_bf16 v[0:3], v[180:183], a[196:199], v[0:3]
    ds_read_b64_tr_b16 a[226:227], v221 offset:33920
    v_add_f32 v203, v203, v199
    v_mfma_f32_16x16x32_bf16 v[4:7], v[184:187], a[196:199], v[4:7]
    v_exp_f32 v196, v124
    v_mfma_f32_16x16x32_bf16 v[4:7], v[172:175], a[192:195], v[4:7]
    ds_read_b64_tr_b16 a[228:229], v221 offset:50048
    v_add_f32 v203, v203, v192
    v_mfma_f32_16x16x32_bf16 v[8:11], v[176:179], a[192:195], v[8:11]
    ds_read_b64_tr_b16 a[230:231], v221 offset:50560
    v_mfma_f32_16x16x32_bf16 v[8:11], v[188:191], a[196:199], v[8:11]
    v_exp_f32 v197, v125
    v_mfma_f32_16x16x32_bf16 v[20:23], v[188:191], a[200:203], v[20:23]
    ds_read_b64_tr_b16 a[232:233], v221 offset:50080
    v_cvt_pk_bf16_f32 v156, v192, v193
    v_mfma_f32_16x16x32_bf16 v[20:23], v[176:179], a[204:207], v[20:23]
    s_add_u32 m0, s21, 48
    ds_read_b64_tr_b16 a[234:235], v221 offset:50592
    v_mfma_f32_16x16x32_bf16 v[16:19], v[172:175], a[204:207], v[16:19]
    buffer_load_dwordx4 v222, s[4:7], s23 offen offset:3072 nt lds
    v_mfma_f32_16x16x32_bf16 v[16:19], v[184:187], a[200:203], v[16:19]
    s_add_u32 s23, s23, 4096
    ds_read_b64_tr_b16 a[236:237], v221 offset:33440
    v_add_f32 v203, v203, v193
    v_mfma_f32_16x16x32_bf16 v[12:15], v[180:183], a[200:203], v[12:15]
    ds_read_b64_tr_b16 a[238:239], v221 offset:33952
    v_add_f32 v203, v203, v194
    v_mfma_f32_16x16x32_bf16 v[12:15], v[168:171], a[204:207], v[12:15]
    v_exp_f32 v198, v126
    v_mfma_f32_16x16x32_bf16 v[24:27], v[168:171], a[208:211], v[24:27]
    ds_read_b64_tr_b16 a[240:241], v221 offset:33472
    v_mfma_f32_16x16x32_bf16 v[24:27], v[180:183], a[212:215], v[24:27]
    ds_read_b64_tr_b16 a[242:243], v221 offset:33984
    v_cvt_pk_bf16_f32 v157, v194, v195
    v_mfma_f32_16x16x32_bf16 v[28:31], v[184:187], a[212:215], v[28:31]
    v_exp_f32 v199, v127
    v_mfma_f32_16x16x32_bf16 v[28:31], v[172:175], a[208:211], v[28:31]
    ds_read_b64_tr_b16 a[244:245], v221 offset:50112
    v_mfma_f32_16x16x32_bf16 v[32:35], v[176:179], a[208:211], v[32:35]
    s_add_u32 m0, s21, 4160
    ds_read_b64_tr_b16 a[246:247], v221 offset:50624
    v_mfma_f32_16x16x32_bf16 v[32:35], v[188:191], a[212:215], v[32:35]
    s_waitcnt lgkmcnt(4)
    buffer_load_dwordx4 v222, s[4:7], s23 offen offset:0 nt lds
    v_mfma_f32_16x16x32_bf16 v[44:47], v[188:191], a[216:219], v[44:47]
    ds_read_b64_tr_b16 a[248:249], v221 offset:50144
    v_add_f32 v203, v203, v195
    v_mfma_f32_16x16x32_bf16 v[44:47], v[176:179], a[220:223], v[44:47]
    ds_read_b64_tr_b16 a[250:251], v221 offset:50656
    v_add_f32 v204, v204, v196
    v_mfma_f32_16x16x32_bf16 v[40:43], v[172:175], a[220:223], v[40:43]
    v_exp_f32 v192, v128
    v_mfma_f32_16x16x32_bf16 v[40:43], v[184:187], a[216:219], v[40:43]
    ds_read_b64_tr_b16 a[252:253], v221 offset:33504
    v_cvt_pk_bf16_f32 v160, v196, v197
    v_mfma_f32_16x16x32_bf16 v[36:39], v[180:183], a[216:219], v[36:39]
    ds_read_b64_tr_b16 a[254:255], v221 offset:34016
    v_mfma_f32_16x16x32_bf16 v[36:39], v[168:171], a[220:223], v[36:39]
    v_exp_f32 v193, v129
    v_mfma_f32_16x16x32_bf16 v[48:51], v[168:171], a[224:227], v[48:51]
    ds_read_b64_tr_b16 a[192:193], v221 offset:33536
    v_add_f32 v204, v204, v197
    v_mfma_f32_16x16x32_bf16 v[48:51], v[180:183], a[228:231], v[48:51]
    s_add_u32 m0, s21, 4176
    ds_read_b64_tr_b16 a[194:195], v221 offset:34048
    v_mfma_f32_16x16x32_bf16 v[52:55], v[184:187], a[228:231], v[52:55]
    buffer_load_dwordx4 v222, s[4:7], s23 offen offset:1024 nt lds
    v_mfma_f32_16x16x32_bf16 v[52:55], v[172:175], a[224:227], v[52:55]
    ds_read_b64_tr_b16 a[196:197], v221 offset:50176
    v_add_f32 v204, v204, v198
    v_mfma_f32_16x16x32_bf16 v[56:59], v[176:179], a[224:227], v[56:59]
    ds_read_b64_tr_b16 a[198:199], v221 offset:50688
    v_cvt_pk_bf16_f32 v161, v198, v199
    v_mfma_f32_16x16x32_bf16 v[56:59], v[188:191], a[228:231], v[56:59]
    v_exp_f32 v194, v130
    v_mfma_f32_16x16x32_bf16 a[4:7], v[188:191], a[232:235], a[4:7]
    ds_read_b64_tr_b16 a[200:201], v221 offset:50208
    v_mfma_f32_16x16x32_bf16 a[4:7], v[176:179], a[236:239], a[4:7]
    ds_read_b64_tr_b16 a[202:203], v221 offset:50720
    v_add_f32 v204, v204, v199
    v_mfma_f32_16x16x32_bf16 a[0:3], v[172:175], a[236:239], a[0:3]
    v_exp_f32 v195, v131
    v_mfma_f32_16x16x32_bf16 a[0:3], v[184:187], a[232:235], a[0:3]
    ds_read_b64_tr_b16 a[204:205], v221 offset:33568
    v_mfma_f32_16x16x32_bf16 v[60:63], v[180:183], a[232:235], v[60:63]
    s_add_u32 m0, s21, 4192
    ds_read_b64_tr_b16 a[206:207], v221 offset:34080
    v_mfma_f32_16x16x32_bf16 v[60:63], v[168:171], a[236:239], v[60:63]
    s_waitcnt lgkmcnt(4)
    buffer_load_dwordx4 v222, s[4:7], s23 offen offset:2048 nt lds
    v_mfma_f32_16x16x32_bf16 a[8:11], v[168:171], a[240:243], a[8:11]
    ds_read_b64_tr_b16 a[208:209], v221 offset:33600
    v_add_f32 v205, v205, v192
    v_mfma_f32_16x16x32_bf16 a[8:11], v[180:183], a[244:247], a[8:11]
    ds_read_b64_tr_b16 a[210:211], v221 offset:34112
    v_cvt_pk_bf16_f32 v164, v192, v193
    v_mfma_f32_16x16x32_bf16 a[12:15], v[184:187], a[244:247], a[12:15]
    v_exp_f32 v196, v140
    v_mfma_f32_16x16x32_bf16 a[12:15], v[172:175], a[240:243], a[12:15]
    ds_read_b64_tr_b16 a[212:213], v221 offset:50240
    v_add_f32 v205, v205, v193
    v_mfma_f32_16x16x32_bf16 a[16:19], v[176:179], a[240:243], a[16:19]
    ds_read_b64_tr_b16 a[214:215], v221 offset:50752
    v_mfma_f32_16x16x32_bf16 a[16:19], v[188:191], a[244:247], a[16:19]
    v_exp_f32 v197, v141
    v_mfma_f32_16x16x32_bf16 a[28:31], v[188:191], a[248:251], a[28:31]
    ds_read_b64_tr_b16 a[216:217], v221 offset:50272
    v_add_f32 v205, v205, v194
    v_mfma_f32_16x16x32_bf16 a[28:31], v[176:179], a[252:255], a[28:31]
    s_add_u32 m0, s21, 4208
    ds_read_b64_tr_b16 a[218:219], v221 offset:50784
    v_mfma_f32_16x16x32_bf16 a[24:27], v[172:175], a[252:255], a[24:27]
    buffer_load_dwordx4 v222, s[4:7], s23 offen offset:3072 nt lds
    v_mfma_f32_16x16x32_bf16 a[24:27], v[184:187], a[248:251], a[24:27]
    s_add_u32 s23, s23, 28672
    ds_read_b64_tr_b16 a[220:221], v221 offset:33632
    v_cvt_pk_bf16_f32 v165, v194, v195
    v_mfma_f32_16x16x32_bf16 a[20:23], v[180:183], a[248:251], a[20:23]
    ds_read_b64_tr_b16 a[222:223], v221 offset:34144
    v_add_f32 v205, v205, v195
    v_mfma_f32_16x16x32_bf16 a[20:23], v[168:171], a[252:255], a[20:23]
    v_exp_f32 v198, v142
    v_mfma_f32_16x16x32_bf16 a[32:35], v[168:171], a[192:195], a[32:35]
    ds_read_b64_tr_b16 a[224:225], v221 offset:33664
    v_mfma_f32_16x16x32_bf16 a[32:35], v[180:183], a[196:199], a[32:35]
    ds_read_b64_tr_b16 a[226:227], v221 offset:34176
    v_add_f32 v205, v205, v196
    v_mfma_f32_16x16x32_bf16 a[36:39], v[184:187], a[196:199], a[36:39]
    v_exp_f32 v199, v143
    v_mfma_f32_16x16x32_bf16 a[36:39], v[172:175], a[192:195], a[36:39]
    ds_read_b64_tr_b16 a[228:229], v221 offset:50304
    v_cvt_pk_bf16_f32 v166, v196, v197
    v_mfma_f32_16x16x32_bf16 a[40:43], v[176:179], a[192:195], a[40:43]
    ds_read_b64_tr_b16 a[230:231], v221 offset:50816
    v_mfma_f32_16x16x32_bf16 a[40:43], v[188:191], a[196:199], a[40:43]
    s_waitcnt lgkmcnt(4)
    v_exp_f32 v192, v136
    v_mfma_f32_16x16x32_bf16 a[52:55], v[188:191], a[200:203], a[52:55]
    ds_read_b64_tr_b16 a[232:233], v221 offset:50336
    v_add_f32 v205, v205, v197
    v_mfma_f32_16x16x32_bf16 a[52:55], v[176:179], a[204:207], a[52:55]
    ds_read_b64_tr_b16 a[234:235], v221 offset:50848
    v_add_f32 v205, v205, v198
    v_mfma_f32_16x16x32_bf16 a[48:51], v[172:175], a[204:207], a[48:51]
    v_exp_f32 v193, v137
    v_mfma_f32_16x16x32_bf16 a[48:51], v[184:187], a[200:203], a[48:51]
    ds_read_b64_tr_b16 a[236:237], v221 offset:33696
    v_mfma_f32_16x16x32_bf16 a[44:47], v[180:183], a[200:203], a[44:47]
    ds_read_b64_tr_b16 a[238:239], v221 offset:34208
    v_mfma_f32_16x16x32_bf16 a[44:47], v[168:171], a[204:207], a[44:47]
    buffer_load_dword v253, v254, s[44:47], s51 offen
    v_mfma_f32_16x16x32_bf16 a[56:59], v[168:171], a[208:211], a[56:59]
    s_sub_u32 s51, s51, 16384
    ds_read_b64_tr_b16 a[240:241], v221 offset:33728
    v_cvt_pk_bf16_f32 v167, v198, v199
    v_mfma_f32_16x16x32_bf16 a[56:59], v[180:183], a[212:215], a[56:59]
    s_cselect_b32 s51, 0x40000000, s51
    ds_read_b64_tr_b16 a[242:243], v221 offset:34240
    v_add_f32 v205, v205, v199
    v_mfma_f32_16x16x32_bf16 a[60:63], v[184:187], a[212:215], a[60:63]
    v_exp_f32 v194, v138
    v_mfma_f32_16x16x32_bf16 a[60:63], v[172:175], a[208:211], a[60:63]
    ds_read_b64_tr_b16 a[244:245], v221 offset:50368
    v_mfma_f32_16x16x32_bf16 a[64:67], v[176:179], a[208:211], a[64:67]
    ds_read_b64_tr_b16 a[246:247], v221 offset:50880
    v_add_f32 v204, v204, v192
    v_mfma_f32_16x16x32_bf16 a[64:67], v[188:191], a[212:215], a[64:67]
    v_exp_f32 v195, v139
    v_mfma_f32_16x16x32_bf16 a[76:79], v[188:191], a[216:219], a[76:79]
    ds_read_b64_tr_b16 a[248:249], v221 offset:50400
    v_cvt_pk_bf16_f32 v162, v192, v193
    v_mfma_f32_16x16x32_bf16 a[76:79], v[176:179], a[220:223], a[76:79]
    ds_read_b64_tr_b16 a[250:251], v221 offset:50912
    v_add_f32 v204, v204, v193
    v_mfma_f32_16x16x32_bf16 a[72:75], v[172:175], a[220:223], a[72:75]
    v_exp_f32 v196, v132
    v_mfma_f32_16x16x32_bf16 a[72:75], v[184:187], a[216:219], a[72:75]
    ds_read_b64_tr_b16 a[252:253], v221 offset:33760
    v_mfma_f32_16x16x32_bf16 a[68:71], v[180:183], a[216:219], a[68:71]
    ds_read_b64_tr_b16 a[254:255], v221 offset:34272
    v_add_f32 v204, v204, v194
    v_mfma_f32_16x16x32_bf16 a[68:71], v[168:171], a[220:223], a[68:71]
    s_waitcnt lgkmcnt(4)
    v_exp_f32 v197, v133
    v_mfma_f32_16x16x32_bf16 a[80:83], v[168:171], a[224:227], a[80:83]
    v_exp_f32 v198, v134
    v_mfma_f32_16x16x32_bf16 a[80:83], v[180:183], a[228:231], a[80:83]
    v_exp_f32 v199, v135
    v_mfma_f32_16x16x32_bf16 a[84:87], v[184:187], a[228:231], a[84:87]
    v_cvt_pk_bf16_f32 v163, v194, v195
    v_mfma_f32_16x16x32_bf16 a[84:87], v[172:175], a[224:227], a[84:87]
    v_add_f32 v204, v204, v195
    v_mfma_f32_16x16x32_bf16 a[88:91], v[176:179], a[224:227], a[88:91]
    v_add_f32 v203, v203, v196
    v_cvt_pk_bf16_f32 v158, v196, v197
    v_mfma_f32_16x16x32_bf16 a[88:91], v[188:191], a[228:231], a[88:91]
    s_waitcnt vmcnt(16) lgkmcnt(0)
    v_mfma_f32_16x16x32_bf16 a[100:103], v[188:191], a[232:235], a[100:103]
    s_barrier
    v_mfma_f32_16x16x32_bf16 a[100:103], v[176:179], a[236:239], a[100:103]
    ds_read_b128 a[192:195], v220 offset:33280
    v_add_f32 v203, v203, v197
    v_mfma_f32_16x16x32_bf16 a[96:99], v[172:175], a[236:239], a[96:99]
    v_add_f32 v203, v203, v198
    v_mfma_f32_16x16x32_bf16 a[96:99], v[184:187], a[232:235], a[96:99]
    ds_read_b128 a[196:199], v220 offset:33344
    v_cvt_pk_bf16_f32 v159, v198, v199
    v_mfma_f32_16x16x32_bf16 a[92:95], v[180:183], a[232:235], a[92:95]
    v_add_f32 v203, v203, v199
    v_max3_f32 v206, v203, v204, v205
    v_mfma_f32_16x16x32_bf16 a[92:95], v[168:171], a[236:239], a[92:95]
    ds_read_b128 a[200:203], v220 offset:33408
    v_cmp_lt_f32 vcc, s27, v206
    v_mfma_f32_16x16x32_bf16 a[104:107], v[168:171], a[240:243], a[104:107]
    v_mfma_f32_16x16x32_bf16 a[104:107], v[180:183], a[244:247], a[104:107]
    s_add_u32 m0, s22, 33280
    ds_read_b128 a[204:207], v220 offset:33472
    v_mfma_f32_16x16x32_bf16 a[108:111], v[184:187], a[244:247], a[108:111]
    buffer_load_dwordx4 v223, s[8:11], s24 offen offset:0 nt lds
    v_mfma_f32_16x16x32_bf16 a[108:111], v[172:175], a[240:243], a[108:111]
    ds_read_b128 a[208:211], v220 offset:33536
    v_mfma_f32_16x16x32_bf16 a[112:115], v[176:179], a[240:243], a[112:115]
    v_mfma_f32_16x16x32_bf16 a[112:115], v[188:191], a[244:247], a[112:115]
    ds_read_b128 a[212:215], v220 offset:33600
    v_mfma_f32_16x16x32_bf16 a[124:127], v[188:191], a[248:251], a[124:127]
    v_mfma_f32_16x16x32_bf16 a[124:127], v[176:179], a[252:255], a[124:127]
    s_add_u32 m0, s22, 41088
    ds_read_b128 a[216:219], v220 offset:33664
    v_mfma_f32_16x16x32_bf16 a[120:123], v[172:175], a[252:255], a[120:123]
    buffer_load_dwordx4 v223, s[8:11], s24 offen offset:512 nt lds
    v_mfma_f32_16x16x32_bf16 a[120:123], v[184:187], a[248:251], a[120:123]
    ds_read_b128 a[220:223], v220 offset:33728
    v_mfma_f32_16x16x32_bf16 a[116:119], v[180:183], a[248:251], a[116:119]
    s_waitcnt lgkmcnt(3)
    v_mfma_f32_16x16x32_bf16 a[116:119], v[168:171], a[252:255], a[116:119]
    s_cbranch_vccz L_loop1
    s_call_b64 s[30:31], L_slow_1
    s_branch L_loop1
L_tr1:
    v_cmp_lt_f32 vcc, s27, v206
    s_nop 4
    s_cbranch_vccz L_nos0_1
    s_call_b64 s[30:31], L_slow_0
L_nos0_1:
    s_cmp_lg_u32 s28, 0
    s_cbranch_scc1 L_ret1
L_final:
    v_mfma_f32_16x16x32_bf16 v[96:99], a[192:195], a[128:131], v[208:211]
    s_add_u32 m0, s22, 32
    v_mfma_f32_16x16x32_bf16 v[96:99], a[196:199], a[132:135], v[96:99]
    buffer_load_dwordx4 v223, s[8:11], s24 offen offset:2048 nt lds
    v_mfma_f32_16x16x32_bf16 v[96:99], a[200:203], a[136:139], v[96:99]
    ds_read_b128 a[224:227], v220 offset:1488
    v_mfma_f32_16x16x32_bf16 v[96:99], a[204:207], a[140:143], v[96:99]
    v_mfma_f32_16x16x32_bf16 v[96:99], a[208:211], a[144:147], v[96:99]
    s_waitcnt lgkmcnt(1)
    s_add_u32 m0, s22, 7840
    ds_read_b128 a[228:231], v220 offset:1424
    v_mfma_f32_16x16x32_bf16 v[96:99], a[212:215], a[148:151], v[96:99]
    buffer_load_dwordx4 v223, s[8:11], s24 offen offset:2560 nt lds
    v_mfma_f32_16x16x32_bf16 v[96:99], a[216:219], a[152:155], v[96:99]
    s_add_u32 s24, s24, 4096
    ds_read_b128 a[232:235], v220 offset:1360
    v_mfma_f32_16x16x32_bf16 v[96:99], a[220:223], a[156:159], v[96:99]
    v_mfma_f32_16x16x32_bf16 v[100:103], a[220:223], a[188:191], v[212:215]
    s_add_u32 m0, s22, 4160
    ds_read_b128 a[236:239], v220 offset:1296
    v_mfma_f32_16x16x32_bf16 v[100:103], a[216:219], a[184:187], v[100:103]
    buffer_load_dwordx4 v223, s[8:11], s24 offen offset:0 nt lds
    v_mfma_f32_16x16x32_bf16 v[100:103], a[212:215], a[180:183], v[100:103]
    ds_read_b128 a[240:243], v220 offset:1232
    v_mfma_f32_16x16x32_bf16 v[100:103], a[208:211], a[176:179], v[100:103]
    v_mfma_f32_16x16x32_bf16 v[100:103], a[204:207], a[172:175], v[100:103]
    s_add_u32 m0, s22, 11968
    ds_read_b128 a[244:247], v220 offset:1168
    v_mfma_f32_16x16x32_bf16 v[100:103], a[200:203], a[168:171], v[100:103]
    buffer_load_dwordx4 v223, s[8:11], s24 offen offset:512 nt lds
    v_mfma_f32_16x16x32_bf16 v[100:103], a[196:199], a[164:167], v[100:103]
    ds_read_b128 a[248:251], v220 offset:1104
    v_mfma_f32_16x16x32_bf16 v[100:103], a[192:195], a[160:163], v[100:103]
    v_exp_f32 v192, v96
    v_mfma_f32_16x16x32_bf16 v[104:107], a[192:195], v[64:67], v[216:219]
    s_add_u32 m0, s22, 4192
    ds_read_b128 a[252:255], v220 offset:1040
    v_mfma_f32_16x16x32_bf16 v[104:107], a[196:199], v[68:71], v[104:107]
    buffer_load_dwordx4 v223, s[8:11], s24 offen offset:2048 nt lds
    v_mfma_f32_16x16x32_bf16 v[104:107], a[200:203], v[72:75], v[104:107]
    v_exp_f32 v193, v97
    v_mfma_f32_16x16x32_bf16 v[104:107], a[204:207], v[76:79], v[104:107]
    v_exp_f32 v194, v98
    v_mfma_f32_16x16x32_bf16 v[104:107], a[208:211], v[80:83], v[104:107]
    s_add_u32 m0, s22, 12000
    v_add_f32 v203, v200, v192
    v_mfma_f32_16x16x32_bf16 v[104:107], a[212:215], v[84:87], v[104:107]
    buffer_load_dwordx4 v223, s[8:11], s24 offen offset:2560 nt lds
    v_mfma_f32_16x16x32_bf16 v[104:107], a[216:219], v[88:91], v[104:107]
    s_add_u32 s24, s24, 28672
    v_exp_f32 v195, v99
    v_mfma_f32_16x16x32_bf16 v[104:107], a[220:223], v[92:95], v[104:107]
    s_waitcnt lgkmcnt(0)
    v_exp_f32 v196, v100
    v_mfma_f32_16x16x32_bf16 v[116:119], a[224:227], v[92:95], v[216:219]
    v_exp_f32 v197, v101
    v_mfma_f32_16x16x32_bf16 v[116:119], a[228:231], v[88:91], v[116:119]
    v_exp_f32 v198, v102
    v_mfma_f32_16x16x32_bf16 v[116:119], a[232:235], v[84:87], v[116:119]
    ds_read_b128 a[192:195], v220 offset:16640
    v_cvt_pk_bf16_f32 v144, v192, v193
    v_mfma_f32_16x16x32_bf16 v[116:119], a[236:239], v[80:83], v[116:119]
    v_exp_f32 v199, v103
    v_mfma_f32_16x16x32_bf16 v[116:119], a[240:243], v[76:79], v[116:119]
    ds_read_b128 a[196:199], v220 offset:16704
    v_add_f32 v203, v203, v193
    v_mfma_f32_16x16x32_bf16 v[116:119], a[244:247], v[72:75], v[116:119]
    v_exp_f32 v192, v104
    v_mfma_f32_16x16x32_bf16 v[116:119], a[248:251], v[68:71], v[116:119]
    ds_read_b128 a[200:203], v220 offset:16768
    v_add_f32 v203, v203, v194
    v_mfma_f32_16x16x32_bf16 v[116:119], a[252:255], v[64:67], v[116:119]
    v_exp_f32 v193, v105
    v_mfma_f32_16x16x32_bf16 v[112:115], a[252:255], a[160:163], v[212:215]
    ds_read_b128 a[204:207], v220 offset:16832
    v_cvt_pk_bf16_f32 v145, v194, v195
    v_mfma_f32_16x16x32_bf16 v[112:115], a[248:251], a[164:167], v[112:115]
    v_exp_f32 v194, v106
    v_mfma_f32_16x16x32_bf16 v[112:115], a[244:247], a[168:171], v[112:115]
    ds_read_b128 a[208:211], v220 offset:16896
    v_add_f32 v203, v203, v195
    v_mfma_f32_16x16x32_bf16 v[112:115], a[240:243], a[172:175], v[112:115]
    v_exp_f32 v195, v107
    v_mfma_f32_16x16x32_bf16 v[112:115], a[236:239], a[176:179], v[112:115]
    ds_read_b128 a[212:215], v220 offset:16960
    v_add_f32 v204, v201, v196
    v_mfma_f32_16x16x32_bf16 v[112:115], a[232:235], a[180:183], v[112:115]
    v_cvt_pk_bf16_f32 v148, v196, v197
    v_add_f32 v204, v204, v197
    v_mfma_f32_16x16x32_bf16 v[112:115], a[228:231], a[184:187], v[112:115]
    ds_read_b128 a[216:219], v220 offset:17024
    v_add_f32 v204, v204, v198
    v_mfma_f32_16x16x32_bf16 v[112:115], a[224:227], a[188:191], v[112:115]
    v_exp_f32 v196, v116
    v_mfma_f32_16x16x32_bf16 v[108:111], a[224:227], a[156:159], v[208:211]
    ds_read_b128 a[220:223], v220 offset:17088
    v_cvt_pk_bf16_f32 v149, v198, v199
    v_mfma_f32_16x16x32_bf16 v[108:111], a[228:231], a[152:155], v[108:111]
    v_exp_f32 v197, v117
    v_mfma_f32_16x16x32_bf16 v[108:111], a[232:235], a[148:151], v[108:111]
    v_exp_f32 v198, v118
    v_mfma_f32_16x16x32_bf16 v[108:111], a[236:239], a[144:147], v[108:111]
    v_add_f32 v204, v204, v199
    v_add_f32 v205, v202, v192
    v_mfma_f32_16x16x32_bf16 v[108:111], a[240:243], a[140:143], v[108:111]
    v_exp_f32 v199, v119
    v_mfma_f32_16x16x32_bf16 v[108:111], a[244:247], a[136:139], v[108:111]
    v_cvt_pk_bf16_f32 v152, v192, v193
    v_add_f32 v205, v205, v193
    v_mfma_f32_16x16x32_bf16 v[108:111], a[248:251], a[132:135], v[108:111]
    ds_read_b128 a[224:227], v220 offset:18128
    v_add_f32 v205, v205, v194
    v_mfma_f32_16x16x32_bf16 v[108:111], a[252:255], a[128:131], v[108:111]
    s_waitcnt lgkmcnt(1)
    v_exp_f32 v192, v112
    v_mfma_f32_16x16x32_bf16 v[120:123], a[192:195], a[128:131], v[208:211]
    ds_read_b128 a[228:231], v220 offset:18064
    v_cvt_pk_bf16_f32 v153, v194, v195
    v_mfma_f32_16x16x32_bf16 v[120:123], a[196:199], a[132:135], v[120:123]
    v_exp_f32 v193, v113
    v_mfma_f32_16x16x32_bf16 v[120:123], a[200:203], a[136:139], v[120:123]
    ds_read_b128 a[232:235], v220 offset:18000
    v_add_f32 v205, v205, v195
    v_mfma_f32_16x16x32_bf16 v[120:123], a[204:207], a[140:143], v[120:123]
    v_exp_f32 v194, v114
    v_mfma_f32_16x16x32_bf16 v[120:123], a[208:211], a[144:147], v[120:123]
    ds_read_b128 a[236:239], v220 offset:17936
    v_add_f32 v205, v205, v196
    v_mfma_f32_16x16x32_bf16 v[120:123], a[212:215], a[148:151], v[120:123]
    v_exp_f32 v195, v115
    v_mfma_f32_16x16x32_bf16 v[120:123], a[216:219], a[152:155], v[120:123]
    ds_read_b128 a[240:243], v220 offset:17872
    v_cvt_pk_bf16_f32 v154, v196, v197
    v_mfma_f32_16x16x32_bf16 v[120:123], a[220:223], a[156:159], v[120:123]
    v_exp_f32 v196, v108
    v_mfma_f32_16x16x32_bf16 v[124:127], a[220:223], a[188:191], v[212:215]
    ds_read_b128 a[244:247], v220 offset:17808
    v_add_f32 v205, v205, v197
    v_mfma_f32_16x16x32_bf16 v[124:127], a[216:219], a[184:187], v[124:127]
    v_exp_f32 v197, v109
    v_mfma_f32_16x16x32_bf16 v[124:127], a[212:215], a[180:183], v[124:127]
    ds_read_b128 a[248:251], v220 offset:17744
    v_add_f32 v205, v205, v198
    v_mfma_f32_16x16x32_bf16 v[124:127], a[208:211], a[176:179], v[124:127]
    v_cvt_pk_bf16_f32 v155, v198, v199
    v_add_f32 v205, v205, v199
    v_mfma_f32_16x16x32_bf16 v[124:127], a[204:207], a[172:175], v[124:127]
    ds_read_b128 a[252:255], v220 offset:17680
    v_add_f32 v204, v204, v192
    v_mfma_f32_16x16x32_bf16 v[124:127], a[200:203], a[168:171], v[124:127]
    v_exp_f32 v198, v110
    v_mfma_f32_16x16x32_bf16 v[124:127], a[196:199], a[164:167], v[124:127]
    v_exp_f32 v199, v111
    v_mfma_f32_16x16x32_bf16 v[124:127], a[192:195], a[160:163], v[124:127]
    v_cvt_pk_bf16_f32 v150, v192, v193
    v_add_f32 v204, v204, v193
    v_mfma_f32_16x16x32_bf16 v[128:131], a[192:195], v[64:67], v[216:219]
    v_exp_f32 v192, v120
    v_mfma_f32_16x16x32_bf16 v[128:131], a[196:199], v[68:71], v[128:131]
    v_exp_f32 v193, v121
    v_mfma_f32_16x16x32_bf16 v[128:131], a[200:203], v[72:75], v[128:131]
    v_add_f32 v204, v204, v194
    v_cvt_pk_bf16_f32 v151, v194, v195
    v_mfma_f32_16x16x32_bf16 v[128:131], a[204:207], v[76:79], v[128:131]
    s_waitcnt vmcnt(8) lgkmcnt(0)
    v_exp_f32 v194, v122
    v_mfma_f32_16x16x32_bf16 v[128:131], a[208:211], v[80:83], v[128:131]
    s_barrier
    v_add_f32 v204, v204, v195
    v_mfma_f32_16x16x32_bf16 v[128:131], a[212:215], v[84:87], v[128:131]
    v_exp_f32 v195, v123
    v_mfma_f32_16x16x32_bf16 v[128:131], a[216:219], v[88:91], v[128:131]
    v_add_f32 v203, v203, v196
    v_cvt_pk_bf16_f32 v146, v196, v197
    v_mfma_f32_16x16x32_bf16 v[128:131], a[220:223], v[92:95], v[128:131]
    v_exp_f32 v196, v124
    v_mfma_f32_16x16x32_bf16 v[140:143], a[224:227], v[92:95], v[216:219]
    ds_read_b64_tr_b16 a[192:193], v221 offset:33280
    v_add_f32 v203, v203, v197
    v_mfma_f32_16x16x32_bf16 v[140:143], a[228:231], v[88:91], v[140:143]
    s_add_u32 m0, s22, 4294900736
    ds_read_b64_tr_b16 a[194:195], v221 offset:33792
    v_mfma_f32_16x16x32_bf16 v[140:143], a[232:235], v[84:87], v[140:143]
    buffer_load_dwordx4 v223, s[8:11], s24 offen offset:0 nt lds
    v_mfma_f32_16x16x32_bf16 v[140:143], a[236:239], v[80:83], v[140:143]
    ds_read_b64_tr_b16 a[196:197], v221 offset:49920
    v_add_f32 v203, v203, v198
    v_mfma_f32_16x16x32_bf16 v[140:143], a[240:243], v[76:79], v[140:143]
    ds_read_b64_tr_b16 a[198:199], v221 offset:50432
    v_cvt_pk_bf16_f32 v147, v198, v199
    v_mfma_f32_16x16x32_bf16 v[140:143], a[244:247], v[72:75], v[140:143]
    v_exp_f32 v197, v125
    v_mfma_f32_16x16x32_bf16 v[140:143], a[248:251], v[68:71], v[140:143]
    ds_read_b64_tr_b16 a[200:201], v221 offset:49952
    v_add_f32 v203, v203, v199
    v_mfma_f32_16x16x32_bf16 v[140:143], a[252:255], v[64:67], v[140:143]
    ds_read_b64_tr_b16 a[202:203], v221 offset:50464
    v_add_f32 v203, v203, v192
    v_mfma_f32_16x16x32_bf16 v[136:139], a[252:255], a[160:163], v[212:215]
    v_exp_f32 v198, v126
    v_mfma_f32_16x16x32_bf16 v[136:139], a[248:251], a[164:167], v[136:139]
    ds_read_b64_tr_b16 a[204:205], v221 offset:33312
    v_cvt_pk_bf16_f32 v156, v192, v193
    v_mfma_f32_16x16x32_bf16 v[136:139], a[244:247], a[168:171], v[136:139]
    s_add_u32 m0, s22, 4294908544
    ds_read_b64_tr_b16 a[206:207], v221 offset:33824
    v_mfma_f32_16x16x32_bf16 v[136:139], a[240:243], a[172:175], v[136:139]
    buffer_load_dwordx4 v223, s[8:11], s24 offen offset:512 nt lds
    v_mfma_f32_16x16x32_bf16 v[136:139], a[236:239], a[176:179], v[136:139]
    ds_read_b64_tr_b16 a[208:209], v221 offset:33344
    v_add_f32 v203, v203, v193
    v_mfma_f32_16x16x32_bf16 v[136:139], a[232:235], a[180:183], v[136:139]
    ds_read_b64_tr_b16 a[210:211], v221 offset:33856
    v_add_f32 v203, v203, v194
    v_mfma_f32_16x16x32_bf16 v[136:139], a[228:231], a[184:187], v[136:139]
    v_exp_f32 v199, v127
    v_mfma_f32_16x16x32_bf16 v[136:139], a[224:227], a[188:191], v[136:139]
    ds_read_b64_tr_b16 a[212:213], v221 offset:49984
    v_cvt_pk_bf16_f32 v157, v194, v195
    v_mfma_f32_16x16x32_bf16 v[132:135], a[224:227], a[156:159], v[208:211]
    ds_read_b64_tr_b16 a[214:215], v221 offset:50496
    v_add_f32 v203, v203, v195
    v_mfma_f32_16x16x32_bf16 v[132:135], a[228:231], a[152:155], v[132:135]
    v_exp_f32 v192, v128
    v_mfma_f32_16x16x32_bf16 v[132:135], a[232:235], a[148:151], v[132:135]
    ds_read_b64_tr_b16 a[216:217], v221 offset:50016
    v_add_f32 v204, v204, v196
    v_mfma_f32_16x16x32_bf16 v[132:135], a[236:239], a[144:147], v[132:135]
    s_add_u32 m0, s22, 4294900768
    ds_read_b64_tr_b16 a[218:219], v221 offset:50528
    v_mfma_f32_16x16x32_bf16 v[132:135], a[240:243], a[140:143], v[132:135]
    buffer_load_dwordx4 v223, s[8:11], s24 offen offset:2048 nt lds
    v_mfma_f32_16x16x32_bf16 v[132:135], a[244:247], a[136:139], v[132:135]
    ds_read_b64_tr_b16 a[220:221], v221 offset:33376
    v_cvt_pk_bf16_f32 v160, v196, v197
    v_mfma_f32_16x16x32_bf16 v[132:135], a[248:251], a[132:135], v[132:135]
    ds_read_b64_tr_b16 a[222:223], v221 offset:33888
    v_add_f32 v204, v204, v197
    v_mfma_f32_16x16x32_bf16 v[132:135], a[252:255], a[128:131], v[132:135]
    s_waitcnt lgkmcnt(4)
    v_exp_f32 v193, v129
    v_mfma_f32_16x16x32_bf16 v[0:3], v[168:171], a[192:195], v[0:3]
    ds_read_b128 a[224:227], v220 offset:33280
    v_add_f32 v204, v204, v198
    v_mfma_f32_16x16x32_bf16 v[0:3], v[180:183], a[196:199], v[0:3]
    v_exp_f32 v194, v130
    v_mfma_f32_16x16x32_bf16 v[4:7], v[184:187], a[196:199], v[4:7]
    v_exp_f32 v195, v131
    v_mfma_f32_16x16x32_bf16 v[4:7], v[172:175], a[192:195], v[4:7]
    ds_read_b128 a[228:231], v220 offset:33344
    v_cvt_pk_bf16_f32 v161, v198, v199
    v_mfma_f32_16x16x32_bf16 v[8:11], v[176:179], a[192:195], v[8:11]
    s_add_u32 m0, s22, 4294908576
    v_add_f32 v204, v204, v199
    v_mfma_f32_16x16x32_bf16 v[8:11], v[188:191], a[196:199], v[8:11]
    buffer_load_dwordx4 v223, s[8:11], s24 offen offset:2560 nt lds
    v_mfma_f32_16x16x32_bf16 v[20:23], v[188:191], a[200:203], v[20:23]
    s_add_u32 s24, s24, 4096
    ds_read_b128 a[232:235], v220 offset:33408
    v_add_f32 v205, v205, v192
    v_mfma_f32_16x16x32_bf16 v[20:23], v[176:179], a[204:207], v[20:23]
    v_exp_f32 v196, v140
    v_mfma_f32_16x16x32_bf16 v[16:19], v[172:175], a[204:207], v[16:19]
    v_exp_f32 v197, v141
    v_mfma_f32_16x16x32_bf16 v[16:19], v[184:187], a[200:203], v[16:19]
    ds_read_b128 a[236:239], v220 offset:33472
    v_cvt_pk_bf16_f32 v164, v192, v193
    v_mfma_f32_16x16x32_bf16 v[12:15], v[180:183], a[200:203], v[12:15]
    v_exp_f32 v198, v142
    v_mfma_f32_16x16x32_bf16 v[12:15], v[168:171], a[204:207], v[12:15]
    v_exp_f32 v199, v143
    v_mfma_f32_16x16x32_bf16 v[24:27], v[168:171], a[208:211], v[24:27]
    ds_read_b128 a[240:243], v220 offset:33536
    v_add_f32 v205, v205, v193
    v_mfma_f32_16x16x32_bf16 v[24:27], v[180:183], a[212:215], v[24:27]
    v_exp_f32 v192, v136
    v_mfma_f32_16x16x32_bf16 v[28:31], v[184:187], a[212:215], v[28:31]
    v_exp_f32 v193, v137
    v_mfma_f32_16x16x32_bf16 v[28:31], v[172:175], a[208:211], v[28:31]
    ds_read_b128 a[244:247], v220 offset:33600
    v_add_f32 v205, v205, v194
    v_mfma_f32_16x16x32_bf16 v[32:35], v[176:179], a[208:211], v[32:35]
    v_cvt_pk_bf16_f32 v165, v194, v195
    v_add_f32 v205, v205, v195
    v_mfma_f32_16x16x32_bf16 v[32:35], v[188:191], a[212:215], v[32:35]
    s_waitcnt lgkmcnt(2)
    ds_read_b128 a[248:251], v220 offset:33664
    v_add_f32 v205, v205, v196
    v_mfma_f32_16x16x32_bf16 v[44:47], v[188:191], a[216:219], v[44:47]
    v_exp_f32 v194, v138
    v_mfma_f32_16x16x32_bf16 v[44:47], v[176:179], a[220:223], v[44:47]
    v_exp_f32 v195, v139
    v_mfma_f32_16x16x32_bf16 v[40:43], v[172:175], a[220:223], v[40:43]
    ds_read_b128 a[252:255], v220 offset:33728
    v_cvt_pk_bf16_f32 v166, v196, v197
    v_mfma_f32_16x16x32_bf16 v[40:43], v[184:187], a[216:219], v[40:43]
    v_exp_f32 v196, v132
    v_mfma_f32_16x16x32_bf16 v[36:39], v[180:183], a[216:219], v[36:39]
    v_add_f32 v205, v205, v197
    v_add_f32 v205, v205, v198
    v_mfma_f32_16x16x32_bf16 v[36:39], v[168:171], a[220:223], v[36:39]
    v_exp_f32 v197, v133
    v_cvt_pk_bf16_f32 v167, v198, v199
    v_exp_f32 v198, v134
    v_add_f32 v205, v205, v199
    v_exp_f32 v199, v135
    v_add_f32 v204, v204, v192
    v_cvt_pk_bf16_f32 v162, v192, v193
    v_add_f32 v204, v204, v193
    v_add_f32 v204, v204, v194
    v_cvt_pk_bf16_f32 v163, v194, v195
    v_add_f32 v204, v204, v195
    v_add_f32 v203, v203, v196
    v_cvt_pk_bf16_f32 v158, v196, v197
    v_add_f32 v203, v203, v197
    v_add_f32 v203, v203, v198
    v_cvt_pk_bf16_f32 v159, v198, v199
    v_add_f32 v203, v203, v199
    v_max3_f32 v206, v203, v204, v205
    v_cmp_lt_f32 vcc, s27, v206
    s_nop 4
    s_cbranch_vccnz L_trf0
L_nosf0:
    v_mfma_f32_16x16x32_bf16 v[96:99], a[224:227], a[128:131], v[208:211]
    s_add_u32 m0, s22, 4294904896
    v_mfma_f32_16x16x32_bf16 v[96:99], a[228:231], a[132:135], v[96:99]
    buffer_load_dwordx4 v223, s[8:11], s24 offen offset:0 nt lds
    v_mfma_f32_16x16x32_bf16 v[96:99], a[232:235], a[136:139], v[96:99]
    ds_read_b128 a[192:195], v220 offset:34768
    v_mfma_f32_16x16x32_bf16 v[96:99], a[236:239], a[140:143], v[96:99]
    s_waitcnt lgkmcnt(1)
    v_mfma_f32_16x16x32_bf16 v[96:99], a[240:243], a[144:147], v[96:99]
    s_add_u32 m0, s22, 4294912704
    ds_read_b128 a[196:199], v220 offset:34704
    v_mfma_f32_16x16x32_bf16 v[96:99], a[244:247], a[148:151], v[96:99]
    buffer_load_dwordx4 v223, s[8:11], s24 offen offset:512 nt lds
    v_mfma_f32_16x16x32_bf16 v[96:99], a[248:251], a[152:155], v[96:99]
    ds_read_b128 a[200:203], v220 offset:34640
    v_mfma_f32_16x16x32_bf16 v[96:99], a[252:255], a[156:159], v[96:99]
    v_mfma_f32_16x16x32_bf16 v[100:103], a[252:255], a[188:191], v[212:215]
    s_add_u32 m0, s22, 4294904928
    ds_read_b128 a[204:207], v220 offset:34576
    v_mfma_f32_16x16x32_bf16 v[100:103], a[248:251], a[184:187], v[100:103]
    buffer_load_dwordx4 v223, s[8:11], s24 offen offset:2048 nt lds
    v_mfma_f32_16x16x32_bf16 v[100:103], a[244:247], a[180:183], v[100:103]
    ds_read_b128 a[208:211], v220 offset:34512
    v_mfma_f32_16x16x32_bf16 v[100:103], a[240:243], a[176:179], v[100:103]
    v_mfma_f32_16x16x32_bf16 v[100:103], a[236:239], a[172:175], v[100:103]
    s_add_u32 m0, s22, 4294912736
    ds_read_b128 a[212:215], v220 offset:34448
    v_mfma_f32_16x16x32_bf16 v[100:103], a[232:235], a[168:171], v[100:103]
    buffer_load_dwordx4 v223, s[8:11], s24 offen offset:2560 nt lds
    v_mfma_f32_16x16x32_bf16 v[100:103], a[228:231], a[164:167], v[100:103]
    s_add_u32 s24, s24, 28672
    ds_read_b128 a[216:219], v220 offset:34384
    v_mfma_f32_16x16x32_bf16 v[100:103], a[224:227], a[160:163], v[100:103]
    v_exp_f32 v192, v96
    v_mfma_f32_16x16x32_bf16 v[104:107], a[224:227], v[64:67], v[216:219]
    ds_read_b128 a[220:223], v220 offset:34320
    v_add_f32 v200, v203, v192
    v_mfma_f32_16x16x32_bf16 v[104:107], a[228:231], v[68:71], v[104:107]
    v_exp_f32 v193, v97
    v_mfma_f32_16x16x32_bf16 v[104:107], a[232:235], v[72:75], v[104:107]
    v_exp_f32 v194, v98
    v_mfma_f32_16x16x32_bf16 v[104:107], a[236:239], v[76:79], v[104:107]
    v_exp_f32 v195, v99
    v_mfma_f32_16x16x32_bf16 v[104:107], a[240:243], v[80:83], v[104:107]
    v_exp_f32 v196, v100
    v_mfma_f32_16x16x32_bf16 v[104:107], a[244:247], v[84:87], v[104:107]
    v_exp_f32 v197, v101
    v_mfma_f32_16x16x32_bf16 v[104:107], a[248:251], v[88:91], v[104:107]
    v_exp_f32 v198, v102
    v_mfma_f32_16x16x32_bf16 v[104:107], a[252:255], v[92:95], v[104:107]
    s_waitcnt lgkmcnt(0)
    v_exp_f32 v199, v103
    v_mfma_f32_16x16x32_bf16 v[116:119], a[192:195], v[92:95], v[216:219]
    v_cvt_pk_bf16_f32 v228, v192, v193
    v_add_f32 v200, v200, v193
    v_mfma_f32_16x16x32_bf16 v[116:119], a[196:199], v[88:91], v[116:119]
    v_add_f32 v200, v200, v194
    v_cvt_pk_bf16_f32 v229, v194, v195
    v_mfma_f32_16x16x32_bf16 v[116:119], a[200:203], v[84:87], v[116:119]
    ds_read_b128 a[224:227], v220 offset:49920
    v_add_f32 v200, v200, v195
    v_mfma_f32_16x16x32_bf16 v[116:119], a[204:207], v[80:83], v[116:119]
    v_add_f32 v201, v204, v196
    v_cvt_pk_bf16_f32 v232, v196, v197
    v_mfma_f32_16x16x32_bf16 v[116:119], a[208:211], v[76:79], v[116:119]
    ds_read_b128 a[228:231], v220 offset:49984
    v_add_f32 v201, v201, v197
    v_mfma_f32_16x16x32_bf16 v[116:119], a[212:215], v[72:75], v[116:119]
    v_exp_f32 v192, v104
    v_mfma_f32_16x16x32_bf16 v[116:119], a[216:219], v[68:71], v[116:119]
    ds_read_b128 a[232:235], v220 offset:50048
    v_add_f32 v201, v201, v198
    v_mfma_f32_16x16x32_bf16 v[116:119], a[220:223], v[64:67], v[116:119]
    v_exp_f32 v193, v105
    v_mfma_f32_16x16x32_bf16 v[112:115], a[220:223], a[160:163], v[212:215]
    ds_read_b128 a[236:239], v220 offset:50112
    v_cvt_pk_bf16_f32 v233, v198, v199
    v_mfma_f32_16x16x32_bf16 v[112:115], a[216:219], a[164:167], v[112:115]
    v_exp_f32 v194, v106
    v_mfma_f32_16x16x32_bf16 v[112:115], a[212:215], a[168:171], v[112:115]
    ds_read_b128 a[240:243], v220 offset:50176
    v_add_f32 v201, v201, v199
    v_mfma_f32_16x16x32_bf16 v[112:115], a[208:211], a[172:175], v[112:115]
    v_exp_f32 v195, v107
    v_mfma_f32_16x16x32_bf16 v[112:115], a[204:207], a[176:179], v[112:115]
    ds_read_b128 a[244:247], v220 offset:50240
    v_add_f32 v202, v205, v192
    v_mfma_f32_16x16x32_bf16 v[112:115], a[200:203], a[180:183], v[112:115]
    v_exp_f32 v196, v116
    v_mfma_f32_16x16x32_bf16 v[112:115], a[196:199], a[184:187], v[112:115]
    ds_read_b128 a[248:251], v220 offset:50304
    v_cvt_pk_bf16_f32 v236, v192, v193
    v_mfma_f32_16x16x32_bf16 v[112:115], a[192:195], a[188:191], v[112:115]
    v_exp_f32 v197, v117
    v_mfma_f32_16x16x32_bf16 v[108:111], a[192:195], a[156:159], v[208:211]
    ds_read_b128 a[252:255], v220 offset:50368
    v_add_f32 v202, v202, v193
    v_mfma_f32_16x16x32_bf16 v[108:111], a[196:199], a[152:155], v[108:111]
    v_exp_f32 v198, v118
    v_mfma_f32_16x16x32_bf16 v[108:111], a[200:203], a[148:151], v[108:111]
    v_exp_f32 v199, v119
    v_mfma_f32_16x16x32_bf16 v[108:111], a[204:207], a[144:147], v[108:111]
    v_add_f32 v202, v202, v194
    v_cvt_pk_bf16_f32 v237, v194, v195
    v_mfma_f32_16x16x32_bf16 v[108:111], a[208:211], a[140:143], v[108:111]
    v_exp_f32 v192, v112
    v_mfma_f32_16x16x32_bf16 v[108:111], a[212:215], a[136:139], v[108:111]
    v_exp_f32 v193, v113
    v_mfma_f32_16x16x32_bf16 v[108:111], a[216:219], a[132:135], v[108:111]
    ds_read_b128 a[192:195], v220 offset:51408
    v_add_f32 v202, v202, v195
    v_mfma_f32_16x16x32_bf16 v[108:111], a[220:223], a[128:131], v[108:111]
    s_waitcnt lgkmcnt(1)
    v_exp_f32 v194, v114
    v_mfma_f32_16x16x32_bf16 v[120:123], a[224:227], a[128:131], v[208:211]
    ds_read_b128 a[196:199], v220 offset:51344
    v_add_f32 v202, v202, v196
    v_mfma_f32_16x16x32_bf16 v[120:123], a[228:231], a[132:135], v[120:123]
    v_exp_f32 v195, v115
    v_mfma_f32_16x16x32_bf16 v[120:123], a[232:235], a[136:139], v[120:123]
    ds_read_b128 a[200:203], v220 offset:51280
    v_cvt_pk_bf16_f32 v238, v196, v197
    v_mfma_f32_16x16x32_bf16 v[120:123], a[236:239], a[140:143], v[120:123]
    v_add_f32 v202, v202, v197
    v_add_f32 v202, v202, v198
    v_mfma_f32_16x16x32_bf16 v[120:123], a[240:243], a[144:147], v[120:123]
    ds_read_b128 a[204:207], v220 offset:51216
    v_cvt_pk_bf16_f32 v239, v198, v199
    v_mfma_f32_16x16x32_bf16 v[120:123], a[244:247], a[148:151], v[120:123]
    v_exp_f32 v196, v108
    v_mfma_f32_16x16x32_bf16 v[120:123], a[248:251], a[152:155], v[120:123]
    ds_read_b128 a[208:211], v220 offset:51152
    v_add_f32 v202, v202, v199
    v_mfma_f32_16x16x32_bf16 v[120:123], a[252:255], a[156:159], v[120:123]
    v_exp_f32 v197, v109
    v_mfma_f32_16x16x32_bf16 v[124:127], a[252:255], a[188:191], v[212:215]
    ds_read_b128 a[212:215], v220 offset:51088
    v_add_f32 v201, v201, v192
    v_mfma_f32_16x16x32_bf16 v[124:127], a[248:251], a[184:187], v[124:127]
    v_exp_f32 v198, v110
    v_mfma_f32_16x16x32_bf16 v[124:127], a[244:247], a[180:183], v[124:127]
    ds_read_b128 a[216:219], v220 offset:51024
    v_cvt_pk_bf16_f32 v234, v192, v193
    v_mfma_f32_16x16x32_bf16 v[124:127], a[240:243], a[176:179], v[124:127]
    v_exp_f32 v199, v111
    v_mfma_f32_16x16x32_bf16 v[124:127], a[236:239], a[172:175], v[124:127]
    ds_read_b128 a[220:223], v220 offset:50960
    v_add_f32 v201, v201, v193
    v_mfma_f32_16x16x32_bf16 v[124:127], a[232:235], a[168:171], v[124:127]
    v_exp_f32 v192, v120
    v_mfma_f32_16x16x32_bf16 v[124:127], a[228:231], a[164:167], v[124:127]
    v_exp_f32 v193, v121
    v_mfma_f32_16x16x32_bf16 v[124:127], a[224:227], a[160:163], v[124:127]
    v_add_f32 v201, v201, v194
    v_cvt_pk_bf16_f32 v235, v194, v195
    v_mfma_f32_16x16x32_bf16 v[128:131], a[224:227], v[64:67], v[216:219]
    v_exp_f32 v194, v122
    v_mfma_f32_16x16x32_bf16 v[128:131], a[228:231], v[68:71], v[128:131]
    v_add_f32 v201, v201, v195
    v_add_f32 v200, v200, v196
    v_mfma_f32_16x16x32_bf16 v[128:131], a[232:235], v[72:75], v[128:131]
    v_exp_f32 v195, v123
    v_mfma_f32_16x16x32_bf16 v[128:131], a[236:239], v[76:79], v[128:131]
    s_waitcnt vmcnt(0) lgkmcnt(0)
    v_cvt_pk_bf16_f32 v230, v196, v197
    v_add_f32 v200, v200, v197
    v_mfma_f32_16x16x32_bf16 v[128:131], a[240:243], v[80:83], v[128:131]
    s_barrier
    v_add_f32 v200, v200, v198
    v_mfma_f32_16x16x32_bf16 v[128:131], a[244:247], v[84:87], v[128:131]
    v_exp_f32 v196, v124
    v_mfma_f32_16x16x32_bf16 v[128:131], a[248:251], v[88:91], v[128:131]
    v_exp_f32 v197, v125
    v_mfma_f32_16x16x32_bf16 v[128:131], a[252:255], v[92:95], v[128:131]
    v_cvt_pk_bf16_f32 v231, v198, v199
    v_add_f32 v200, v200, v199
    v_mfma_f32_16x16x32_bf16 v[140:143], a[192:195], v[92:95], v[216:219]
    ds_read_b64_tr_b16 a[224:225], v221 offset:0
    v_add_f32 v200, v200, v192
    v_mfma_f32_16x16x32_bf16 v[140:143], a[196:199], v[88:91], v[140:143]
    ds_read_b64_tr_b16 a[226:227], v221 offset:512
    v_cvt_pk_bf16_f32 v240, v192, v193
    v_mfma_f32_16x16x32_bf16 v[140:143], a[200:203], v[84:87], v[140:143]
    v_exp_f32 v198, v126
    v_mfma_f32_16x16x32_bf16 v[140:143], a[204:207], v[80:83], v[140:143]
    ds_read_b64_tr_b16 a[228:229], v221 offset:16640
    v_add_f32 v200, v200, v193
    v_mfma_f32_16x16x32_bf16 v[140:143], a[208:211], v[76:79], v[140:143]
    ds_read_b64_tr_b16 a[230:231], v221 offset:17152
    v_add_f32 v200, v200, v194
    v_mfma_f32_16x16x32_bf16 v[140:143], a[212:215], v[72:75], v[140:143]
    v_exp_f32 v199, v127
    v_mfma_f32_16x16x32_bf16 v[140:143], a[216:219], v[68:71], v[140:143]
    ds_read_b64_tr_b16 a[232:233], v221 offset:16672
    v_cvt_pk_bf16_f32 v241, v194, v195
    v_mfma_f32_16x16x32_bf16 v[140:143], a[220:223], v[64:67], v[140:143]
    ds_read_b64_tr_b16 a[234:235], v221 offset:17184
    v_add_f32 v200, v200, v195
    v_mfma_f32_16x16x32_bf16 v[136:139], a[220:223], a[160:163], v[212:215]
    v_exp_f32 v192, v128
    v_mfma_f32_16x16x32_bf16 v[136:139], a[216:219], a[164:167], v[136:139]
    ds_read_b64_tr_b16 a[236:237], v221 offset:32
    v_add_f32 v201, v201, v196
    v_mfma_f32_16x16x32_bf16 v[136:139], a[212:215], a[168:171], v[136:139]
    ds_read_b64_tr_b16 a[238:239], v221 offset:544
    v_cvt_pk_bf16_f32 v244, v196, v197
    v_mfma_f32_16x16x32_bf16 v[136:139], a[208:211], a[172:175], v[136:139]
    v_exp_f32 v193, v129
    v_mfma_f32_16x16x32_bf16 v[136:139], a[204:207], a[176:179], v[136:139]
    ds_read_b64_tr_b16 a[240:241], v221 offset:64
    v_add_f32 v201, v201, v197
    v_mfma_f32_16x16x32_bf16 v[136:139], a[200:203], a[180:183], v[136:139]
    ds_read_b64_tr_b16 a[242:243], v221 offset:576
    v_add_f32 v201, v201, v198
    v_mfma_f32_16x16x32_bf16 v[136:139], a[196:199], a[184:187], v[136:139]
    v_exp_f32 v194, v130
    v_mfma_f32_16x16x32_bf16 v[136:139], a[192:195], a[188:191], v[136:139]
    ds_read_b64_tr_b16 a[244:245], v221 offset:16704
    v_cvt_pk_bf16_f32 v245, v198, v199
    v_mfma_f32_16x16x32_bf16 v[132:135], a[192:195], a[156:159], v[208:211]
    ds_read_b64_tr_b16 a[246:247], v221 offset:17216
    v_add_f32 v201, v201, v199
    v_mfma_f32_16x16x32_bf16 v[132:135], a[196:199], a[152:155], v[132:135]
    v_exp_f32 v195, v131
    v_mfma_f32_16x16x32_bf16 v[132:135], a[200:203], a[148:151], v[132:135]
    ds_read_b64_tr_b16 a[248:249], v221 offset:16736
    v_add_f32 v202, v202, v192
    v_mfma_f32_16x16x32_bf16 v[132:135], a[204:207], a[144:147], v[132:135]
    ds_read_b64_tr_b16 a[250:251], v221 offset:17248
    v_cvt_pk_bf16_f32 v248, v192, v193
    v_mfma_f32_16x16x32_bf16 v[132:135], a[208:211], a[140:143], v[132:135]
    v_exp_f32 v196, v140
    v_mfma_f32_16x16x32_bf16 v[132:135], a[212:215], a[136:139], v[132:135]
    ds_read_b64_tr_b16 a[252:253], v221 offset:96
    v_add_f32 v202, v202, v193
    v_mfma_f32_16x16x32_bf16 v[132:135], a[216:219], a[132:135], v[132:135]
    ds_read_b64_tr_b16 a[254:255], v221 offset:608
    v_add_f32 v202, v202, v194
    v_mfma_f32_16x16x32_bf16 v[132:135], a[220:223], a[128:131], v[132:135]
    s_waitcnt lgkmcnt(4)
    v_exp_f32 v197, v141
    v_mfma_f32_16x16x32_bf16 v[0:3], v[144:147], a[224:227], v[0:3]
    ds_read_b64_tr_b16 a[192:193], v207 offset:0
    v_cvt_pk_bf16_f32 v249, v194, v195
    v_mfma_f32_16x16x32_bf16 v[0:3], v[156:159], a[228:231], v[0:3]
    ds_read_b64_tr_b16 a[194:195], v207 offset:512
    v_add_f32 v202, v202, v195
    v_mfma_f32_16x16x32_bf16 v[4:7], v[160:163], a[228:231], v[4:7]
    v_exp_f32 v198, v142
    v_mfma_f32_16x16x32_bf16 v[4:7], v[148:151], a[224:227], v[4:7]
    ds_read_b64_tr_b16 a[196:197], v207 offset:16640
    v_add_f32 v202, v202, v196
    v_mfma_f32_16x16x32_bf16 v[8:11], v[152:155], a[224:227], v[8:11]
    ds_read_b64_tr_b16 a[198:199], v207 offset:17152
    v_cvt_pk_bf16_f32 v250, v196, v197
    v_mfma_f32_16x16x32_bf16 v[8:11], v[164:167], a[228:231], v[8:11]
    v_exp_f32 v199, v143
    v_mfma_f32_16x16x32_bf16 v[20:23], v[164:167], a[232:235], v[20:23]
    ds_read_b64_tr_b16 a[200:201], v207 offset:16672
    v_add_f32 v202, v202, v197
    v_mfma_f32_16x16x32_bf16 v[20:23], v[152:155], a[236:239], v[20:23]
    ds_read_b64_tr_b16 a[202:203], v207 offset:17184
    v_add_f32 v202, v202, v198
    v_mfma_f32_16x16x32_bf16 v[16:19], v[148:151], a[236:239], v[16:19]
    v_exp_f32 v192, v136
    v_mfma_f32_16x16x32_bf16 v[16:19], v[160:163], a[232:235], v[16:19]
    ds_read_b64_tr_b16 a[204:205], v207 offset:32
    v_cvt_pk_bf16_f32 v251, v198, v199
    v_mfma_f32_16x16x32_bf16 v[12:15], v[156:159], a[232:235], v[12:15]
    ds_read_b64_tr_b16 a[206:207], v207 offset:544
    v_add_f32 v202, v202, v199
    v_mfma_f32_16x16x32_bf16 v[12:15], v[144:147], a[236:239], v[12:15]
    v_exp_f32 v193, v137
    v_mfma_f32_16x16x32_bf16 v[24:27], v[144:147], a[240:243], v[24:27]
    ds_read_b64_tr_b16 a[208:209], v207 offset:64
    v_add_f32 v201, v201, v192
    v_mfma_f32_16x16x32_bf16 v[24:27], v[156:159], a[244:247], v[24:27]
    ds_read_b64_tr_b16 a[210:211], v207 offset:576
    v_cvt_pk_bf16_f32 v246, v192, v193
    v_mfma_f32_16x16x32_bf16 v[28:31], v[160:163], a[244:247], v[28:31]
    v_exp_f32 v194, v138
    v_mfma_f32_16x16x32_bf16 v[28:31], v[148:151], a[240:243], v[28:31]
    ds_read_b64_tr_b16 a[212:213], v207 offset:16704
    v_add_f32 v201, v201, v193
    v_mfma_f32_16x16x32_bf16 v[32:35], v[152:155], a[240:243], v[32:35]
    ds_read_b64_tr_b16 a[214:215], v207 offset:17216
    v_add_f32 v201, v201, v194
    v_mfma_f32_16x16x32_bf16 v[32:35], v[164:167], a[244:247], v[32:35]
    s_waitcnt lgkmcnt(4)
    v_exp_f32 v195, v139
    v_mfma_f32_16x16x32_bf16 v[44:47], v[164:167], a[248:251], v[44:47]
    ds_read_b64_tr_b16 a[216:217], v207 offset:16736
    v_cvt_pk_bf16_f32 v247, v194, v195
    v_mfma_f32_16x16x32_bf16 v[44:47], v[152:155], a[252:255], v[44:47]
    ds_read_b64_tr_b16 a[218:219], v207 offset:17248
    v_add_f32 v201, v201, v195
    v_mfma_f32_16x16x32_bf16 v[40:43], v[148:151], a[252:255], v[40:43]
    v_exp_f32 v196, v132
    v_mfma_f32_16x16x32_bf16 v[40:43], v[160:163], a[248:251], v[40:43]
    ds_read_b64_tr_b16 a[220:221], v207 offset:96
    v_add_f32 v200, v200, v196
    v_mfma_f32_16x16x32_bf16 v[36:39], v[156:159], a[248:251], v[36:39]
    ds_read_b64_tr_b16 a[222:223], v207 offset:608
    v_mfma_f32_16x16x32_bf16 v[36:39], v[144:147], a[252:255], v[36:39]
    v_exp_f32 v197, v133
    v_exp_f32 v198, v134
    v_exp_f32 v199, v135
    v_cvt_pk_bf16_f32 v242, v196, v197
    v_add_f32 v200, v200, v197
    v_add_f32 v200, v200, v198
    v_cvt_pk_bf16_f32 v243, v198, v199
    v_add_f32 v200, v200, v199
    v_max3_f32 v206, v200, v201, v202
    v_cmp_lt_f32 vcc, s27, v206
    s_nop 4
    s_cbranch_vccnz L_trf1
L_nosf1:
    v_mfma_f32_16x16x32_bf16 v[0:3], v[228:231], a[192:195], v[0:3]
    ds_read_b64_tr_b16 a[224:225], v221 offset:33408
    v_mov_b32 v192, v200
    v_mov_b32 v193, v201
    v_mov_b32 v194, v202
    v_mfma_f32_16x16x32_bf16 v[0:3], v[240:243], a[196:199], v[0:3]
    ds_read_b64_tr_b16 a[226:227], v221 offset:33920
    v_permlane32_swap_b32 v200, v192
    v_permlane32_swap_b32 v201, v193
    v_permlane32_swap_b32 v202, v194
    v_mfma_f32_16x16x32_bf16 v[12:15], v[240:243], a[200:203], v[12:15]
    ds_read_b64_tr_b16 a[228:229], v221 offset:50048
    v_add_f32 v200, v200, v192
    v_add_f32 v201, v201, v193
    v_add_f32 v202, v202, v194
    v_mfma_f32_16x16x32_bf16 v[12:15], v[228:231], a[204:207], v[12:15]
    s_waitcnt lgkmcnt(5)
    ds_read_b64_tr_b16 a[230:231], v221 offset:50560
    v_mov_b32 v192, v200
    v_mov_b32 v193, v201
    v_mov_b32 v194, v202
    v_mfma_f32_16x16x32_bf16 v[24:27], v[228:231], a[208:211], v[24:27]
    ds_read_b64_tr_b16 a[232:233], v221 offset:50080
    ds_write2_b32 v224, v0, v1 offset0:0 offset1:68
    v_permlane16_swap_b32 v200, v192
    v_mfma_f32_16x16x32_bf16 v[24:27], v[240:243], a[212:215], v[24:27]
    ds_read_b64_tr_b16 a[234:235], v221 offset:50592
    ds_write2_b32 v224, v2, v3 offset0:136 offset1:204
    v_permlane16_swap_b32 v201, v193
    v_mfma_f32_16x16x32_bf16 v[36:39], v[240:243], a[216:219], v[36:39]
    s_waitcnt lgkmcnt(8)
    ds_read_b64_tr_b16 a[236:237], v221 offset:33440
    ds_write2_b32 v224, v12, v13 offset0:16 offset1:84
    v_permlane16_swap_b32 v202, v194
    v_mfma_f32_16x16x32_bf16 v[36:39], v[228:231], a[220:223], v[36:39]
    ds_read_b64_tr_b16 a[238:239], v221 offset:33952
    ds_write2_b32 v224, v14, v15 offset0:152 offset1:220
    v_add_f32 v200, v200, v192
    v_mfma_f32_16x16x32_bf16 v[40:43], v[232:235], a[220:223], v[40:43]
    ds_read_b64_tr_b16 a[240:241], v221 offset:33472
    ds_write2_b32 v224, v24, v25 offset0:32 offset1:100
    v_add_f32 v201, v201, v193
    v_mfma_f32_16x16x32_bf16 v[40:43], v[244:247], a[216:219], v[40:43]
    ds_read_b64_tr_b16 a[242:243], v221 offset:33984
    ds_write2_b32 v224, v26, v27 offset0:168 offset1:236
    v_add_f32 v202, v202, v194
    v_mfma_f32_16x16x32_bf16 v[28:31], v[244:247], a[212:215], v[28:31]
    ds_read_b64_tr_b16 a[244:245], v221 offset:50112
    ds_write2_b32 v224, v36, v37 offset0:48 offset1:116
    v_rcp_f32 v203, v200
    v_mfma_f32_16x16x32_bf16 v[28:31], v[232:235], a[208:211], v[28:31]
    ds_read_b64_tr_b16 a[246:247], v221 offset:50624
    ds_write2_b32 v224, v38, v39 offset0:184 offset1:252
    v_rcp_f32 v204, v201
    v_mfma_f32_16x16x32_bf16 v[16:19], v[232:235], a[204:207], v[16:19]
    ds_read_b64_tr_b16 a[248:249], v221 offset:50144
    v_rcp_f32 v205, v202
    v_lshrrev_b32 v254, 7, v222
    v_lshlrev_b32 v254, 2, v254
    v_mfma_f32_16x16x32_bf16 v[16:19], v[244:247], a[200:203], v[16:19]
    ds_read_b64_tr_b16 a[250:251], v221 offset:50656
    ds_bpermute_b32 v208, v254, v203 offset:0
    ds_bpermute_b32 v209, v254, v203 offset:32
    v_mfma_f32_16x16x32_bf16 v[4:7], v[244:247], a[196:199], v[4:7]
    ds_read_b64_tr_b16 a[252:253], v221 offset:33504
    ds_read_b128 v[64:67], v225 offset:0
    ds_read_b128 v[68:71], v225 offset:16
    v_mfma_f32_16x16x32_bf16 v[4:7], v[232:235], a[192:195], v[4:7]
    ds_read_b64_tr_b16 a[254:255], v221 offset:34016
    ds_read_b128 v[76:79], v225 offset:2176
    ds_read_b128 v[80:83], v225 offset:2192
    v_mfma_f32_16x16x32_bf16 v[8:11], v[236:239], a[192:195], v[8:11]
    ds_read_b64_tr_b16 a[192:193], v221 offset:128
    ds_bpermute_b32 v210, v254, v204 offset:0
    ds_bpermute_b32 v211, v254, v204 offset:32
    v_mfma_f32_16x16x32_bf16 v[8:11], v[248:251], a[196:199], v[8:11]
    ds_read_b64_tr_b16 a[194:195], v221 offset:640
    ds_write2_b32 v224, v40, v41 offset0:48 offset1:116
    v_mfma_f32_16x16x32_bf16 v[20:23], v[248:251], a[200:203], v[20:23]
    ds_read_b64_tr_b16 a[196:197], v221 offset:16768
    s_waitcnt lgkmcnt(9)
    v_mul_f32 v64, v64, v208
    v_mul_f32 v65, v65, v208
    v_mul_f32 v66, v66, v208
    v_mfma_f32_16x16x32_bf16 v[20:23], v[236:239], a[204:207], v[20:23]
    ds_read_b64_tr_b16 a[198:199], v221 offset:17280
    v_mul_f32 v67, v67, v208
    v_mul_f32 v68, v68, v208
    v_mul_f32 v69, v69, v208
    v_mfma_f32_16x16x32_bf16 v[32:35], v[236:239], a[208:211], v[32:35]
    ds_read_b64_tr_b16 a[200:201], v207 offset:128
    v_mul_f32 v70, v70, v208
    v_mul_f32 v71, v71, v208
    v_cvt_pk_bf16_f32 v72, v64, v65
    v_mfma_f32_16x16x32_bf16 v[32:35], v[248:251], a[212:215], v[32:35]
    ds_read_b64_tr_b16 a[202:203], v207 offset:640
    v_cvt_pk_bf16_f32 v73, v66, v67
    v_cvt_pk_bf16_f32 v74, v68, v69
    v_cvt_pk_bf16_f32 v75, v70, v71
    v_mfma_f32_16x16x32_bf16 v[44:47], v[248:251], a[216:219], v[44:47]
    ds_read_b64_tr_b16 a[204:205], v207 offset:16768
    buffer_store_dwordx4 v[72:75], v226, s[16:19], 0 offen offset:0 sc1 nt
    s_waitcnt lgkmcnt(10)
    v_mul_f32 v76, v76, v209
    v_mfma_f32_16x16x32_bf16 v[44:47], v[236:239], a[220:223], v[44:47]
    ds_read_b64_tr_b16 a[206:207], v207 offset:17280
    ds_write2_b32 v224, v42, v43 offset0:184 offset1:252
    v_mul_f32 v77, v77, v209
    v_mfma_f32_16x16x32_bf16 v[48:51], v[168:171], a[224:227], v[48:51]
    ds_read_b64_tr_b16 a[208:209], v207 offset:16800
    ds_write2_b32 v224, v28, v29 offset0:32 offset1:100
    v_mul_f32 v78, v78, v209
    v_mfma_f32_16x16x32_bf16 v[48:51], v[180:183], a[228:231], v[48:51]
    ds_read_b64_tr_b16 a[210:211], v207 offset:17312
    ds_write2_b32 v224, v30, v31 offset0:168 offset1:236
    v_mul_f32 v79, v79, v209
    v_mfma_f32_16x16x32_bf16 v[52:55], v[184:187], a[228:231], v[52:55]
    ds_read_b64_tr_b16 a[212:213], v207 offset:160
    ds_write2_b32 v224, v16, v17 offset0:16 offset1:84
    v_mul_f32 v80, v80, v209
    v_mfma_f32_16x16x32_bf16 v[52:55], v[172:175], a[224:227], v[52:55]
    ds_read_b64_tr_b16 a[214:215], v207 offset:672
    ds_write2_b32 v224, v18, v19 offset0:152 offset1:220
    v_mul_f32 v81, v81, v209
    v_mfma_f32_16x16x32_bf16 v[56:59], v[176:179], a[224:227], v[56:59]
    ds_read_b64_tr_b16 a[216:217], v221 offset:16800
    ds_write2_b32 v224, v4, v5 offset0:0 offset1:68
    v_mul_f32 v82, v82, v209
    v_mfma_f32_16x16x32_bf16 v[56:59], v[188:191], a[228:231], v[56:59]
    ds_read_b64_tr_b16 a[218:219], v221 offset:17312
    ds_write2_b32 v224, v6, v7 offset0:136 offset1:204
    v_mul_f32 v83, v83, v209
    v_mfma_f32_16x16x32_bf16 a[4:7], v[188:191], a[232:235], a[4:7]
    ds_read_b64_tr_b16 a[220:221], v221 offset:160
    ds_read_b128 v[88:91], v225 offset:0
    ds_read_b128 v[92:95], v225 offset:16
    v_cvt_pk_bf16_f32 v84, v76, v77
    v_mfma_f32_16x16x32_bf16 a[4:7], v[176:179], a[236:239], a[4:7]
    ds_read_b64_tr_b16 a[222:223], v221 offset:672
    ds_read_b128 v[100:103], v225 offset:2176
    ds_read_b128 v[104:107], v225 offset:2192
    v_cvt_pk_bf16_f32 v85, v78, v79
    v_mfma_f32_16x16x32_bf16 a[0:3], v[172:175], a[236:239], a[0:3]
    ds_read_b64_tr_b16 a[224:225], v221 offset:192
    ds_bpermute_b32 v212, v254, v205 offset:0
    v_cvt_pk_bf16_f32 v86, v80, v81
    v_mfma_f32_16x16x32_bf16 a[0:3], v[184:187], a[232:235], a[0:3]
    ds_read_b64_tr_b16 a[226:227], v221 offset:704
    ds_bpermute_b32 v213, v254, v205 offset:32
    v_cvt_pk_bf16_f32 v87, v82, v83
    v_mfma_f32_16x16x32_bf16 v[60:63], v[180:183], a[232:235], v[60:63]
    ds_read_b64_tr_b16 a[228:229], v221 offset:16832
    buffer_store_dwordx4 v[84:87], v227, s[16:19], 0 offen offset:0 sc1 nt
    s_waitcnt lgkmcnt(8)
    v_mul_f32 v88, v88, v210
    v_mfma_f32_16x16x32_bf16 v[60:63], v[168:171], a[236:239], v[60:63]
    ds_read_b64_tr_b16 a[230:231], v221 offset:17344
    v_mul_f32 v89, v89, v210
    v_mul_f32 v90, v90, v210
    v_mfma_f32_16x16x32_bf16 a[8:11], v[168:171], a[240:243], a[8:11]
    ds_read_b64_tr_b16 a[232:233], v207 offset:192
    v_mul_f32 v91, v91, v210
    v_mul_f32 v92, v92, v210
    v_mfma_f32_16x16x32_bf16 a[8:11], v[180:183], a[244:247], a[8:11]
    ds_read_b64_tr_b16 a[234:235], v207 offset:704
    v_mul_f32 v93, v93, v210
    v_mul_f32 v94, v94, v210
    v_mfma_f32_16x16x32_bf16 a[12:15], v[184:187], a[244:247], a[12:15]
    ds_read_b64_tr_b16 a[236:237], v207 offset:16832
    v_mul_f32 v95, v95, v210
    v_cvt_pk_bf16_f32 v96, v88, v89
    v_mfma_f32_16x16x32_bf16 a[12:15], v[172:175], a[240:243], a[12:15]
    ds_read_b64_tr_b16 a[238:239], v207 offset:17344
    v_cvt_pk_bf16_f32 v97, v90, v91
    v_cvt_pk_bf16_f32 v98, v92, v93
    v_mfma_f32_16x16x32_bf16 a[16:19], v[176:179], a[240:243], a[16:19]
    ds_read_b64_tr_b16 a[240:241], v207 offset:16864
    v_cvt_pk_bf16_f32 v99, v94, v95
    v_mfma_f32_16x16x32_bf16 a[16:19], v[188:191], a[244:247], a[16:19]
    ds_read_b64_tr_b16 a[242:243], v207 offset:17376
    buffer_store_dwordx4 v[96:99], v226, s[16:19], s48 offen offset:0 sc1 nt
    s_waitcnt lgkmcnt(12)
    v_mul_f32 v100, v100, v211
    v_mfma_f32_16x16x32_bf16 a[28:31], v[188:191], a[248:251], a[28:31]
    ds_read_b64_tr_b16 a[244:245], v207 offset:224
    ds_write2_b32 v224, v8, v9 offset0:0 offset1:68
    v_mul_f32 v101, v101, v211
    v_mfma_f32_16x16x32_bf16 a[28:31], v[176:179], a[252:255], a[28:31]
    ds_read_b64_tr_b16 a[246:247], v207 offset:736
    ds_write2_b32 v224, v10, v11 offset0:136 offset1:204
    v_mul_f32 v102, v102, v211
    v_mfma_f32_16x16x32_bf16 a[24:27], v[172:175], a[252:255], a[24:27]
    ds_read_b64_tr_b16 a[128:129], v221 offset:16864
    ds_write2_b32 v224, v20, v21 offset0:16 offset1:84
    v_mul_f32 v103, v103, v211
    v_mfma_f32_16x16x32_bf16 a[24:27], v[184:187], a[248:251], a[24:27]
    ds_read_b64_tr_b16 a[130:131], v221 offset:17376
    ds_write2_b32 v224, v22, v23 offset0:152 offset1:220
    v_mul_f32 v104, v104, v211
    v_mfma_f32_16x16x32_bf16 a[20:23], v[180:183], a[248:251], a[20:23]
    ds_read_b64_tr_b16 a[248:249], v221 offset:224
    ds_write2_b32 v224, v32, v33 offset0:32 offset1:100
    v_mul_f32 v105, v105, v211
    v_mfma_f32_16x16x32_bf16 a[20:23], v[168:171], a[252:255], a[20:23]
    ds_read_b64_tr_b16 a[250:251], v221 offset:736
    ds_write2_b32 v224, v34, v35 offset0:168 offset1:236
    v_mul_f32 v106, v106, v211
    v_mfma_f32_16x16x32_bf16 v[48:51], v[144:147], a[192:195], v[48:51]
    ds_read_b64_tr_b16 a[252:253], v221 offset:33536
    ds_write2_b32 v224, v44, v45 offset0:48 offset1:116
    v_mul_f32 v107, v107, v211
    v_mfma_f32_16x16x32_bf16 v[48:51], v[156:159], a[196:199], v[48:51]
    ds_read_b64_tr_b16 a[254:255], v221 offset:34048
    ds_write2_b32 v224, v46, v47 offset0:184 offset1:252
    v_cvt_pk_bf16_f32 v108, v100, v101
    v_mfma_f32_16x16x32_bf16 v[48:51], v[228:231], a[200:203], v[48:51]
    ds_read_b64_tr_b16 a[132:133], v221 offset:50176
    ds_read_b128 v[112:115], v225 offset:0
    ds_read_b128 v[116:119], v225 offset:16
    v_cvt_pk_bf16_f32 v109, v102, v103
    v_mfma_f32_16x16x32_bf16 v[48:51], v[240:243], a[204:207], v[48:51]
    ds_read_b64_tr_b16 a[134:135], v221 offset:50688
    ds_read_b128 v[124:127], v225 offset:2176
    ds_read_b128 v[128:131], v225 offset:2192
    v_cvt_pk_bf16_f32 v110, v104, v105
    v_mfma_f32_16x16x32_bf16 v[60:63], v[240:243], a[208:211], v[60:63]
    ds_read_b64_tr_b16 a[136:137], v221 offset:50208
    v_cvt_pk_bf16_f32 v111, v106, v107
    v_mfma_f32_16x16x32_bf16 v[60:63], v[228:231], a[212:215], v[60:63]
    ds_read_b64_tr_b16 a[138:139], v221 offset:50720
    buffer_store_dwordx4 v[108:111], v227, s[16:19], s48 offen offset:0 sc1 nt
    v_mfma_f32_16x16x32_bf16 v[60:63], v[156:159], a[216:219], v[60:63]
    ds_read_b64_tr_b16 a[140:141], v221 offset:33568
    s_waitcnt lgkmcnt(6)
    v_mul_f32 v112, v112, v212
    v_mul_f32 v113, v113, v212
    v_mfma_f32_16x16x32_bf16 v[60:63], v[144:147], a[220:223], v[60:63]
    ds_read_b64_tr_b16 a[142:143], v221 offset:34080
    v_mul_f32 v114, v114, v212
    v_mul_f32 v115, v115, v212
    v_mfma_f32_16x16x32_bf16 a[8:11], v[144:147], a[224:227], a[8:11]
    ds_read_b64_tr_b16 a[144:145], v221 offset:33600
    v_mul_f32 v116, v116, v212
    v_mul_f32 v117, v117, v212
    v_mfma_f32_16x16x32_bf16 a[8:11], v[156:159], a[228:231], a[8:11]
    ds_read_b64_tr_b16 a[146:147], v221 offset:34112
    v_mul_f32 v118, v118, v212
    v_mul_f32 v119, v119, v212
    v_mfma_f32_16x16x32_bf16 a[8:11], v[228:231], a[232:235], a[8:11]
    ds_read_b64_tr_b16 a[148:149], v221 offset:50240
    v_cvt_pk_bf16_f32 v120, v112, v113
    v_cvt_pk_bf16_f32 v121, v114, v115
    v_mfma_f32_16x16x32_bf16 a[8:11], v[240:243], a[236:239], a[8:11]
    ds_read_b64_tr_b16 a[150:151], v221 offset:50752
    v_cvt_pk_bf16_f32 v122, v116, v117
    v_cvt_pk_bf16_f32 v123, v118, v119
    v_mfma_f32_16x16x32_bf16 a[20:23], v[240:243], a[240:243], a[20:23]
    ds_read_b64_tr_b16 a[152:153], v221 offset:50272
    buffer_store_dwordx4 v[120:123], v226, s[16:19], s49 offen offset:0 sc1 nt
    s_waitcnt lgkmcnt(9)
    v_mul_f32 v124, v124, v213
    v_mfma_f32_16x16x32_bf16 a[20:23], v[228:231], a[244:247], a[20:23]
    ds_read_b64_tr_b16 a[154:155], v221 offset:50784
    ds_write2_b32 v224, v48, v49 offset0:0 offset1:68
    v_mul_f32 v125, v125, v213
    v_mfma_f32_16x16x32_bf16 a[20:23], v[156:159], a[128:131], a[20:23]
    ds_read_b64_tr_b16 a[156:157], v221 offset:33632
    ds_write2_b32 v224, v50, v51 offset0:136 offset1:204
    v_mul_f32 v126, v126, v213
    v_mfma_f32_16x16x32_bf16 a[20:23], v[144:147], a[248:251], a[20:23]
    ds_read_b64_tr_b16 a[158:159], v221 offset:34144
    ds_write2_b32 v224, v60, v61 offset0:16 offset1:84
    v_mul_f32 v127, v127, v213
    v_mfma_f32_16x16x32_bf16 a[24:27], v[148:151], a[248:251], a[24:27]
    ds_read_b64_tr_b16 a[160:161], v221 offset:256
    ds_write2_b32 v224, v62, v63 offset0:152 offset1:220
    v_mul_f32 v128, v128, v213
    v_mfma_f32_16x16x32_bf16 a[24:27], v[160:163], a[128:131], a[24:27]
    ds_read_b64_tr_b16 a[162:163], v221 offset:768
    ds_write2_b32 v224, a8, a9 offset0:32 offset1:100
    v_mul_f32 v129, v129, v213
    v_mfma_f32_16x16x32_bf16 a[24:27], v[232:235], a[244:247], a[24:27]
    ds_read_b64_tr_b16 a[164:165], v221 offset:16896
    ds_write2_b32 v224, a10, a11 offset0:168 offset1:236
    v_mul_f32 v130, v130, v213
    v_mfma_f32_16x16x32_bf16 a[24:27], v[244:247], a[240:243], a[24:27]
    ds_read_b64_tr_b16 a[166:167], v221 offset:17408
    ds_write2_b32 v224, a20, a21 offset0:48 offset1:116
    v_mul_f32 v131, v131, v213
    v_mfma_f32_16x16x32_bf16 a[12:15], v[244:247], a[236:239], a[12:15]
    ds_read_b64_tr_b16 a[168:169], v207 offset:256
    ds_write2_b32 v224, a22, a23 offset0:184 offset1:252
    v_cvt_pk_bf16_f32 v132, v124, v125
    v_mfma_f32_16x16x32_bf16 a[12:15], v[232:235], a[232:235], a[12:15]
    ds_read_b64_tr_b16 a[170:171], v207 offset:768
    ds_read_b128 v[64:67], v225 offset:0
    ds_read_b128 v[68:71], v225 offset:16
    v_cvt_pk_bf16_f32 v133, v126, v127
    v_mfma_f32_16x16x32_bf16 a[12:15], v[160:163], a[228:231], a[12:15]
    ds_read_b64_tr_b16 a[172:173], v207 offset:16896
    ds_read_b128 v[76:79], v225 offset:2176
    ds_read_b128 v[80:83], v225 offset:2192
    v_cvt_pk_bf16_f32 v134, v128, v129
    v_mfma_f32_16x16x32_bf16 a[12:15], v[148:151], a[224:227], a[12:15]
    ds_read_b64_tr_b16 a[174:175], v207 offset:17408
    v_cvt_pk_bf16_f32 v135, v130, v131
    v_mfma_f32_16x16x32_bf16 a[0:3], v[148:151], a[220:223], a[0:3]
    ds_read_b64_tr_b16 a[176:177], v207 offset:16928
    buffer_store_dwordx4 v[132:135], v227, s[16:19], s49 offen offset:0 sc1 nt
    v_mfma_f32_16x16x32_bf16 a[0:3], v[160:163], a[216:219], a[0:3]
    ds_read_b64_tr_b16 a[178:179], v207 offset:17440
    s_waitcnt lgkmcnt(6)
    v_mul_f32 v64, v64, v208
    v_mul_f32 v65, v65, v208
    v_mfma_f32_16x16x32_bf16 a[0:3], v[232:235], a[212:215], a[0:3]
    ds_read_b64_tr_b16 a[180:181], v207 offset:288
    v_mul_f32 v66, v66, v208
    v_mul_f32 v67, v67, v208
    v_mfma_f32_16x16x32_bf16 a[0:3], v[244:247], a[208:211], a[0:3]
    ds_read_b64_tr_b16 a[182:183], v207 offset:800
    v_mul_f32 v68, v68, v208
    v_mul_f32 v69, v69, v208
    v_mfma_f32_16x16x32_bf16 v[52:55], v[244:247], a[204:207], v[52:55]
    ds_read_b64_tr_b16 a[184:185], v221 offset:16928
    v_mul_f32 v70, v70, v208
    v_mul_f32 v71, v71, v208
    v_mfma_f32_16x16x32_bf16 v[52:55], v[232:235], a[200:203], v[52:55]
    ds_read_b64_tr_b16 a[186:187], v221 offset:17440
    v_cvt_pk_bf16_f32 v72, v64, v65
    v_cvt_pk_bf16_f32 v73, v66, v67
    v_mfma_f32_16x16x32_bf16 v[52:55], v[160:163], a[196:199], v[52:55]
    ds_read_b64_tr_b16 a[188:189], v221 offset:288
    v_cvt_pk_bf16_f32 v74, v68, v69
    v_cvt_pk_bf16_f32 v75, v70, v71
    v_mfma_f32_16x16x32_bf16 v[52:55], v[148:151], a[192:195], v[52:55]
    ds_read_b64_tr_b16 a[190:191], v221 offset:800
    buffer_store_dwordx4 v[72:75], v226, s[16:19], 0 offen offset:128 sc1 nt
    s_waitcnt lgkmcnt(9)
    v_mul_f32 v76, v76, v209
    v_mfma_f32_16x16x32_bf16 v[56:59], v[152:155], a[192:195], v[56:59]
    ds_read_b64_tr_b16 a[192:193], v221 offset:320
    ds_write2_b32 v224, a24, a25 offset0:48 offset1:116
    v_mul_f32 v77, v77, v209
    v_mfma_f32_16x16x32_bf16 v[56:59], v[164:167], a[196:199], v[56:59]
    ds_read_b64_tr_b16 a[194:195], v221 offset:832
    ds_write2_b32 v224, a26, a27 offset0:184 offset1:252
    v_mul_f32 v78, v78, v209
    v_mfma_f32_16x16x32_bf16 v[56:59], v[236:239], a[200:203], v[56:59]
    ds_read_b64_tr_b16 a[196:197], v221 offset:16960
    ds_write2_b32 v224, a12, a13 offset0:32 offset1:100
    v_mul_f32 v79, v79, v209
    v_mfma_f32_16x16x32_bf16 v[56:59], v[248:251], a[204:207], v[56:59]
    ds_read_b64_tr_b16 a[198:199], v221 offset:17472
    ds_write2_b32 v224, a14, a15 offset0:168 offset1:236
    v_mul_f32 v80, v80, v209
    v_mfma_f32_16x16x32_bf16 a[4:7], v[248:251], a[208:211], a[4:7]
    ds_read_b64_tr_b16 a[200:201], v207 offset:320
    ds_write2_b32 v224, a0, a1 offset0:16 offset1:84
    v_mul_f32 v81, v81, v209
    v_mfma_f32_16x16x32_bf16 a[4:7], v[236:239], a[212:215], a[4:7]
    ds_read_b64_tr_b16 a[202:203], v207 offset:832
    ds_write2_b32 v224, a2, a3 offset0:152 offset1:220
    v_mul_f32 v82, v82, v209
    v_mfma_f32_16x16x32_bf16 a[4:7], v[164:167], a[216:219], a[4:7]
    ds_read_b64_tr_b16 a[204:205], v207 offset:16960
    ds_write2_b32 v224, v52, v53 offset0:0 offset1:68
    v_mul_f32 v83, v83, v209
    v_mfma_f32_16x16x32_bf16 a[4:7], v[152:155], a[220:223], a[4:7]
    ds_read_b64_tr_b16 a[206:207], v207 offset:17472
    ds_write2_b32 v224, v54, v55 offset0:136 offset1:204
    v_cvt_pk_bf16_f32 v84, v76, v77
    v_mfma_f32_16x16x32_bf16 a[16:19], v[152:155], a[224:227], a[16:19]
    ds_read_b64_tr_b16 a[208:209], v207 offset:16992
    ds_read_b128 v[88:91], v225 offset:0
    ds_read_b128 v[92:95], v225 offset:16
    v_cvt_pk_bf16_f32 v85, v78, v79
    v_mfma_f32_16x16x32_bf16 a[16:19], v[164:167], a[228:231], a[16:19]
    ds_read_b64_tr_b16 a[210:211], v207 offset:17504
    ds_read_b128 v[100:103], v225 offset:2176
    ds_read_b128 v[104:107], v225 offset:2192
    v_cvt_pk_bf16_f32 v86, v80, v81
    v_mfma_f32_16x16x32_bf16 a[16:19], v[236:239], a[232:235], a[16:19]
    ds_read_b64_tr_b16 a[212:213], v207 offset:352
    v_cvt_pk_bf16_f32 v87, v82, v83
    v_mfma_f32_16x16x32_bf16 a[16:19], v[248:251], a[236:239], a[16:19]
    ds_read_b64_tr_b16 a[214:215], v207 offset:864
    buffer_store_dwordx4 v[84:87], v227, s[16:19], 0 offen offset:128 sc1 nt
    v_mfma_f32_16x16x32_bf16 a[28:31], v[248:251], a[240:243], a[28:31]
    ds_read_b64_tr_b16 a[216:217], v221 offset:16992
    s_waitcnt lgkmcnt(6)
    v_mul_f32 v88, v88, v210
    v_mul_f32 v89, v89, v210
    v_mfma_f32_16x16x32_bf16 a[28:31], v[236:239], a[244:247], a[28:31]
    ds_read_b64_tr_b16 a[218:219], v221 offset:17504
    v_mul_f32 v90, v90, v210
    v_mul_f32 v91, v91, v210
    v_mfma_f32_16x16x32_bf16 a[28:31], v[164:167], a[128:131], a[28:31]
    ds_read_b64_tr_b16 a[220:221], v221 offset:352
    v_mul_f32 v92, v92, v210
    v_mul_f32 v93, v93, v210
    v_mfma_f32_16x16x32_bf16 a[28:31], v[152:155], a[248:251], a[28:31]
    ds_read_b64_tr_b16 a[222:223], v221 offset:864
    v_mul_f32 v94, v94, v210
    v_mul_f32 v95, v95, v210
    v_mfma_f32_16x16x32_bf16 a[32:35], v[168:171], a[252:255], a[32:35]
    v_cvt_pk_bf16_f32 v96, v88, v89
    v_cvt_pk_bf16_f32 v97, v90, v91
    v_cvt_pk_bf16_f32 v98, v92, v93
    v_mfma_f32_16x16x32_bf16 a[32:35], v[180:183], a[132:135], a[32:35]
    v_cvt_pk_bf16_f32 v99, v94, v95
    v_mfma_f32_16x16x32_bf16 a[36:39], v[184:187], a[132:135], a[36:39]
    buffer_store_dwordx4 v[96:99], v226, s[16:19], s48 offen offset:128 sc1 nt
    v_mfma_f32_16x16x32_bf16 a[36:39], v[172:175], a[252:255], a[36:39]
    ds_write2_b32 v224, v56, v57 offset0:0 offset1:68
    s_waitcnt lgkmcnt(7)
    v_mul_f32 v100, v100, v211
    v_mfma_f32_16x16x32_bf16 a[40:43], v[176:179], a[252:255], a[40:43]
    ds_write2_b32 v224, v58, v59 offset0:136 offset1:204
    v_mul_f32 v101, v101, v211
    v_mfma_f32_16x16x32_bf16 a[40:43], v[188:191], a[132:135], a[40:43]
    ds_write2_b32 v224, a4, a5 offset0:16 offset1:84
    v_mul_f32 v102, v102, v211
    v_mfma_f32_16x16x32_bf16 a[52:55], v[188:191], a[136:139], a[52:55]
    ds_write2_b32 v224, a6, a7 offset0:152 offset1:220
    v_mul_f32 v103, v103, v211
    v_mfma_f32_16x16x32_bf16 a[52:55], v[176:179], a[140:143], a[52:55]
    ds_write2_b32 v224, a16, a17 offset0:32 offset1:100
    v_mul_f32 v104, v104, v211
    v_mfma_f32_16x16x32_bf16 a[48:51], v[172:175], a[140:143], a[48:51]
    ds_write2_b32 v224, a18, a19 offset0:168 offset1:236
    v_mul_f32 v105, v105, v211
    v_mfma_f32_16x16x32_bf16 a[48:51], v[184:187], a[136:139], a[48:51]
    ds_write2_b32 v224, a28, a29 offset0:48 offset1:116
    v_mul_f32 v106, v106, v211
    v_mfma_f32_16x16x32_bf16 a[44:47], v[180:183], a[136:139], a[44:47]
    ds_write2_b32 v224, a30, a31 offset0:184 offset1:252
    v_mul_f32 v107, v107, v211
    v_mfma_f32_16x16x32_bf16 a[44:47], v[168:171], a[140:143], a[44:47]
    ds_read_b128 v[112:115], v225 offset:0
    ds_read_b128 v[116:119], v225 offset:16
    v_cvt_pk_bf16_f32 v108, v100, v101
    v_mfma_f32_16x16x32_bf16 a[56:59], v[168:171], a[144:147], a[56:59]
    ds_read_b64_tr_b16 a[224:225], v221 offset:33664
    ds_read_b128 v[124:127], v225 offset:2176
    ds_read_b128 v[128:131], v225 offset:2192
    v_cvt_pk_bf16_f32 v109, v102, v103
    v_mfma_f32_16x16x32_bf16 a[56:59], v[180:183], a[148:151], a[56:59]
    ds_read_b64_tr_b16 a[226:227], v221 offset:34176
    v_cvt_pk_bf16_f32 v110, v104, v105
    v_cvt_pk_bf16_f32 v111, v106, v107
    v_mfma_f32_16x16x32_bf16 a[60:63], v[184:187], a[148:151], a[60:63]
    ds_read_b64_tr_b16 a[228:229], v221 offset:50304
    buffer_store_dwordx4 v[108:111], v227, s[16:19], s48 offen offset:128 sc1 nt
    v_mfma_f32_16x16x32_bf16 a[60:63], v[172:175], a[144:147], a[60:63]
    ds_read_b64_tr_b16 a[230:231], v221 offset:50816
    s_waitcnt lgkmcnt(6)
    v_mul_f32 v112, v112, v212
    v_mul_f32 v113, v113, v212
    v_mfma_f32_16x16x32_bf16 a[64:67], v[176:179], a[144:147], a[64:67]
    ds_read_b64_tr_b16 a[232:233], v221 offset:384
    v_mul_f32 v114, v114, v212
    v_mul_f32 v115, v115, v212
    v_mfma_f32_16x16x32_bf16 a[64:67], v[188:191], a[148:151], a[64:67]
    ds_read_b64_tr_b16 a[234:235], v221 offset:896
    v_mul_f32 v116, v116, v212
    v_mul_f32 v117, v117, v212
    v_mfma_f32_16x16x32_bf16 a[76:79], v[188:191], a[152:155], a[76:79]
    ds_read_b64_tr_b16 a[236:237], v221 offset:17024
    v_mul_f32 v118, v118, v212
    v_mul_f32 v119, v119, v212
    v_mfma_f32_16x16x32_bf16 a[76:79], v[176:179], a[156:159], a[76:79]
    ds_read_b64_tr_b16 a[238:239], v221 offset:17536
    v_cvt_pk_bf16_f32 v120, v112, v113
    v_cvt_pk_bf16_f32 v121, v114, v115
    v_mfma_f32_16x16x32_bf16 a[72:75], v[172:175], a[156:159], a[72:75]
    ds_read_b64_tr_b16 a[240:241], v207 offset:384
    v_cvt_pk_bf16_f32 v122, v116, v117
    v_cvt_pk_bf16_f32 v123, v118, v119
    v_mfma_f32_16x16x32_bf16 a[72:75], v[184:187], a[152:155], a[72:75]
    ds_read_b64_tr_b16 a[242:243], v207 offset:896
    buffer_store_dwordx4 v[120:123], v226, s[16:19], s49 offen offset:128 sc1 nt
    s_waitcnt lgkmcnt(9)
    v_mul_f32 v124, v124, v213
    v_mfma_f32_16x16x32_bf16 a[68:71], v[180:183], a[152:155], a[68:71]
    ds_read_b64_tr_b16 a[244:245], v207 offset:17024
    v_mul_f32 v125, v125, v213
    v_mul_f32 v126, v126, v213
    v_mfma_f32_16x16x32_bf16 a[68:71], v[168:171], a[156:159], a[68:71]
    ds_read_b64_tr_b16 a[246:247], v207 offset:17536
    v_mul_f32 v127, v127, v213
    v_mul_f32 v128, v128, v213
    v_mfma_f32_16x16x32_bf16 a[32:35], v[144:147], a[160:163], a[32:35]
    ds_read_b64_tr_b16 a[248:249], v207 offset:17056
    v_mul_f32 v129, v129, v213
    v_mul_f32 v130, v130, v213
    v_mfma_f32_16x16x32_bf16 a[32:35], v[156:159], a[164:167], a[32:35]
    ds_read_b64_tr_b16 a[250:251], v207 offset:17568
    v_mul_f32 v131, v131, v213
    v_cvt_pk_bf16_f32 v132, v124, v125
    v_mfma_f32_16x16x32_bf16 a[32:35], v[228:231], a[168:171], a[32:35]
    ds_read_b64_tr_b16 a[252:253], v207 offset:416
    v_cvt_pk_bf16_f32 v133, v126, v127
    v_cvt_pk_bf16_f32 v134, v128, v129
    v_mfma_f32_16x16x32_bf16 a[32:35], v[240:243], a[172:175], a[32:35]
    ds_read_b64_tr_b16 a[254:255], v207 offset:928
    v_cvt_pk_bf16_f32 v135, v130, v131
    v_mfma_f32_16x16x32_bf16 a[44:47], v[240:243], a[176:179], a[44:47]
    ds_read_b64_tr_b16 a[128:129], v221 offset:17056
    buffer_store_dwordx4 v[132:135], v227, s[16:19], s49 offen offset:128 sc1 nt
    v_mfma_f32_16x16x32_bf16 a[44:47], v[228:231], a[180:183], a[44:47]
    ds_read_b64_tr_b16 a[130:131], v221 offset:17568
    v_mfma_f32_16x16x32_bf16 a[44:47], v[156:159], a[184:187], a[44:47]
    ds_read_b64_tr_b16 a[132:133], v221 offset:416
    ds_write2_b32 v224, a32, a33 offset0:0 offset1:68
    v_mfma_f32_16x16x32_bf16 a[44:47], v[144:147], a[188:191], a[44:47]
    ds_read_b64_tr_b16 a[134:135], v221 offset:928
    ds_write2_b32 v224, a34, a35 offset0:136 offset1:204
    v_mfma_f32_16x16x32_bf16 a[56:59], v[144:147], a[192:195], a[56:59]
    ds_read_b64_tr_b16 a[136:137], v221 offset:50336
    v_mfma_f32_16x16x32_bf16 a[56:59], v[156:159], a[196:199], a[56:59]
    ds_read_b64_tr_b16 a[138:139], v221 offset:50848
    v_mfma_f32_16x16x32_bf16 a[56:59], v[228:231], a[200:203], a[56:59]
    ds_read_b64_tr_b16 a[140:141], v221 offset:33696
    v_mfma_f32_16x16x32_bf16 a[56:59], v[240:243], a[204:207], a[56:59]
    ds_read_b64_tr_b16 a[142:143], v221 offset:34208
    ds_write2_b32 v224, a44, a45 offset0:16 offset1:84
    v_mfma_f32_16x16x32_bf16 a[68:71], v[240:243], a[208:211], a[68:71]
    ds_read_b64_tr_b16 a[144:145], v221 offset:33728
    ds_write2_b32 v224, a46, a47 offset0:152 offset1:220
    v_mfma_f32_16x16x32_bf16 a[68:71], v[228:231], a[212:215], a[68:71]
    ds_read_b64_tr_b16 a[146:147], v221 offset:34240
    v_mfma_f32_16x16x32_bf16 a[68:71], v[156:159], a[216:219], a[68:71]
    ds_read_b64_tr_b16 a[148:149], v221 offset:50368
    ds_write2_b32 v224, a56, a57 offset0:32 offset1:100
    v_mfma_f32_16x16x32_bf16 a[68:71], v[144:147], a[220:223], a[68:71]
    ds_read_b64_tr_b16 a[150:151], v221 offset:50880
    ds_write2_b32 v224, a58, a59 offset0:168 offset1:236
    v_mfma_f32_16x16x32_bf16 a[72:75], v[148:151], a[220:223], a[72:75]
    ds_read_b64_tr_b16 a[152:153], v221 offset:448
    v_mfma_f32_16x16x32_bf16 a[72:75], v[160:163], a[216:219], a[72:75]
    ds_read_b64_tr_b16 a[154:155], v221 offset:960
    v_mfma_f32_16x16x32_bf16 a[72:75], v[232:235], a[212:215], a[72:75]
    ds_read_b64_tr_b16 a[156:157], v221 offset:17088
    v_mfma_f32_16x16x32_bf16 a[72:75], v[244:247], a[208:211], a[72:75]
    ds_read_b64_tr_b16 a[158:159], v221 offset:17600
    ds_write2_b32 v224, a68, a69 offset0:48 offset1:116
    v_mfma_f32_16x16x32_bf16 a[60:63], v[244:247], a[204:207], a[60:63]
    ds_write2_b32 v224, a70, a71 offset0:184 offset1:252
    v_mfma_f32_16x16x32_bf16 a[60:63], v[232:235], a[200:203], a[60:63]
    ds_read_b128 v[64:67], v225 offset:0
    ds_read_b128 v[68:71], v225 offset:16
    v_mfma_f32_16x16x32_bf16 a[60:63], v[160:163], a[196:199], a[60:63]
    ds_read_b128 v[76:79], v225 offset:2176
    ds_read_b128 v[80:83], v225 offset:2192
    v_mfma_f32_16x16x32_bf16 a[60:63], v[148:151], a[192:195], a[60:63]
    ds_write2_b32 v224, a72, a73 offset0:48 offset1:116
    v_mfma_f32_16x16x32_bf16 a[48:51], v[148:151], a[188:191], a[48:51]
    ds_write2_b32 v224, a74, a75 offset0:184 offset1:252
    v_mfma_f32_16x16x32_bf16 a[48:51], v[160:163], a[184:187], a[48:51]
    s_waitcnt lgkmcnt(4)
    v_mul_f32 v64, v64, v208
    v_mul_f32 v65, v65, v208
    v_mul_f32 v66, v66, v208
    v_mfma_f32_16x16x32_bf16 a[48:51], v[232:235], a[180:183], a[48:51]
    v_mul_f32 v67, v67, v208
    v_mul_f32 v68, v68, v208
    v_mul_f32 v69, v69, v208
    v_mfma_f32_16x16x32_bf16 a[48:51], v[244:247], a[176:179], a[48:51]
    v_mul_f32 v70, v70, v208
    v_mul_f32 v71, v71, v208
    v_cvt_pk_bf16_f32 v72, v64, v65
    v_mfma_f32_16x16x32_bf16 a[36:39], v[244:247], a[172:175], a[36:39]
    v_cvt_pk_bf16_f32 v73, v66, v67
    v_cvt_pk_bf16_f32 v74, v68, v69
    v_cvt_pk_bf16_f32 v75, v70, v71
    v_mfma_f32_16x16x32_bf16 a[36:39], v[232:235], a[168:171], a[36:39]
    buffer_store_dwordx4 v[72:75], v226, s[16:19], 0 offen offset:256 sc1 nt
    v_mfma_f32_16x16x32_bf16 a[36:39], v[160:163], a[164:167], a[36:39]
    ds_write2_b32 v224, a60, a61 offset0:32 offset1:100
    s_waitcnt lgkmcnt(3)
    v_mul_f32 v76, v76, v209
    v_mfma_f32_16x16x32_bf16 a[36:39], v[148:151], a[160:163], a[36:39]
    ds_write2_b32 v224, a62, a63 offset0:168 offset1:236
    v_mul_f32 v77, v77, v209
    v_mfma_f32_16x16x32_bf16 a[40:43], v[152:155], a[160:163], a[40:43]
    ds_read_b64_tr_b16 a[160:161], v207 offset:448
    ds_write2_b32 v224, a48, a49 offset0:16 offset1:84
    v_mul_f32 v78, v78, v209
    v_mfma_f32_16x16x32_bf16 a[40:43], v[164:167], a[164:167], a[40:43]
    ds_read_b64_tr_b16 a[162:163], v207 offset:960
    ds_write2_b32 v224, a50, a51 offset0:152 offset1:220
    v_mul_f32 v79, v79, v209
    v_mfma_f32_16x16x32_bf16 a[40:43], v[236:239], a[168:171], a[40:43]
    ds_read_b64_tr_b16 a[164:165], v207 offset:17088
    ds_write2_b32 v224, a36, a37 offset0:0 offset1:68
    v_mul_f32 v80, v80, v209
    v_mfma_f32_16x16x32_bf16 a[40:43], v[248:251], a[172:175], a[40:43]
    ds_read_b64_tr_b16 a[166:167], v207 offset:17600
    ds_write2_b32 v224, a38, a39 offset0:136 offset1:204
    v_mul_f32 v81, v81, v209
    v_mfma_f32_16x16x32_bf16 a[52:55], v[248:251], a[176:179], a[52:55]
    ds_read_b64_tr_b16 a[168:169], v207 offset:17120
    ds_read_b128 v[88:91], v225 offset:0
    ds_read_b128 v[92:95], v225 offset:16
    v_mul_f32 v82, v82, v209
    v_mfma_f32_16x16x32_bf16 a[52:55], v[236:239], a[180:183], a[52:55]
    ds_read_b64_tr_b16 a[170:171], v207 offset:17632
    ds_read_b128 v[100:103], v225 offset:2176
    ds_read_b128 v[104:107], v225 offset:2192
    v_mul_f32 v83, v83, v209
    v_mfma_f32_16x16x32_bf16 a[52:55], v[164:167], a[184:187], a[52:55]
    ds_read_b64_tr_b16 a[172:173], v207 offset:480
    v_cvt_pk_bf16_f32 v84, v76, v77
    v_cvt_pk_bf16_f32 v85, v78, v79
    v_mfma_f32_16x16x32_bf16 a[52:55], v[152:155], a[188:191], a[52:55]
    ds_read_b64_tr_b16 a[174:175], v207 offset:992
    v_cvt_pk_bf16_f32 v86, v80, v81
    v_cvt_pk_bf16_f32 v87, v82, v83
    v_mfma_f32_16x16x32_bf16 a[64:67], v[152:155], a[192:195], a[64:67]
    ds_read_b64_tr_b16 a[192:193], v221 offset:17120
    buffer_store_dwordx4 v[84:87], v227, s[16:19], 0 offen offset:256 sc1 nt
    s_waitcnt lgkmcnt(6)
    v_mul_f32 v88, v88, v210
    v_mfma_f32_16x16x32_bf16 a[64:67], v[164:167], a[196:199], a[64:67]
    ds_read_b64_tr_b16 a[194:195], v221 offset:17632
    v_mul_f32 v89, v89, v210
    v_mul_f32 v90, v90, v210
    v_mfma_f32_16x16x32_bf16 a[64:67], v[236:239], a[200:203], a[64:67]
    ds_read_b64_tr_b16 a[196:197], v221 offset:480
    v_mul_f32 v91, v91, v210
    v_mul_f32 v92, v92, v210
    v_mfma_f32_16x16x32_bf16 a[64:67], v[248:251], a[204:207], a[64:67]
    ds_read_b64_tr_b16 a[198:199], v221 offset:992
    v_mul_f32 v93, v93, v210
    v_mul_f32 v94, v94, v210
    v_mfma_f32_16x16x32_bf16 a[76:79], v[248:251], a[208:211], a[76:79]
    ds_read_b64_tr_b16 a[200:201], v221 offset:50400
    v_mul_f32 v95, v95, v210
    v_cvt_pk_bf16_f32 v96, v88, v89
    v_mfma_f32_16x16x32_bf16 a[76:79], v[236:239], a[212:215], a[76:79]
    ds_read_b64_tr_b16 a[202:203], v221 offset:50912
    v_cvt_pk_bf16_f32 v97, v90, v91
    v_cvt_pk_bf16_f32 v98, v92, v93
    v_mfma_f32_16x16x32_bf16 a[76:79], v[164:167], a[216:219], a[76:79]
    ds_read_b64_tr_b16 a[204:205], v221 offset:33760
    v_cvt_pk_bf16_f32 v99, v94, v95
    v_mfma_f32_16x16x32_bf16 a[76:79], v[152:155], a[220:223], a[76:79]
    ds_read_b64_tr_b16 a[206:207], v221 offset:34272
    buffer_store_dwordx4 v[96:99], v226, s[16:19], s48 offen offset:256 sc1 nt
    s_waitcnt lgkmcnt(10)
    v_mul_f32 v100, v100, v211
    v_mfma_f32_16x16x32_bf16 a[80:83], v[168:171], a[224:227], a[80:83]
    ds_write2_b32 v224, a40, a41 offset0:0 offset1:68
    v_mul_f32 v101, v101, v211
    v_mfma_f32_16x16x32_bf16 a[80:83], v[180:183], a[228:231], a[80:83]
    ds_write2_b32 v224, a42, a43 offset0:136 offset1:204
    v_mul_f32 v102, v102, v211
    v_mfma_f32_16x16x32_bf16 a[80:83], v[144:147], a[232:235], a[80:83]
    ds_write2_b32 v224, a52, a53 offset0:16 offset1:84
    v_mul_f32 v103, v103, v211
    v_mfma_f32_16x16x32_bf16 a[80:83], v[156:159], a[236:239], a[80:83]
    ds_write2_b32 v224, a54, a55 offset0:152 offset1:220
    v_mul_f32 v104, v104, v211
    v_mfma_f32_16x16x32_bf16 a[80:83], v[228:231], a[240:243], a[80:83]
    ds_write2_b32 v224, a64, a65 offset0:32 offset1:100
    v_mul_f32 v105, v105, v211
    v_mfma_f32_16x16x32_bf16 a[80:83], v[240:243], a[244:247], a[80:83]
    ds_write2_b32 v224, a66, a67 offset0:168 offset1:236
    v_mul_f32 v106, v106, v211
    v_mfma_f32_16x16x32_bf16 a[92:95], v[240:243], a[248:251], a[92:95]
    ds_write2_b32 v224, a76, a77 offset0:48 offset1:116
    v_mul_f32 v107, v107, v211
    v_mfma_f32_16x16x32_bf16 a[92:95], v[228:231], a[252:255], a[92:95]
    ds_write2_b32 v224, a78, a79 offset0:184 offset1:252
    v_cvt_pk_bf16_f32 v108, v100, v101
    v_mfma_f32_16x16x32_bf16 a[92:95], v[156:159], a[128:131], a[92:95]
    ds_read_b128 v[112:115], v225 offset:0
    ds_read_b128 v[116:119], v225 offset:16
    v_cvt_pk_bf16_f32 v109, v102, v103
    v_mfma_f32_16x16x32_bf16 a[92:95], v[144:147], a[132:135], a[92:95]
    ds_read_b128 v[124:127], v225 offset:2176
    ds_read_b128 v[128:131], v225 offset:2192
    v_cvt_pk_bf16_f32 v110, v104, v105
    v_mfma_f32_16x16x32_bf16 a[92:95], v[180:183], a[136:139], a[92:95]
    v_cvt_pk_bf16_f32 v111, v106, v107
    v_mfma_f32_16x16x32_bf16 a[92:95], v[168:171], a[140:143], a[92:95]
    buffer_store_dwordx4 v[108:111], v227, s[16:19], s48 offen offset:256 sc1 nt
    v_mfma_f32_16x16x32_bf16 a[104:107], v[168:171], a[144:147], a[104:107]
    s_waitcnt lgkmcnt(2)
    v_mul_f32 v112, v112, v212
    v_mul_f32 v113, v113, v212
    v_mul_f32 v114, v114, v212
    v_mfma_f32_16x16x32_bf16 a[104:107], v[180:183], a[148:151], a[104:107]
    v_mul_f32 v115, v115, v212
    v_mul_f32 v116, v116, v212
    v_mul_f32 v117, v117, v212
    v_mfma_f32_16x16x32_bf16 a[104:107], v[144:147], a[152:155], a[104:107]
    v_mul_f32 v118, v118, v212
    v_mul_f32 v119, v119, v212
    v_cvt_pk_bf16_f32 v120, v112, v113
    v_mfma_f32_16x16x32_bf16 a[104:107], v[156:159], a[156:159], a[104:107]
    v_cvt_pk_bf16_f32 v121, v114, v115
    v_cvt_pk_bf16_f32 v122, v116, v117
    v_cvt_pk_bf16_f32 v123, v118, v119
    v_mfma_f32_16x16x32_bf16 a[104:107], v[228:231], a[160:163], a[104:107]
    buffer_store_dwordx4 v[120:123], v226, s[16:19], s49 offen offset:256 sc1 nt
    v_mfma_f32_16x16x32_bf16 a[104:107], v[240:243], a[164:167], a[104:107]
    ds_write2_b32 v224, a80, a81 offset0:0 offset1:68
    s_waitcnt lgkmcnt(1)
    v_mul_f32 v124, v124, v213
    v_mfma_f32_16x16x32_bf16 a[116:119], v[240:243], a[168:171], a[116:119]
    ds_write2_b32 v224, a82, a83 offset0:136 offset1:204
    v_mul_f32 v125, v125, v213
    v_mfma_f32_16x16x32_bf16 a[116:119], v[228:231], a[172:175], a[116:119]
    ds_write2_b32 v224, a92, a93 offset0:16 offset1:84
    v_mul_f32 v126, v126, v213
    v_mfma_f32_16x16x32_bf16 a[116:119], v[156:159], a[192:195], a[116:119]
    ds_write2_b32 v224, a94, a95 offset0:152 offset1:220
    v_mul_f32 v127, v127, v213
    v_mfma_f32_16x16x32_bf16 a[116:119], v[144:147], a[196:199], a[116:119]
    ds_write2_b32 v224, a104, a105 offset0:32 offset1:100
    v_mul_f32 v128, v128, v213
    v_mfma_f32_16x16x32_bf16 a[116:119], v[180:183], a[200:203], a[116:119]
    ds_write2_b32 v224, a106, a107 offset0:168 offset1:236
    v_mul_f32 v129, v129, v213
    v_mfma_f32_16x16x32_bf16 a[116:119], v[168:171], a[204:207], a[116:119]
    v_mul_f32 v130, v130, v213
    v_mul_f32 v131, v131, v213
    v_cvt_pk_bf16_f32 v132, v124, v125
    v_mfma_f32_16x16x32_bf16 a[120:123], v[172:175], a[204:207], a[120:123]
    v_cvt_pk_bf16_f32 v133, v126, v127
    v_cvt_pk_bf16_f32 v134, v128, v129
    v_cvt_pk_bf16_f32 v135, v130, v131
    v_mfma_f32_16x16x32_bf16 a[120:123], v[184:187], a[200:203], a[120:123]
    buffer_store_dwordx4 v[132:135], v227, s[16:19], s49 offen offset:256 sc1 nt
    v_mfma_f32_16x16x32_bf16 a[120:123], v[148:151], a[196:199], a[120:123]
    ds_write2_b32 v224, a116, a117 offset0:48 offset1:116
    v_mfma_f32_16x16x32_bf16 a[120:123], v[160:163], a[192:195], a[120:123]
    ds_write2_b32 v224, a118, a119 offset0:184 offset1:252
    v_mfma_f32_16x16x32_bf16 a[120:123], v[232:235], a[172:175], a[120:123]
    ds_read_b128 v[64:67], v225 offset:0
    ds_read_b128 v[68:71], v225 offset:16
    v_mfma_f32_16x16x32_bf16 a[120:123], v[244:247], a[168:171], a[120:123]
    ds_read_b128 v[76:79], v225 offset:2176
    ds_read_b128 v[80:83], v225 offset:2192
    v_mfma_f32_16x16x32_bf16 a[108:111], v[244:247], a[164:167], a[108:111]
    v_mfma_f32_16x16x32_bf16 a[108:111], v[232:235], a[160:163], a[108:111]
    v_mfma_f32_16x16x32_bf16 a[108:111], v[160:163], a[156:159], a[108:111]
    s_waitcnt lgkmcnt(2)
    v_mul_f32 v64, v64, v208
    v_mul_f32 v65, v65, v208
    v_mul_f32 v66, v66, v208
    v_mfma_f32_16x16x32_bf16 a[108:111], v[148:151], a[152:155], a[108:111]
    v_mul_f32 v67, v67, v208
    v_mul_f32 v68, v68, v208
    v_mul_f32 v69, v69, v208
    v_mfma_f32_16x16x32_bf16 a[108:111], v[184:187], a[148:151], a[108:111]
    v_mul_f32 v70, v70, v208
    v_mul_f32 v71, v71, v208
    v_cvt_pk_bf16_f32 v72, v64, v65
    v_mfma_f32_16x16x32_bf16 a[108:111], v[172:175], a[144:147], a[108:111]
    v_cvt_pk_bf16_f32 v73, v66, v67
    v_cvt_pk_bf16_f32 v74, v68, v69
    v_cvt_pk_bf16_f32 v75, v70, v71
    v_mfma_f32_16x16x32_bf16 a[96:99], v[172:175], a[140:143], a[96:99]
    buffer_store_dwordx4 v[72:75], v226, s[16:19], 0 offen offset:384 sc1 nt
    v_mfma_f32_16x16x32_bf16 a[96:99], v[184:187], a[136:139], a[96:99]
    ds_write2_b32 v224, a120, a121 offset0:48 offset1:116
    s_waitcnt lgkmcnt(1)
    v_mul_f32 v76, v76, v209
    v_mfma_f32_16x16x32_bf16 a[96:99], v[148:151], a[132:135], a[96:99]
    ds_write2_b32 v224, a122, a123 offset0:184 offset1:252
    v_mul_f32 v77, v77, v209
    v_mfma_f32_16x16x32_bf16 a[96:99], v[160:163], a[128:131], a[96:99]
    ds_write2_b32 v224, a108, a109 offset0:32 offset1:100
    v_mul_f32 v78, v78, v209
    v_mfma_f32_16x16x32_bf16 a[96:99], v[232:235], a[252:255], a[96:99]
    ds_write2_b32 v224, a110, a111 offset0:168 offset1:236
    v_mul_f32 v79, v79, v209
    v_mfma_f32_16x16x32_bf16 a[96:99], v[244:247], a[248:251], a[96:99]
    v_mul_f32 v80, v80, v209
    v_mul_f32 v81, v81, v209
    v_mul_f32 v82, v82, v209
    v_mfma_f32_16x16x32_bf16 a[84:87], v[244:247], a[244:247], a[84:87]
    v_mul_f32 v83, v83, v209
    v_cvt_pk_bf16_f32 v84, v76, v77
    v_cvt_pk_bf16_f32 v85, v78, v79
    v_mfma_f32_16x16x32_bf16 a[84:87], v[232:235], a[240:243], a[84:87]
    v_cvt_pk_bf16_f32 v86, v80, v81
    v_cvt_pk_bf16_f32 v87, v82, v83
    v_mfma_f32_16x16x32_bf16 a[84:87], v[160:163], a[236:239], a[84:87]
    buffer_store_dwordx4 v[84:87], v227, s[16:19], 0 offen offset:384 sc1 nt
    v_mfma_f32_16x16x32_bf16 a[84:87], v[148:151], a[232:235], a[84:87]
    ds_write2_b32 v224, a96, a97 offset0:16 offset1:84
    v_mfma_f32_16x16x32_bf16 a[84:87], v[184:187], a[228:231], a[84:87]
    ds_write2_b32 v224, a98, a99 offset0:152 offset1:220
    v_mfma_f32_16x16x32_bf16 a[84:87], v[172:175], a[224:227], a[84:87]
    v_mfma_f32_16x16x32_bf16 a[88:91], v[176:179], a[224:227], a[88:91]
    v_mfma_f32_16x16x32_bf16 a[88:91], v[188:191], a[228:231], a[88:91]
    v_mfma_f32_16x16x32_bf16 a[88:91], v[152:155], a[232:235], a[88:91]
    v_mfma_f32_16x16x32_bf16 a[88:91], v[164:167], a[236:239], a[88:91]
    v_mfma_f32_16x16x32_bf16 a[88:91], v[236:239], a[240:243], a[88:91]
    v_mfma_f32_16x16x32_bf16 a[88:91], v[248:251], a[244:247], a[88:91]
    v_mfma_f32_16x16x32_bf16 a[100:103], v[248:251], a[248:251], a[100:103]
    v_mfma_f32_16x16x32_bf16 a[100:103], v[236:239], a[252:255], a[100:103]
    v_mfma_f32_16x16x32_bf16 a[100:103], v[164:167], a[128:131], a[100:103]
    ds_write2_b32 v224, a84, a85 offset0:0 offset1:68
    v_mfma_f32_16x16x32_bf16 a[100:103], v[152:155], a[132:135], a[100:103]
    ds_write2_b32 v224, a86, a87 offset0:136 offset1:204
    v_mfma_f32_16x16x32_bf16 a[100:103], v[188:191], a[136:139], a[100:103]
    ds_read_b128 v[88:91], v225 offset:0
    ds_read_b128 v[92:95], v225 offset:16
    v_mfma_f32_16x16x32_bf16 a[100:103], v[176:179], a[140:143], a[100:103]
    ds_read_b128 v[100:103], v225 offset:2176
    ds_read_b128 v[104:107], v225 offset:2192
    v_mfma_f32_16x16x32_bf16 a[112:115], v[176:179], a[144:147], a[112:115]
    ds_write2_b32 v224, a88, a89 offset0:0 offset1:68
    v_mfma_f32_16x16x32_bf16 a[112:115], v[188:191], a[148:151], a[112:115]
    ds_write2_b32 v224, a90, a91 offset0:136 offset1:204
    v_mfma_f32_16x16x32_bf16 a[112:115], v[152:155], a[152:155], a[112:115]
    s_waitcnt lgkmcnt(4)
    v_mul_f32 v88, v88, v210
    v_mul_f32 v89, v89, v210
    v_mul_f32 v90, v90, v210
    v_mfma_f32_16x16x32_bf16 a[112:115], v[164:167], a[156:159], a[112:115]
    v_mul_f32 v91, v91, v210
    v_mul_f32 v92, v92, v210
    v_mul_f32 v93, v93, v210
    v_mfma_f32_16x16x32_bf16 a[112:115], v[236:239], a[160:163], a[112:115]
    v_mul_f32 v94, v94, v210
    v_mul_f32 v95, v95, v210
    v_cvt_pk_bf16_f32 v96, v88, v89
    v_mfma_f32_16x16x32_bf16 a[112:115], v[248:251], a[164:167], a[112:115]
    v_cvt_pk_bf16_f32 v97, v90, v91
    v_cvt_pk_bf16_f32 v98, v92, v93
    v_cvt_pk_bf16_f32 v99, v94, v95
    v_mfma_f32_16x16x32_bf16 a[124:127], v[248:251], a[168:171], a[124:127]
    buffer_store_dwordx4 v[96:99], v226, s[16:19], s48 offen offset:384 sc1 nt
    v_mfma_f32_16x16x32_bf16 a[124:127], v[236:239], a[172:175], a[124:127]
    ds_write2_b32 v224, a100, a101 offset0:16 offset1:84
    s_waitcnt lgkmcnt(3)
    v_mul_f32 v100, v100, v211
    v_mfma_f32_16x16x32_bf16 a[124:127], v[164:167], a[192:195], a[124:127]
    ds_write2_b32 v224, a102, a103 offset0:152 offset1:220
    v_mul_f32 v101, v101, v211
    v_mfma_f32_16x16x32_bf16 a[124:127], v[152:155], a[196:199], a[124:127]
    ds_write2_b32 v224, a112, a113 offset0:32 offset1:100
    v_mul_f32 v102, v102, v211
    v_mfma_f32_16x16x32_bf16 a[124:127], v[188:191], a[200:203], a[124:127]
    ds_write2_b32 v224, a114, a115 offset0:168 offset1:236
    v_mul_f32 v103, v103, v211
    v_mfma_f32_16x16x32_bf16 a[124:127], v[176:179], a[204:207], a[124:127]
    v_mul_f32 v104, v104, v211
    v_mul_f32 v105, v105, v211
    v_mul_f32 v106, v106, v211
    s_nop 7
    ds_write2_b32 v224, a124, a125 offset0:48 offset1:116
    v_mul_f32 v107, v107, v211
    v_cvt_pk_bf16_f32 v108, v100, v101
    ds_write2_b32 v224, a126, a127 offset0:184 offset1:252
    v_cvt_pk_bf16_f32 v109, v102, v103
    v_cvt_pk_bf16_f32 v110, v104, v105
    ds_read_b128 v[112:115], v225 offset:0
    v_cvt_pk_bf16_f32 v111, v106, v107
    buffer_store_dwordx4 v[108:111], v227, s[16:19], s48 offen offset:384 sc1 nt
    ds_read_b128 v[116:119], v225 offset:16
    ds_read_b128 v[124:127], v225 offset:2176
    ds_read_b128 v[128:131], v225 offset:2192
    s_waitcnt lgkmcnt(2)
    v_mul_f32 v112, v112, v212
    v_mul_f32 v113, v113, v212
    v_mul_f32 v114, v114, v212
    v_mul_f32 v115, v115, v212
    v_mul_f32 v116, v116, v212
    v_mul_f32 v117, v117, v212
    v_mul_f32 v118, v118, v212
    v_mul_f32 v119, v119, v212
    v_cvt_pk_bf16_f32 v120, v112, v113
    v_cvt_pk_bf16_f32 v121, v114, v115
    v_cvt_pk_bf16_f32 v122, v116, v117
    v_cvt_pk_bf16_f32 v123, v118, v119
    buffer_store_dwordx4 v[120:123], v226, s[16:19], s49 offen offset:384 sc1 nt
    s_waitcnt lgkmcnt(0)
    v_mul_f32 v124, v124, v213
    v_mul_f32 v125, v125, v213
    v_mul_f32 v126, v126, v213
    v_mul_f32 v127, v127, v213
    v_mul_f32 v128, v128, v213
    v_mul_f32 v129, v129, v213
    v_mul_f32 v130, v130, v213
    v_mul_f32 v131, v131, v213
    v_cvt_pk_bf16_f32 v132, v124, v125
    v_cvt_pk_bf16_f32 v133, v126, v127
    v_cvt_pk_bf16_f32 v134, v128, v129
    v_cvt_pk_bf16_f32 v135, v130, v131
    buffer_store_dwordx4 v[132:135], v227, s[16:19], s49 offen offset:384 sc1 nt
L_end:
    s_endpgm
L_codeend:
L_tr_first:
    s_call_b64 s[30:31], L_slow_0
    s_branch L_ret_first
L_trf0:
    s_call_b64 s[30:31], L_slow_f0
    s_branch L_nosf0
L_trf1:
    s_call_b64 s[30:31], L_slow_f1
    s_branch L_nosf1
L_slow_0:
    s_nop 15
    v_log_f32 v198, v203
    v_max3_f32 v195, v96, v97, v98
    v_max3_f32 v195, v195, v99, v108
    v_max3_f32 v195, v195, v109, v110
    v_max3_f32 v195, v195, v111, v120
    v_max3_f32 v195, v195, v121, v122
    v_max3_f32 v195, v195, v123, v132
    v_max3_f32 v195, v195, v133, v134
    v_max3_f32 v195, v195, v135, v198
    v_mov_b32 v199, v195
    s_nop 1
    v_permlane32_swap_b32 v195, v199
    s_nop 1
    v_max_f32 v195, v195, v199
    v_mov_b32 v199, v195
    s_nop 1
    v_permlane16_swap_b32 v195, v199
    s_nop 1
    v_max_f32 v195, v195, v199
    v_max_f32 v195, 0, v195
    v_ceil_f32 v195, v195
    v_sub_f32 v208, v208, v195
    v_sub_f32 v209, v209, v195
    v_sub_f32 v210, v210, v195
    v_sub_f32 v211, v211, v195
    v_min_f32 v198, 0x43800000, v195
    v_cvt_i32_f32 v198, v198
    v_sub_u32 v198, 0, v198
    v_ldexp_f32 v192, 1.0, v198
    v_log_f32 v198, v204
    v_max3_f32 v196, v100, v101, v102
    v_max3_f32 v196, v196, v103, v112
    v_max3_f32 v196, v196, v113, v114
    v_max3_f32 v196, v196, v115, v124
    v_max3_f32 v196, v196, v125, v126
    v_max3_f32 v196, v196, v127, v136
    v_max3_f32 v196, v196, v137, v138
    v_max3_f32 v196, v196, v139, v198
    v_mov_b32 v199, v196
    s_nop 1
    v_permlane32_swap_b32 v196, v199
    s_nop 1
    v_max_f32 v196, v196, v199
    v_mov_b32 v199, v196
    s_nop 1
    v_permlane16_swap_b32 v196, v199
    s_nop 1
    v_max_f32 v196, v196, v199
    v_max_f32 v196, 0, v196
    v_ceil_f32 v196, v196
    v_sub_f32 v212, v212, v196
    v_sub_f32 v213, v213, v196
    v_sub_f32 v214, v214, v196
    v_sub_f32 v215, v215, v196
    v_min_f32 v198, 0x43800000, v196
    v_cvt_i32_f32 v198, v198
    v_sub_u32 v198, 0, v198
    v_ldexp_f32 v193, 1.0, v198
    v_log_f32 v198, v205
    v_max3_f32 v197, v104, v105, v106
    v_max3_f32 v197, v197, v107, v116
    v_max3_f32 v197, v197, v117, v118
    v_max3_f32 v197, v197, v119, v128
    v_max3_f32 v197, v197, v129, v130
    v_max3_f32 v197, v197, v131, v140
    v_max3_f32 v197, v197, v141, v142
    v_max3_f32 v197, v197, v143, v198
    v_mov_b32 v199, v197
    s_nop 1
    v_permlane32_swap_b32 v197, v199
    s_nop 1
    v_max_f32 v197, v197, v199
    v_mov_b32 v199, v197
    s_nop 1
    v_permlane16_swap_b32 v197, v199
    s_nop 1
    v_max_f32 v197, v197, v199
    v_max_f32 v197, 0, v197
    v_ceil_f32 v197, v197
    v_sub_f32 v216, v216, v197
    v_sub_f32 v217, v217, v197
    v_sub_f32 v218, v218, v197
    v_sub_f32 v219, v219, v197
    v_min_f32 v198, 0x43800000, v197
    v_cvt_i32_f32 v198, v198
    v_sub_u32 v198, 0, v198
    v_ldexp_f32 v194, 1.0, v198
    v_mbcnt_lo_u32_b32 v198, -1, 0
    v_mbcnt_hi_u32_b32 v198, -1, v198
    v_and_b32 v198, 48, v198
    ds_bpermute_b32 v168, v198, v192 offset:0
    ds_bpermute_b32 v169, v198, v192 offset:4
    ds_bpermute_b32 v170, v198, v192 offset:8
    ds_bpermute_b32 v171, v198, v192 offset:12
    ds_bpermute_b32 v172, v198, v193 offset:0
    ds_bpermute_b32 v173, v198, v193 offset:4
    ds_bpermute_b32 v174, v198, v193 offset:8
    ds_bpermute_b32 v175, v198, v193 offset:12
    ds_bpermute_b32 v176, v198, v194 offset:0
    ds_bpermute_b32 v177, v198, v194 offset:4
    ds_bpermute_b32 v178, v198, v194 offset:8
    ds_bpermute_b32 v179, v198, v194 offset:12
    s_waitcnt lgkmcnt(0)
    v_mul_f32 v0, v0, v168
    v_mul_f32 v1, v1, v169
    v_mul_f32 v2, v2, v170
    v_mul_f32 v3, v3, v171
    v_mul_f32 v4, v4, v172
    v_mul_f32 v5, v5, v173
    v_mul_f32 v6, v6, v174
    v_mul_f32 v7, v7, v175
    v_mul_f32 v8, v8, v176
    v_mul_f32 v9, v9, v177
    v_mul_f32 v10, v10, v178
    v_mul_f32 v11, v11, v179
    v_mul_f32 v12, v12, v168
    v_mul_f32 v13, v13, v169
    v_mul_f32 v14, v14, v170
    v_mul_f32 v15, v15, v171
    v_mul_f32 v16, v16, v172
    v_mul_f32 v17, v17, v173
    v_mul_f32 v18, v18, v174
    v_mul_f32 v19, v19, v175
    v_mul_f32 v20, v20, v176
    v_mul_f32 v21, v21, v177
    v_mul_f32 v22, v22, v178
    v_mul_f32 v23, v23, v179
    v_mul_f32 v24, v24, v168
    v_mul_f32 v25, v25, v169
    v_mul_f32 v26, v26, v170
    v_mul_f32 v27, v27, v171
    v_mul_f32 v28, v28, v172
    v_mul_f32 v29, v29, v173
    v_mul_f32 v30, v30, v174
    v_mul_f32 v31, v31, v175
    v_mul_f32 v32, v32, v176
    v_mul_f32 v33, v33, v177
    v_mul_f32 v34, v34, v178
    v_mul_f32 v35, v35, v179
    v_mul_f32 v36, v36, v168
    v_mul_f32 v37, v37, v169
    v_mul_f32 v38, v38, v170
    v_mul_f32 v39, v39, v171
    v_mul_f32 v40, v40, v172
    v_mul_f32 v41, v41, v173
    v_mul_f32 v42, v42, v174
    v_mul_f32 v43, v43, v175
    v_mul_f32 v44, v44, v176
    v_mul_f32 v45, v45, v177
    v_mul_f32 v46, v46, v178
    v_mul_f32 v47, v47, v179
    v_mul_f32 v48, v48, v168
    v_mul_f32 v49, v49, v169
    v_mul_f32 v50, v50, v170
    v_mul_f32 v51, v51, v171
    v_mul_f32 v52, v52, v172
    v_mul_f32 v53, v53, v173
    v_mul_f32 v54, v54, v174
    v_mul_f32 v55, v55, v175
    v_mul_f32 v56, v56, v176
    v_mul_f32 v57, v57, v177
    v_mul_f32 v58, v58, v178
    v_mul_f32 v59, v59, v179
    v_mul_f32 v60, v60, v168
    v_mul_f32 v61, v61, v169
    v_mul_f32 v62, v62, v170
    v_mul_f32 v63, v63, v171
    v_accvgpr_read_b32 v198, a0
    v_accvgpr_read_b32 v199, a1
    v_accvgpr_read_b32 v252, a2
    v_accvgpr_read_b32 v255, a3
    v_mul_f32 v198, v198, v172
    v_mul_f32 v199, v199, v173
    v_mul_f32 v252, v252, v174
    v_mul_f32 v255, v255, v175
    v_accvgpr_write_b32 a0, v198
    v_accvgpr_write_b32 a1, v199
    v_accvgpr_write_b32 a2, v252
    v_accvgpr_write_b32 a3, v255
    v_accvgpr_read_b32 v198, a4
    v_accvgpr_read_b32 v199, a5
    v_accvgpr_read_b32 v252, a6
    v_accvgpr_read_b32 v255, a7
    v_mul_f32 v198, v198, v176
    v_mul_f32 v199, v199, v177
    v_mul_f32 v252, v252, v178
    v_mul_f32 v255, v255, v179
    v_accvgpr_write_b32 a4, v198
    v_accvgpr_write_b32 a5, v199
    v_accvgpr_write_b32 a6, v252
    v_accvgpr_write_b32 a7, v255
    v_accvgpr_read_b32 v198, a8
    v_accvgpr_read_b32 v199, a9
    v_accvgpr_read_b32 v252, a10
    v_accvgpr_read_b32 v255, a11
    v_mul_f32 v198, v198, v168
    v_mul_f32 v199, v199, v169
    v_mul_f32 v252, v252, v170
    v_mul_f32 v255, v255, v171
    v_accvgpr_write_b32 a8, v198
    v_accvgpr_write_b32 a9, v199
    v_accvgpr_write_b32 a10, v252
    v_accvgpr_write_b32 a11, v255
    v_accvgpr_read_b32 v198, a12
    v_accvgpr_read_b32 v199, a13
    v_accvgpr_read_b32 v252, a14
    v_accvgpr_read_b32 v255, a15
    v_mul_f32 v198, v198, v172
    v_mul_f32 v199, v199, v173
    v_mul_f32 v252, v252, v174
    v_mul_f32 v255, v255, v175
    v_accvgpr_write_b32 a12, v198
    v_accvgpr_write_b32 a13, v199
    v_accvgpr_write_b32 a14, v252
    v_accvgpr_write_b32 a15, v255
    v_accvgpr_read_b32 v198, a16
    v_accvgpr_read_b32 v199, a17
    v_accvgpr_read_b32 v252, a18
    v_accvgpr_read_b32 v255, a19
    v_mul_f32 v198, v198, v176
    v_mul_f32 v199, v199, v177
    v_mul_f32 v252, v252, v178
    v_mul_f32 v255, v255, v179
    v_accvgpr_write_b32 a16, v198
    v_accvgpr_write_b32 a17, v199
    v_accvgpr_write_b32 a18, v252
    v_accvgpr_write_b32 a19, v255
    v_accvgpr_read_b32 v198, a20
    v_accvgpr_read_b32 v199, a21
    v_accvgpr_read_b32 v252, a22
    v_accvgpr_read_b32 v255, a23
    v_mul_f32 v198, v198, v168
    v_mul_f32 v199, v199, v169
    v_mul_f32 v252, v252, v170
    v_mul_f32 v255, v255, v171
    v_accvgpr_write_b32 a20, v198
    v_accvgpr_write_b32 a21, v199
    v_accvgpr_write_b32 a22, v252
    v_accvgpr_write_b32 a23, v255
    v_accvgpr_read_b32 v198, a24
    v_accvgpr_read_b32 v199, a25
    v_accvgpr_read_b32 v252, a26
    v_accvgpr_read_b32 v255, a27
    v_mul_f32 v198, v198, v172
    v_mul_f32 v199, v199, v173
    v_mul_f32 v252, v252, v174
    v_mul_f32 v255, v255, v175
    v_accvgpr_write_b32 a24, v198
    v_accvgpr_write_b32 a25, v199
    v_accvgpr_write_b32 a26, v252
    v_accvgpr_write_b32 a27, v255
    v_accvgpr_read_b32 v198, a28
    v_accvgpr_read_b32 v199, a29
    v_accvgpr_read_b32 v252, a30
    v_accvgpr_read_b32 v255, a31
    v_mul_f32 v198, v198, v176
    v_mul_f32 v199, v199, v177
    v_mul_f32 v252, v252, v178
    v_mul_f32 v255, v255, v179
    v_accvgpr_write_b32 a28, v198
    v_accvgpr_write_b32 a29, v199
    v_accvgpr_write_b32 a30, v252
    v_accvgpr_write_b32 a31, v255
    v_accvgpr_read_b32 v198, a32
    v_accvgpr_read_b32 v199, a33
    v_accvgpr_read_b32 v252, a34
    v_accvgpr_read_b32 v255, a35
    v_mul_f32 v198, v198, v168
    v_mul_f32 v199, v199, v169
    v_mul_f32 v252, v252, v170
    v_mul_f32 v255, v255, v171
    v_accvgpr_write_b32 a32, v198
    v_accvgpr_write_b32 a33, v199
    v_accvgpr_write_b32 a34, v252
    v_accvgpr_write_b32 a35, v255
    v_accvgpr_read_b32 v198, a36
    v_accvgpr_read_b32 v199, a37
    v_accvgpr_read_b32 v252, a38
    v_accvgpr_read_b32 v255, a39
    v_mul_f32 v198, v198, v172
    v_mul_f32 v199, v199, v173
    v_mul_f32 v252, v252, v174
    v_mul_f32 v255, v255, v175
    v_accvgpr_write_b32 a36, v198
    v_accvgpr_write_b32 a37, v199
    v_accvgpr_write_b32 a38, v252
    v_accvgpr_write_b32 a39, v255
    v_accvgpr_read_b32 v198, a40
    v_accvgpr_read_b32 v199, a41
    v_accvgpr_read_b32 v252, a42
    v_accvgpr_read_b32 v255, a43
    v_mul_f32 v198, v198, v176
    v_mul_f32 v199, v199, v177
    v_mul_f32 v252, v252, v178
    v_mul_f32 v255, v255, v179
    v_accvgpr_write_b32 a40, v198
    v_accvgpr_write_b32 a41, v199
    v_accvgpr_write_b32 a42, v252
    v_accvgpr_write_b32 a43, v255
    v_accvgpr_read_b32 v198, a44
    v_accvgpr_read_b32 v199, a45
    v_accvgpr_read_b32 v252, a46
    v_accvgpr_read_b32 v255, a47
    v_mul_f32 v198, v198, v168
    v_mul_f32 v199, v199, v169
    v_mul_f32 v252, v252, v170
    v_mul_f32 v255, v255, v171
    v_accvgpr_write_b32 a44, v198
    v_accvgpr_write_b32 a45, v199
    v_accvgpr_write_b32 a46, v252
    v_accvgpr_write_b32 a47, v255
    v_accvgpr_read_b32 v198, a48
    v_accvgpr_read_b32 v199, a49
    v_accvgpr_read_b32 v252, a50
    v_accvgpr_read_b32 v255, a51
    v_mul_f32 v198, v198, v172
    v_mul_f32 v199, v199, v173
    v_mul_f32 v252, v252, v174
    v_mul_f32 v255, v255, v175
    v_accvgpr_write_b32 a48, v198
    v_accvgpr_write_b32 a49, v199
    v_accvgpr_write_b32 a50, v252
    v_accvgpr_write_b32 a51, v255
    v_accvgpr_read_b32 v198, a52
    v_accvgpr_read_b32 v199, a53
    v_accvgpr_read_b32 v252, a54
    v_accvgpr_read_b32 v255, a55
    v_mul_f32 v198, v198, v176
    v_mul_f32 v199, v199, v177
    v_mul_f32 v252, v252, v178
    v_mul_f32 v255, v255, v179
    v_accvgpr_write_b32 a52, v198
    v_accvgpr_write_b32 a53, v199
    v_accvgpr_write_b32 a54, v252
    v_accvgpr_write_b32 a55, v255
    v_accvgpr_read_b32 v198, a56
    v_accvgpr_read_b32 v199, a57
    v_accvgpr_read_b32 v252, a58
    v_accvgpr_read_b32 v255, a59
    v_mul_f32 v198, v198, v168
    v_mul_f32 v199, v199, v169
    v_mul_f32 v252, v252, v170
    v_mul_f32 v255, v255, v171
    v_accvgpr_write_b32 a56, v198
    v_accvgpr_write_b32 a57, v199
    v_accvgpr_write_b32 a58, v252
    v_accvgpr_write_b32 a59, v255
    v_accvgpr_read_b32 v198, a60
    v_accvgpr_read_b32 v199, a61
    v_accvgpr_read_b32 v252, a62
    v_accvgpr_read_b32 v255, a63
    v_mul_f32 v198, v198, v172
    v_mul_f32 v199, v199, v173
    v_mul_f32 v252, v252, v174
    v_mul_f32 v255, v255, v175
    v_accvgpr_write_b32 a60, v198
    v_accvgpr_write_b32 a61, v199
    v_accvgpr_write_b32 a62, v252
    v_accvgpr_write_b32 a63, v255
    v_accvgpr_read_b32 v198, a64
    v_accvgpr_read_b32 v199, a65
    v_accvgpr_read_b32 v252, a66
    v_accvgpr_read_b32 v255, a67
    v_mul_f32 v198, v198, v176
    v_mul_f32 v199, v199, v177
    v_mul_f32 v252, v252, v178
    v_mul_f32 v255, v255, v179
    v_accvgpr_write_b32 a64, v198
    v_accvgpr_write_b32 a65, v199
    v_accvgpr_write_b32 a66, v252
    v_accvgpr_write_b32 a67, v255
    v_accvgpr_read_b32 v198, a68
    v_accvgpr_read_b32 v199, a69
    v_accvgpr_read_b32 v252, a70
    v_accvgpr_read_b32 v255, a71
    v_mul_f32 v198, v198, v168
    v_mul_f32 v199, v199, v169
    v_mul_f32 v252, v252, v170
    v_mul_f32 v255, v255, v171
    v_accvgpr_write_b32 a68, v198
    v_accvgpr_write_b32 a69, v199
    v_accvgpr_write_b32 a70, v252
    v_accvgpr_write_b32 a71, v255
    v_accvgpr_read_b32 v198, a72
    v_accvgpr_read_b32 v199, a73
    v_accvgpr_read_b32 v252, a74
    v_accvgpr_read_b32 v255, a75
    v_mul_f32 v198, v198, v172
    v_mul_f32 v199, v199, v173
    v_mul_f32 v252, v252, v174
    v_mul_f32 v255, v255, v175
    v_accvgpr_write_b32 a72, v198
    v_accvgpr_write_b32 a73, v199
    v_accvgpr_write_b32 a74, v252
    v_accvgpr_write_b32 a75, v255
    v_accvgpr_read_b32 v198, a76
    v_accvgpr_read_b32 v199, a77
    v_accvgpr_read_b32 v252, a78
    v_accvgpr_read_b32 v255, a79
    v_mul_f32 v198, v198, v176
    v_mul_f32 v199, v199, v177
    v_mul_f32 v252, v252, v178
    v_mul_f32 v255, v255, v179
    v_accvgpr_write_b32 a76, v198
    v_accvgpr_write_b32 a77, v199
    v_accvgpr_write_b32 a78, v252
    v_accvgpr_write_b32 a79, v255
    v_accvgpr_read_b32 v198, a80
    v_accvgpr_read_b32 v199, a81
    v_accvgpr_read_b32 v252, a82
    v_accvgpr_read_b32 v255, a83
    v_mul_f32 v198, v198, v168
    v_mul_f32 v199, v199, v169
    v_mul_f32 v252, v252, v170
    v_mul_f32 v255, v255, v171
    v_accvgpr_write_b32 a80, v198
    v_accvgpr_write_b32 a81, v199
    v_accvgpr_write_b32 a82, v252
    v_accvgpr_write_b32 a83, v255
    v_accvgpr_read_b32 v198, a84
    v_accvgpr_read_b32 v199, a85
    v_accvgpr_read_b32 v252, a86
    v_accvgpr_read_b32 v255, a87
    v_mul_f32 v198, v198, v172
    v_mul_f32 v199, v199, v173
    v_mul_f32 v252, v252, v174
    v_mul_f32 v255, v255, v175
    v_accvgpr_write_b32 a84, v198
    v_accvgpr_write_b32 a85, v199
    v_accvgpr_write_b32 a86, v252
    v_accvgpr_write_b32 a87, v255
    v_accvgpr_read_b32 v198, a88
    v_accvgpr_read_b32 v199, a89
    v_accvgpr_read_b32 v252, a90
    v_accvgpr_read_b32 v255, a91
    v_mul_f32 v198, v198, v176
    v_mul_f32 v199, v199, v177
    v_mul_f32 v252, v252, v178
    v_mul_f32 v255, v255, v179
    v_accvgpr_write_b32 a88, v198
    v_accvgpr_write_b32 a89, v199
    v_accvgpr_write_b32 a90, v252
    v_accvgpr_write_b32 a91, v255
    v_accvgpr_read_b32 v198, a92
    v_accvgpr_read_b32 v199, a93
    v_accvgpr_read_b32 v252, a94
    v_accvgpr_read_b32 v255, a95
    v_mul_f32 v198, v198, v168
    v_mul_f32 v199, v199, v169
    v_mul_f32 v252, v252, v170
    v_mul_f32 v255, v255, v171
    v_accvgpr_write_b32 a92, v198
    v_accvgpr_write_b32 a93, v199
    v_accvgpr_write_b32 a94, v252
    v_accvgpr_write_b32 a95, v255
    v_accvgpr_read_b32 v198, a96
    v_accvgpr_read_b32 v199, a97
    v_accvgpr_read_b32 v252, a98
    v_accvgpr_read_b32 v255, a99
    v_mul_f32 v198, v198, v172
    v_mul_f32 v199, v199, v173
    v_mul_f32 v252, v252, v174
    v_mul_f32 v255, v255, v175
    v_accvgpr_write_b32 a96, v198
    v_accvgpr_write_b32 a97, v199
    v_accvgpr_write_b32 a98, v252
    v_accvgpr_write_b32 a99, v255
    v_accvgpr_read_b32 v198, a100
    v_accvgpr_read_b32 v199, a101
    v_accvgpr_read_b32 v252, a102
    v_accvgpr_read_b32 v255, a103
    v_mul_f32 v198, v198, v176
    v_mul_f32 v199, v199, v177
    v_mul_f32 v252, v252, v178
    v_mul_f32 v255, v255, v179
    v_accvgpr_write_b32 a100, v198
    v_accvgpr_write_b32 a101, v199
    v_accvgpr_write_b32 a102, v252
    v_accvgpr_write_b32 a103, v255
    v_accvgpr_read_b32 v198, a104
    v_accvgpr_read_b32 v199, a105
    v_accvgpr_read_b32 v252, a106
    v_accvgpr_read_b32 v255, a107
    v_mul_f32 v198, v198, v168
    v_mul_f32 v199, v199, v169
    v_mul_f32 v252, v252, v170
    v_mul_f32 v255, v255, v171
    v_accvgpr_write_b32 a104, v198
    v_accvgpr_write_b32 a105, v199
    v_accvgpr_write_b32 a106, v252
    v_accvgpr_write_b32 a107, v255
    v_accvgpr_read_b32 v198, a108
    v_accvgpr_read_b32 v199, a109
    v_accvgpr_read_b32 v252, a110
    v_accvgpr_read_b32 v255, a111
    v_mul_f32 v198, v198, v172
    v_mul_f32 v199, v199, v173
    v_mul_f32 v252, v252, v174
    v_mul_f32 v255, v255, v175
    v_accvgpr_write_b32 a108, v198
    v_accvgpr_write_b32 a109, v199
    v_accvgpr_write_b32 a110, v252
    v_accvgpr_write_b32 a111, v255
    v_accvgpr_read_b32 v198, a112
    v_accvgpr_read_b32 v199, a113
    v_accvgpr_read_b32 v252, a114
    v_accvgpr_read_b32 v255, a115
    v_mul_f32 v198, v198, v176
    v_mul_f32 v199, v199, v177
    v_mul_f32 v252, v252, v178
    v_mul_f32 v255, v255, v179
    v_accvgpr_write_b32 a112, v198
    v_accvgpr_write_b32 a113, v199
    v_accvgpr_write_b32 a114, v252
    v_accvgpr_write_b32 a115, v255
    v_accvgpr_read_b32 v198, a116
    v_accvgpr_read_b32 v199, a117
    v_accvgpr_read_b32 v252, a118
    v_accvgpr_read_b32 v255, a119
    v_mul_f32 v198, v198, v168
    v_mul_f32 v199, v199, v169
    v_mul_f32 v252, v252, v170
    v_mul_f32 v255, v255, v171
    v_accvgpr_write_b32 a116, v198
    v_accvgpr_write_b32 a117, v199
    v_accvgpr_write_b32 a118, v252
    v_accvgpr_write_b32 a119, v255
    v_accvgpr_read_b32 v198, a120
    v_accvgpr_read_b32 v199, a121
    v_accvgpr_read_b32 v252, a122
    v_accvgpr_read_b32 v255, a123
    v_mul_f32 v198, v198, v172
    v_mul_f32 v199, v199, v173
    v_mul_f32 v252, v252, v174
    v_mul_f32 v255, v255, v175
    v_accvgpr_write_b32 a120, v198
    v_accvgpr_write_b32 a121, v199
    v_accvgpr_write_b32 a122, v252
    v_accvgpr_write_b32 a123, v255
    v_accvgpr_read_b32 v198, a124
    v_accvgpr_read_b32 v199, a125
    v_accvgpr_read_b32 v252, a126
    v_accvgpr_read_b32 v255, a127
    v_mul_f32 v198, v198, v176
    v_mul_f32 v199, v199, v177
    v_mul_f32 v252, v252, v178
    v_mul_f32 v255, v255, v179
    v_accvgpr_write_b32 a124, v198
    v_accvgpr_write_b32 a125, v199
    v_accvgpr_write_b32 a126, v252
    v_accvgpr_write_b32 a127, v255
    v_mul_f32 v200, v203, v192
    v_sub_f32 v198, v96, v195
    v_sub_f32 v199, v97, v195
    v_sub_f32 v252, v98, v195
    v_sub_f32 v255, v99, v195
    v_exp_f32 v198, v198
    v_exp_f32 v199, v199
    v_exp_f32 v252, v252
    v_exp_f32 v255, v255
    s_nop 0
    v_add_f32 v200, v200, v198
    v_add_f32 v200, v200, v199
    v_add_f32 v200, v200, v252
    v_add_f32 v200, v200, v255
    v_cvt_pk_bf16_f32 v168, v198, v199
    v_cvt_pk_bf16_f32 v169, v252, v255
    v_sub_f32 v198, v108, v195
    v_sub_f32 v199, v109, v195
    v_sub_f32 v252, v110, v195
    v_sub_f32 v255, v111, v195
    v_exp_f32 v198, v198
    v_exp_f32 v199, v199
    v_exp_f32 v252, v252
    v_exp_f32 v255, v255
    s_nop 0
    v_add_f32 v200, v200, v198
    v_add_f32 v200, v200, v199
    v_add_f32 v200, v200, v252
    v_add_f32 v200, v200, v255
    v_cvt_pk_bf16_f32 v170, v198, v199
    v_cvt_pk_bf16_f32 v171, v252, v255
    v_sub_f32 v198, v120, v195
    v_sub_f32 v199, v121, v195
    v_sub_f32 v252, v122, v195
    v_sub_f32 v255, v123, v195
    v_exp_f32 v198, v198
    v_exp_f32 v199, v199
    v_exp_f32 v252, v252
    v_exp_f32 v255, v255
    s_nop 0
    v_add_f32 v200, v200, v198
    v_add_f32 v200, v200, v199
    v_add_f32 v200, v200, v252
    v_add_f32 v200, v200, v255
    v_cvt_pk_bf16_f32 v180, v198, v199
    v_cvt_pk_bf16_f32 v181, v252, v255
    v_sub_f32 v198, v132, v195
    v_sub_f32 v199, v133, v195
    v_sub_f32 v252, v134, v195
    v_sub_f32 v255, v135, v195
    v_exp_f32 v198, v198
    v_exp_f32 v199, v199
    v_exp_f32 v252, v252
    v_exp_f32 v255, v255
    s_nop 0
    v_add_f32 v200, v200, v198
    v_add_f32 v200, v200, v199
    v_add_f32 v200, v200, v252
    v_add_f32 v200, v200, v255
    v_cvt_pk_bf16_f32 v182, v198, v199
    v_cvt_pk_bf16_f32 v183, v252, v255
    v_mul_f32 v201, v204, v193
    v_sub_f32 v198, v100, v196
    v_sub_f32 v199, v101, v196
    v_sub_f32 v252, v102, v196
    v_sub_f32 v255, v103, v196
    v_exp_f32 v198, v198
    v_exp_f32 v199, v199
    v_exp_f32 v252, v252
    v_exp_f32 v255, v255
    s_nop 0
    v_add_f32 v201, v201, v198
    v_add_f32 v201, v201, v199
    v_add_f32 v201, v201, v252
    v_add_f32 v201, v201, v255
    v_cvt_pk_bf16_f32 v172, v198, v199
    v_cvt_pk_bf16_f32 v173, v252, v255
    v_sub_f32 v198, v112, v196
    v_sub_f32 v199, v113, v196
    v_sub_f32 v252, v114, v196
    v_sub_f32 v255, v115, v196
    v_exp_f32 v198, v198
    v_exp_f32 v199, v199
    v_exp_f32 v252, v252
    v_exp_f32 v255, v255
    s_nop 0
    v_add_f32 v201, v201, v198
    v_add_f32 v201, v201, v199
    v_add_f32 v201, v201, v252
    v_add_f32 v201, v201, v255
    v_cvt_pk_bf16_f32 v174, v198, v199
    v_cvt_pk_bf16_f32 v175, v252, v255
    v_sub_f32 v198, v124, v196
    v_sub_f32 v199, v125, v196
    v_sub_f32 v252, v126, v196
    v_sub_f32 v255, v127, v196
    v_exp_f32 v198, v198
    v_exp_f32 v199, v199
    v_exp_f32 v252, v252
    v_exp_f32 v255, v255
    s_nop 0
    v_add_f32 v201, v201, v198
    v_add_f32 v201, v201, v199
    v_add_f32 v201, v201, v252
    v_add_f32 v201, v201, v255
    v_cvt_pk_bf16_f32 v184, v198, v199
    v_cvt_pk_bf16_f32 v185, v252, v255
    v_sub_f32 v198, v136, v196
    v_sub_f32 v199, v137, v196
    v_sub_f32 v252, v138, v196
    v_sub_f32 v255, v139, v196
    v_exp_f32 v198, v198
    v_exp_f32 v199, v199
    v_exp_f32 v252, v252
    v_exp_f32 v255, v255
    s_nop 0
    v_add_f32 v201, v201, v198
    v_add_f32 v201, v201, v199
    v_add_f32 v201, v201, v252
    v_add_f32 v201, v201, v255
    v_cvt_pk_bf16_f32 v186, v198, v199
    v_cvt_pk_bf16_f32 v187, v252, v255
    v_mul_f32 v202, v205, v194
    v_sub_f32 v198, v104, v197
    v_sub_f32 v199, v105, v197
    v_sub_f32 v252, v106, v197
    v_sub_f32 v255, v107, v197
    v_exp_f32 v198, v198
    v_exp_f32 v199, v199
    v_exp_f32 v252, v252
    v_exp_f32 v255, v255
    s_nop 0
    v_add_f32 v202, v202, v198
    v_add_f32 v202, v202, v199
    v_add_f32 v202, v202, v252
    v_add_f32 v202, v202, v255
    v_cvt_pk_bf16_f32 v176, v198, v199
    v_cvt_pk_bf16_f32 v177, v252, v255
    v_sub_f32 v198, v116, v197
    v_sub_f32 v199, v117, v197
    v_sub_f32 v252, v118, v197
    v_sub_f32 v255, v119, v197
    v_exp_f32 v198, v198
    v_exp_f32 v199, v199
    v_exp_f32 v252, v252
    v_exp_f32 v255, v255
    s_nop 0
    v_add_f32 v202, v202, v198
    v_add_f32 v202, v202, v199
    v_add_f32 v202, v202, v252
    v_add_f32 v202, v202, v255
    v_cvt_pk_bf16_f32 v178, v198, v199
    v_cvt_pk_bf16_f32 v179, v252, v255
    v_sub_f32 v198, v128, v197
    v_sub_f32 v199, v129, v197
    v_sub_f32 v252, v130, v197
    v_sub_f32 v255, v131, v197
    v_exp_f32 v198, v198
    v_exp_f32 v199, v199
    v_exp_f32 v252, v252
    v_exp_f32 v255, v255
    s_nop 0
    v_add_f32 v202, v202, v198
    v_add_f32 v202, v202, v199
    v_add_f32 v202, v202, v252
    v_add_f32 v202, v202, v255
    v_cvt_pk_bf16_f32 v188, v198, v199
    v_cvt_pk_bf16_f32 v189, v252, v255
    v_sub_f32 v198, v140, v197
    v_sub_f32 v199, v141, v197
    v_sub_f32 v252, v142, v197
    v_sub_f32 v255, v143, v197
    v_exp_f32 v198, v198
    v_exp_f32 v199, v199
    v_exp_f32 v252, v252
    v_exp_f32 v255, v255
    s_nop 0
    v_add_f32 v202, v202, v198
    v_add_f32 v202, v202, v199
    v_add_f32 v202, v202, v252
    v_add_f32 v202, v202, v255
    v_cvt_pk_bf16_f32 v190, v198, v199
    v_cvt_pk_bf16_f32 v191, v252, v255
    s_nop 3
    s_setpc_b64 s[30:31]
L_slow_1:
    s_nop 15
    v_log_f32 v198, v200
    v_max3_f32 v195, v96, v97, v98
    v_max3_f32 v195, v195, v99, v108
    v_max3_f32 v195, v195, v109, v110
    v_max3_f32 v195, v195, v111, v120
    v_max3_f32 v195, v195, v121, v122
    v_max3_f32 v195, v195, v123, v132
    v_max3_f32 v195, v195, v133, v134
    v_max3_f32 v195, v195, v135, v198
    v_mov_b32 v199, v195
    s_nop 1
    v_permlane32_swap_b32 v195, v199
    s_nop 1
    v_max_f32 v195, v195, v199
    v_mov_b32 v199, v195
    s_nop 1
    v_permlane16_swap_b32 v195, v199
    s_nop 1
    v_max_f32 v195, v195, v199
    v_max_f32 v195, 0, v195
    v_ceil_f32 v195, v195
    v_sub_f32 v208, v208, v195
    v_sub_f32 v209, v209, v195
    v_sub_f32 v210, v210, v195
    v_sub_f32 v211, v211, v195
    v_min_f32 v198, 0x43800000, v195
    v_cvt_i32_f32 v198, v198
    v_sub_u32 v198, 0, v198
    v_ldexp_f32 v192, 1.0, v198
    v_log_f32 v198, v201
    v_max3_f32 v196, v100, v101, v102
    v_max3_f32 v196, v196, v103, v112
    v_max3_f32 v196, v196, v113, v114
    v_max3_f32 v196, v196, v115, v124
    v_max3_f32 v196, v196, v125, v126
    v_max3_f32 v196, v196, v127, v136
    v_max3_f32 v196, v196, v137, v138
    v_max3_f32 v196, v196, v139, v198
    v_mov_b32 v199, v196
    s_nop 1
    v_permlane32_swap_b32 v196, v199
    s_nop 1
    v_max_f32 v196, v196, v199
    v_mov_b32 v199, v196
    s_nop 1
    v_permlane16_swap_b32 v196, v199
    s_nop 1
    v_max_f32 v196, v196, v199
    v_max_f32 v196, 0, v196
    v_ceil_f32 v196, v196
    v_sub_f32 v212, v212, v196
    v_sub_f32 v213, v213, v196
    v_sub_f32 v214, v214, v196
    v_sub_f32 v215, v215, v196
    v_min_f32 v198, 0x43800000, v196
    v_cvt_i32_f32 v198, v198
    v_sub_u32 v198, 0, v198
    v_ldexp_f32 v193, 1.0, v198
    v_log_f32 v198, v202
    v_max3_f32 v197, v104, v105, v106
    v_max3_f32 v197, v197, v107, v116
    v_max3_f32 v197, v197, v117, v118
    v_max3_f32 v197, v197, v119, v128
    v_max3_f32 v197, v197, v129, v130
    v_max3_f32 v197, v197, v131, v140
    v_max3_f32 v197, v197, v141, v142
    v_max3_f32 v197, v197, v143, v198
    v_mov_b32 v199, v197
    s_nop 1
    v_permlane32_swap_b32 v197, v199
    s_nop 1
    v_max_f32 v197, v197, v199
    v_mov_b32 v199, v197
    s_nop 1
    v_permlane16_swap_b32 v197, v199
    s_nop 1
    v_max_f32 v197, v197, v199
    v_max_f32 v197, 0, v197
    v_ceil_f32 v197, v197
    v_sub_f32 v216, v216, v197
    v_sub_f32 v217, v217, v197
    v_sub_f32 v218, v218, v197
    v_sub_f32 v219, v219, v197
    v_min_f32 v198, 0x43800000, v197
    v_cvt_i32_f32 v198, v198
    v_sub_u32 v198, 0, v198
    v_ldexp_f32 v194, 1.0, v198
    v_mbcnt_lo_u32_b32 v198, -1, 0
    v_mbcnt_hi_u32_b32 v198, -1, v198
    v_and_b32 v198, 48, v198
    ds_bpermute_b32 v144, v198, v192 offset:0
    ds_bpermute_b32 v145, v198, v192 offset:4
    ds_bpermute_b32 v146, v198, v192 offset:8
    ds_bpermute_b32 v147, v198, v192 offset:12
    ds_bpermute_b32 v148, v198, v193 offset:0
    ds_bpermute_b32 v149, v198, v193 offset:4
    ds_bpermute_b32 v150, v198, v193 offset:8
    ds_bpermute_b32 v151, v198, v193 offset:12
    ds_bpermute_b32 v152, v198, v194 offset:0
    ds_bpermute_b32 v153, v198, v194 offset:4
    ds_bpermute_b32 v154, v198, v194 offset:8
    ds_bpermute_b32 v155, v198, v194 offset:12
    s_waitcnt lgkmcnt(0)
    v_mul_f32 v0, v0, v144
    v_mul_f32 v1, v1, v145
    v_mul_f32 v2, v2, v146
    v_mul_f32 v3, v3, v147
    v_mul_f32 v4, v4, v148
    v_mul_f32 v5, v5, v149
    v_mul_f32 v6, v6, v150
    v_mul_f32 v7, v7, v151
    v_mul_f32 v8, v8, v152
    v_mul_f32 v9, v9, v153
    v_mul_f32 v10, v10, v154
    v_mul_f32 v11, v11, v155
    v_mul_f32 v12, v12, v144
    v_mul_f32 v13, v13, v145
    v_mul_f32 v14, v14, v146
    v_mul_f32 v15, v15, v147
    v_mul_f32 v16, v16, v148
    v_mul_f32 v17, v17, v149
    v_mul_f32 v18, v18, v150
    v_mul_f32 v19, v19, v151
    v_mul_f32 v20, v20, v152
    v_mul_f32 v21, v21, v153
    v_mul_f32 v22, v22, v154
    v_mul_f32 v23, v23, v155
    v_mul_f32 v24, v24, v144
    v_mul_f32 v25, v25, v145
    v_mul_f32 v26, v26, v146
    v_mul_f32 v27, v27, v147
    v_mul_f32 v28, v28, v148
    v_mul_f32 v29, v29, v149
    v_mul_f32 v30, v30, v150
    v_mul_f32 v31, v31, v151
    v_mul_f32 v32, v32, v152
    v_mul_f32 v33, v33, v153
    v_mul_f32 v34, v34, v154
    v_mul_f32 v35, v35, v155
    v_mul_f32 v36, v36, v144
    v_mul_f32 v37, v37, v145
    v_mul_f32 v38, v38, v146
    v_mul_f32 v39, v39, v147
    v_mul_f32 v40, v40, v148
    v_mul_f32 v41, v41, v149
    v_mul_f32 v42, v42, v150
    v_mul_f32 v43, v43, v151
    v_mul_f32 v44, v44, v152
    v_mul_f32 v45, v45, v153
    v_mul_f32 v46, v46, v154
    v_mul_f32 v47, v47, v155
    v_mul_f32 v48, v48, v144
    v_mul_f32 v49, v49, v145
    v_mul_f32 v50, v50, v146
    v_mul_f32 v51, v51, v147
    v_mul_f32 v52, v52, v148
    v_mul_f32 v53, v53, v149
    v_mul_f32 v54, v54, v150
    v_mul_f32 v55, v55, v151
    v_mul_f32 v56, v56, v152
    v_mul_f32 v57, v57, v153
    v_mul_f32 v58, v58, v154
    v_mul_f32 v59, v59, v155
    v_mul_f32 v60, v60, v144
    v_mul_f32 v61, v61, v145
    v_mul_f32 v62, v62, v146
    v_mul_f32 v63, v63, v147
    v_accvgpr_read_b32 v198, a0
    v_accvgpr_read_b32 v199, a1
    v_accvgpr_read_b32 v252, a2
    v_accvgpr_read_b32 v255, a3
    v_mul_f32 v198, v198, v148
    v_mul_f32 v199, v199, v149
    v_mul_f32 v252, v252, v150
    v_mul_f32 v255, v255, v151
    v_accvgpr_write_b32 a0, v198
    v_accvgpr_write_b32 a1, v199
    v_accvgpr_write_b32 a2, v252
    v_accvgpr_write_b32 a3, v255
    v_accvgpr_read_b32 v198, a4
    v_accvgpr_read_b32 v199, a5
    v_accvgpr_read_b32 v252, a6
    v_accvgpr_read_b32 v255, a7
    v_mul_f32 v198, v198, v152
    v_mul_f32 v199, v199, v153
    v_mul_f32 v252, v252, v154
    v_mul_f32 v255, v255, v155
    v_accvgpr_write_b32 a4, v198
    v_accvgpr_write_b32 a5, v199
    v_accvgpr_write_b32 a6, v252
    v_accvgpr_write_b32 a7, v255
    v_accvgpr_read_b32 v198, a8
    v_accvgpr_read_b32 v199, a9
    v_accvgpr_read_b32 v252, a10
    v_accvgpr_read_b32 v255, a11
    v_mul_f32 v198, v198, v144
    v_mul_f32 v199, v199, v145
    v_mul_f32 v252, v252, v146
    v_mul_f32 v255, v255, v147
    v_accvgpr_write_b32 a8, v198
    v_accvgpr_write_b32 a9, v199
    v_accvgpr_write_b32 a10, v252
    v_accvgpr_write_b32 a11, v255
    v_accvgpr_read_b32 v198, a12
    v_accvgpr_read_b32 v199, a13
    v_accvgpr_read_b32 v252, a14
    v_accvgpr_read_b32 v255, a15
    v_mul_f32 v198, v198, v148
    v_mul_f32 v199, v199, v149
    v_mul_f32 v252, v252, v150
    v_mul_f32 v255, v255, v151
    v_accvgpr_write_b32 a12, v198
    v_accvgpr_write_b32 a13, v199
    v_accvgpr_write_b32 a14, v252
    v_accvgpr_write_b32 a15, v255
    v_accvgpr_read_b32 v198, a16
    v_accvgpr_read_b32 v199, a17
    v_accvgpr_read_b32 v252, a18
    v_accvgpr_read_b32 v255, a19
    v_mul_f32 v198, v198, v152
    v_mul_f32 v199, v199, v153
    v_mul_f32 v252, v252, v154
    v_mul_f32 v255, v255, v155
    v_accvgpr_write_b32 a16, v198
    v_accvgpr_write_b32 a17, v199
    v_accvgpr_write_b32 a18, v252
    v_accvgpr_write_b32 a19, v255
    v_accvgpr_read_b32 v198, a20
    v_accvgpr_read_b32 v199, a21
    v_accvgpr_read_b32 v252, a22
    v_accvgpr_read_b32 v255, a23
    v_mul_f32 v198, v198, v144
    v_mul_f32 v199, v199, v145
    v_mul_f32 v252, v252, v146
    v_mul_f32 v255, v255, v147
    v_accvgpr_write_b32 a20, v198
    v_accvgpr_write_b32 a21, v199
    v_accvgpr_write_b32 a22, v252
    v_accvgpr_write_b32 a23, v255
    v_accvgpr_read_b32 v198, a24
    v_accvgpr_read_b32 v199, a25
    v_accvgpr_read_b32 v252, a26
    v_accvgpr_read_b32 v255, a27
    v_mul_f32 v198, v198, v148
    v_mul_f32 v199, v199, v149
    v_mul_f32 v252, v252, v150
    v_mul_f32 v255, v255, v151
    v_accvgpr_write_b32 a24, v198
    v_accvgpr_write_b32 a25, v199
    v_accvgpr_write_b32 a26, v252
    v_accvgpr_write_b32 a27, v255
    v_accvgpr_read_b32 v198, a28
    v_accvgpr_read_b32 v199, a29
    v_accvgpr_read_b32 v252, a30
    v_accvgpr_read_b32 v255, a31
    v_mul_f32 v198, v198, v152
    v_mul_f32 v199, v199, v153
    v_mul_f32 v252, v252, v154
    v_mul_f32 v255, v255, v155
    v_accvgpr_write_b32 a28, v198
    v_accvgpr_write_b32 a29, v199
    v_accvgpr_write_b32 a30, v252
    v_accvgpr_write_b32 a31, v255
    v_accvgpr_read_b32 v198, a32
    v_accvgpr_read_b32 v199, a33
    v_accvgpr_read_b32 v252, a34
    v_accvgpr_read_b32 v255, a35
    v_mul_f32 v198, v198, v144
    v_mul_f32 v199, v199, v145
    v_mul_f32 v252, v252, v146
    v_mul_f32 v255, v255, v147
    v_accvgpr_write_b32 a32, v198
    v_accvgpr_write_b32 a33, v199
    v_accvgpr_write_b32 a34, v252
    v_accvgpr_write_b32 a35, v255
    v_accvgpr_read_b32 v198, a36
    v_accvgpr_read_b32 v199, a37
    v_accvgpr_read_b32 v252, a38
    v_accvgpr_read_b32 v255, a39
    v_mul_f32 v198, v198, v148
    v_mul_f32 v199, v199, v149
    v_mul_f32 v252, v252, v150
    v_mul_f32 v255, v255, v151
    v_accvgpr_write_b32 a36, v198
    v_accvgpr_write_b32 a37, v199
    v_accvgpr_write_b32 a38, v252
    v_accvgpr_write_b32 a39, v255
    v_accvgpr_read_b32 v198, a40
    v_accvgpr_read_b32 v199, a41
    v_accvgpr_read_b32 v252, a42
    v_accvgpr_read_b32 v255, a43
    v_mul_f32 v198, v198, v152
    v_mul_f32 v199, v199, v153
    v_mul_f32 v252, v252, v154
    v_mul_f32 v255, v255, v155
    v_accvgpr_write_b32 a40, v198
    v_accvgpr_write_b32 a41, v199
    v_accvgpr_write_b32 a42, v252
    v_accvgpr_write_b32 a43, v255
    v_accvgpr_read_b32 v198, a44
    v_accvgpr_read_b32 v199, a45
    v_accvgpr_read_b32 v252, a46
    v_accvgpr_read_b32 v255, a47
    v_mul_f32 v198, v198, v144
    v_mul_f32 v199, v199, v145
    v_mul_f32 v252, v252, v146
    v_mul_f32 v255, v255, v147
    v_accvgpr_write_b32 a44, v198
    v_accvgpr_write_b32 a45, v199
    v_accvgpr_write_b32 a46, v252
    v_accvgpr_write_b32 a47, v255
    v_accvgpr_read_b32 v198, a48
    v_accvgpr_read_b32 v199, a49
    v_accvgpr_read_b32 v252, a50
    v_accvgpr_read_b32 v255, a51
    v_mul_f32 v198, v198, v148
    v_mul_f32 v199, v199, v149
    v_mul_f32 v252, v252, v150
    v_mul_f32 v255, v255, v151
    v_accvgpr_write_b32 a48, v198
    v_accvgpr_write_b32 a49, v199
    v_accvgpr_write_b32 a50, v252
    v_accvgpr_write_b32 a51, v255
    v_accvgpr_read_b32 v198, a52
    v_accvgpr_read_b32 v199, a53
    v_accvgpr_read_b32 v252, a54
    v_accvgpr_read_b32 v255, a55
    v_mul_f32 v198, v198, v152
    v_mul_f32 v199, v199, v153
    v_mul_f32 v252, v252, v154
    v_mul_f32 v255, v255, v155
    v_accvgpr_write_b32 a52, v198
    v_accvgpr_write_b32 a53, v199
    v_accvgpr_write_b32 a54, v252
    v_accvgpr_write_b32 a55, v255
    v_accvgpr_read_b32 v198, a56
    v_accvgpr_read_b32 v199, a57
    v_accvgpr_read_b32 v252, a58
    v_accvgpr_read_b32 v255, a59
    v_mul_f32 v198, v198, v144
    v_mul_f32 v199, v199, v145
    v_mul_f32 v252, v252, v146
    v_mul_f32 v255, v255, v147
    v_accvgpr_write_b32 a56, v198
    v_accvgpr_write_b32 a57, v199
    v_accvgpr_write_b32 a58, v252
    v_accvgpr_write_b32 a59, v255
    v_accvgpr_read_b32 v198, a60
    v_accvgpr_read_b32 v199, a61
    v_accvgpr_read_b32 v252, a62
    v_accvgpr_read_b32 v255, a63
    v_mul_f32 v198, v198, v148
    v_mul_f32 v199, v199, v149
    v_mul_f32 v252, v252, v150
    v_mul_f32 v255, v255, v151
    v_accvgpr_write_b32 a60, v198
    v_accvgpr_write_b32 a61, v199
    v_accvgpr_write_b32 a62, v252
    v_accvgpr_write_b32 a63, v255
    v_accvgpr_read_b32 v198, a64
    v_accvgpr_read_b32 v199, a65
    v_accvgpr_read_b32 v252, a66
    v_accvgpr_read_b32 v255, a67
    v_mul_f32 v198, v198, v152
    v_mul_f32 v199, v199, v153
    v_mul_f32 v252, v252, v154
    v_mul_f32 v255, v255, v155
    v_accvgpr_write_b32 a64, v198
    v_accvgpr_write_b32 a65, v199
    v_accvgpr_write_b32 a66, v252
    v_accvgpr_write_b32 a67, v255
    v_accvgpr_read_b32 v198, a68
    v_accvgpr_read_b32 v199, a69
    v_accvgpr_read_b32 v252, a70
    v_accvgpr_read_b32 v255, a71
    v_mul_f32 v198, v198, v144
    v_mul_f32 v199, v199, v145
    v_mul_f32 v252, v252, v146
    v_mul_f32 v255, v255, v147
    v_accvgpr_write_b32 a68, v198
    v_accvgpr_write_b32 a69, v199
    v_accvgpr_write_b32 a70, v252
    v_accvgpr_write_b32 a71, v255
    v_accvgpr_read_b32 v198, a72
    v_accvgpr_read_b32 v199, a73
    v_accvgpr_read_b32 v252, a74
    v_accvgpr_read_b32 v255, a75
    v_mul_f32 v198, v198, v148
    v_mul_f32 v199, v199, v149
    v_mul_f32 v252, v252, v150
    v_mul_f32 v255, v255, v151
    v_accvgpr_write_b32 a72, v198
    v_accvgpr_write_b32 a73, v199
    v_accvgpr_write_b32 a74, v252
    v_accvgpr_write_b32 a75, v255
    v_accvgpr_read_b32 v198, a76
    v_accvgpr_read_b32 v199, a77
    v_accvgpr_read_b32 v252, a78
    v_accvgpr_read_b32 v255, a79
    v_mul_f32 v198, v198, v152
    v_mul_f32 v199, v199, v153
    v_mul_f32 v252, v252, v154
    v_mul_f32 v255, v255, v155
    v_accvgpr_write_b32 a76, v198
    v_accvgpr_write_b32 a77, v199
    v_accvgpr_write_b32 a78, v252
    v_accvgpr_write_b32 a79, v255
    v_accvgpr_read_b32 v198, a80
    v_accvgpr_read_b32 v199, a81
    v_accvgpr_read_b32 v252, a82
    v_accvgpr_read_b32 v255, a83
    v_mul_f32 v198, v198, v144
    v_mul_f32 v199, v199, v145
    v_mul_f32 v252, v252, v146
    v_mul_f32 v255, v255, v147
    v_accvgpr_write_b32 a80, v198
    v_accvgpr_write_b32 a81, v199
    v_accvgpr_write_b32 a82, v252
    v_accvgpr_write_b32 a83, v255
    v_accvgpr_read_b32 v198, a84
    v_accvgpr_read_b32 v199, a85
    v_accvgpr_read_b32 v252, a86
    v_accvgpr_read_b32 v255, a87
    v_mul_f32 v198, v198, v148
    v_mul_f32 v199, v199, v149
    v_mul_f32 v252, v252, v150
    v_mul_f32 v255, v255, v151
    v_accvgpr_write_b32 a84, v198
    v_accvgpr_write_b32 a85, v199
    v_accvgpr_write_b32 a86, v252
    v_accvgpr_write_b32 a87, v255
    v_accvgpr_read_b32 v198, a88
    v_accvgpr_read_b32 v199, a89
    v_accvgpr_read_b32 v252, a90
    v_accvgpr_read_b32 v255, a91
    v_mul_f32 v198, v198, v152
    v_mul_f32 v199, v199, v153
    v_mul_f32 v252, v252, v154
    v_mul_f32 v255, v255, v155
    v_accvgpr_write_b32 a88, v198
    v_accvgpr_write_b32 a89, v199
    v_accvgpr_write_b32 a90, v252
    v_accvgpr_write_b32 a91, v255
    v_accvgpr_read_b32 v198, a92
    v_accvgpr_read_b32 v199, a93
    v_accvgpr_read_b32 v252, a94
    v_accvgpr_read_b32 v255, a95
    v_mul_f32 v198, v198, v144
    v_mul_f32 v199, v199, v145
    v_mul_f32 v252, v252, v146
    v_mul_f32 v255, v255, v147
    v_accvgpr_write_b32 a92, v198
    v_accvgpr_write_b32 a93, v199
    v_accvgpr_write_b32 a94, v252
    v_accvgpr_write_b32 a95, v255
    v_accvgpr_read_b32 v198, a96
    v_accvgpr_read_b32 v199, a97
    v_accvgpr_read_b32 v252, a98
    v_accvgpr_read_b32 v255, a99
    v_mul_f32 v198, v198, v148
    v_mul_f32 v199, v199, v149
    v_mul_f32 v252, v252, v150
    v_mul_f32 v255, v255, v151
    v_accvgpr_write_b32 a96, v198
    v_accvgpr_write_b32 a97, v199
    v_accvgpr_write_b32 a98, v252
    v_accvgpr_write_b32 a99, v255
    v_accvgpr_read_b32 v198, a100
    v_accvgpr_read_b32 v199, a101
    v_accvgpr_read_b32 v252, a102
    v_accvgpr_read_b32 v255, a103
    v_mul_f32 v198, v198, v152
    v_mul_f32 v199, v199, v153
    v_mul_f32 v252, v252, v154
    v_mul_f32 v255, v255, v155
    v_accvgpr_write_b32 a100, v198
    v_accvgpr_write_b32 a101, v199
    v_accvgpr_write_b32 a102, v252
    v_accvgpr_write_b32 a103, v255
    v_accvgpr_read_b32 v198, a104
    v_accvgpr_read_b32 v199, a105
    v_accvgpr_read_b32 v252, a106
    v_accvgpr_read_b32 v255, a107
    v_mul_f32 v198, v198, v144
    v_mul_f32 v199, v199, v145
    v_mul_f32 v252, v252, v146
    v_mul_f32 v255, v255, v147
    v_accvgpr_write_b32 a104, v198
    v_accvgpr_write_b32 a105, v199
    v_accvgpr_write_b32 a106, v252
    v_accvgpr_write_b32 a107, v255
    v_accvgpr_read_b32 v198, a108
    v_accvgpr_read_b32 v199, a109
    v_accvgpr_read_b32 v252, a110
    v_accvgpr_read_b32 v255, a111
    v_mul_f32 v198, v198, v148
    v_mul_f32 v199, v199, v149
    v_mul_f32 v252, v252, v150
    v_mul_f32 v255, v255, v151
    v_accvgpr_write_b32 a108, v198
    v_accvgpr_write_b32 a109, v199
    v_accvgpr_write_b32 a110, v252
    v_accvgpr_write_b32 a111, v255
    v_accvgpr_read_b32 v198, a112
    v_accvgpr_read_b32 v199, a113
    v_accvgpr_read_b32 v252, a114
    v_accvgpr_read_b32 v255, a115
    v_mul_f32 v198, v198, v152
    v_mul_f32 v199, v199, v153
    v_mul_f32 v252, v252, v154
    v_mul_f32 v255, v255, v155
    v_accvgpr_write_b32 a112, v198
    v_accvgpr_write_b32 a113, v199
    v_accvgpr_write_b32 a114, v252
    v_accvgpr_write_b32 a115, v255
    v_accvgpr_read_b32 v198, a116
    v_accvgpr_read_b32 v199, a117
    v_accvgpr_read_b32 v252, a118
    v_accvgpr_read_b32 v255, a119
    v_mul_f32 v198, v198, v144
    v_mul_f32 v199, v199, v145
    v_mul_f32 v252, v252, v146
    v_mul_f32 v255, v255, v147
    v_accvgpr_write_b32 a116, v198
    v_accvgpr_write_b32 a117, v199
    v_accvgpr_write_b32 a118, v252
    v_accvgpr_write_b32 a119, v255
    v_accvgpr_read_b32 v198, a120
    v_accvgpr_read_b32 v199, a121
    v_accvgpr_read_b32 v252, a122
    v_accvgpr_read_b32 v255, a123
    v_mul_f32 v198, v198, v148
    v_mul_f32 v199, v199, v149
    v_mul_f32 v252, v252, v150
    v_mul_f32 v255, v255, v151
    v_accvgpr_write_b32 a120, v198
    v_accvgpr_write_b32 a121, v199
    v_accvgpr_write_b32 a122, v252
    v_accvgpr_write_b32 a123, v255
    v_accvgpr_read_b32 v198, a124
    v_accvgpr_read_b32 v199, a125
    v_accvgpr_read_b32 v252, a126
    v_accvgpr_read_b32 v255, a127
    v_mul_f32 v198, v198, v152
    v_mul_f32 v199, v199, v153
    v_mul_f32 v252, v252, v154
    v_mul_f32 v255, v255, v155
    v_accvgpr_write_b32 a124, v198
    v_accvgpr_write_b32 a125, v199
    v_accvgpr_write_b32 a126, v252
    v_accvgpr_write_b32 a127, v255
    v_mul_f32 v203, v200, v192
    v_sub_f32 v198, v96, v195
    v_sub_f32 v199, v97, v195
    v_sub_f32 v252, v98, v195
    v_sub_f32 v255, v99, v195
    v_exp_f32 v198, v198
    v_exp_f32 v199, v199
    v_exp_f32 v252, v252
    v_exp_f32 v255, v255
    s_nop 0
    v_add_f32 v203, v203, v198
    v_add_f32 v203, v203, v199
    v_add_f32 v203, v203, v252
    v_add_f32 v203, v203, v255
    v_cvt_pk_bf16_f32 v144, v198, v199
    v_cvt_pk_bf16_f32 v145, v252, v255
    v_sub_f32 v198, v108, v195
    v_sub_f32 v199, v109, v195
    v_sub_f32 v252, v110, v195
    v_sub_f32 v255, v111, v195
    v_exp_f32 v198, v198
    v_exp_f32 v199, v199
    v_exp_f32 v252, v252
    v_exp_f32 v255, v255
    s_nop 0
    v_add_f32 v203, v203, v198
    v_add_f32 v203, v203, v199
    v_add_f32 v203, v203, v252
    v_add_f32 v203, v203, v255
    v_cvt_pk_bf16_f32 v146, v198, v199
    v_cvt_pk_bf16_f32 v147, v252, v255
    v_sub_f32 v198, v120, v195
    v_sub_f32 v199, v121, v195
    v_sub_f32 v252, v122, v195
    v_sub_f32 v255, v123, v195
    v_exp_f32 v198, v198
    v_exp_f32 v199, v199
    v_exp_f32 v252, v252
    v_exp_f32 v255, v255
    s_nop 0
    v_add_f32 v203, v203, v198
    v_add_f32 v203, v203, v199
    v_add_f32 v203, v203, v252
    v_add_f32 v203, v203, v255
    v_cvt_pk_bf16_f32 v156, v198, v199
    v_cvt_pk_bf16_f32 v157, v252, v255
    v_sub_f32 v198, v132, v195
    v_sub_f32 v199, v133, v195
    v_sub_f32 v252, v134, v195
    v_sub_f32 v255, v135, v195
    v_exp_f32 v198, v198
    v_exp_f32 v199, v199
    v_exp_f32 v252, v252
    v_exp_f32 v255, v255
    s_nop 0
    v_add_f32 v203, v203, v198
    v_add_f32 v203, v203, v199
    v_add_f32 v203, v203, v252
    v_add_f32 v203, v203, v255
    v_cvt_pk_bf16_f32 v158, v198, v199
    v_cvt_pk_bf16_f32 v159, v252, v255
    v_mul_f32 v204, v201, v193
    v_sub_f32 v198, v100, v196
    v_sub_f32 v199, v101, v196
    v_sub_f32 v252, v102, v196
    v_sub_f32 v255, v103, v196
    v_exp_f32 v198, v198
    v_exp_f32 v199, v199
    v_exp_f32 v252, v252
    v_exp_f32 v255, v255
    s_nop 0
    v_add_f32 v204, v204, v198
    v_add_f32 v204, v204, v199
    v_add_f32 v204, v204, v252
    v_add_f32 v204, v204, v255
    v_cvt_pk_bf16_f32 v148, v198, v199
    v_cvt_pk_bf16_f32 v149, v252, v255
    v_sub_f32 v198, v112, v196
    v_sub_f32 v199, v113, v196
    v_sub_f32 v252, v114, v196
    v_sub_f32 v255, v115, v196
    v_exp_f32 v198, v198
    v_exp_f32 v199, v199
    v_exp_f32 v252, v252
    v_exp_f32 v255, v255
    s_nop 0
    v_add_f32 v204, v204, v198
    v_add_f32 v204, v204, v199
    v_add_f32 v204, v204, v252
    v_add_f32 v204, v204, v255
    v_cvt_pk_bf16_f32 v150, v198, v199
    v_cvt_pk_bf16_f32 v151, v252, v255
    v_sub_f32 v198, v124, v196
    v_sub_f32 v199, v125, v196
    v_sub_f32 v252, v126, v196
    v_sub_f32 v255, v127, v196
    v_exp_f32 v198, v198
    v_exp_f32 v199, v199
    v_exp_f32 v252, v252
    v_exp_f32 v255, v255
    s_nop 0
    v_add_f32 v204, v204, v198
    v_add_f32 v204, v204, v199
    v_add_f32 v204, v204, v252
    v_add_f32 v204, v204, v255
    v_cvt_pk_bf16_f32 v160, v198, v199
    v_cvt_pk_bf16_f32 v161, v252, v255
    v_sub_f32 v198, v136, v196
    v_sub_f32 v199, v137, v196
    v_sub_f32 v252, v138, v196
    v_sub_f32 v255, v139, v196
    v_exp_f32 v198, v198
    v_exp_f32 v199, v199
    v_exp_f32 v252, v252
    v_exp_f32 v255, v255
    s_nop 0
    v_add_f32 v204, v204, v198
    v_add_f32 v204, v204, v199
    v_add_f32 v204, v204, v252
    v_add_f32 v204, v204, v255
    v_cvt_pk_bf16_f32 v162, v198, v199
    v_cvt_pk_bf16_f32 v163, v252, v255
    v_mul_f32 v205, v202, v194
    v_sub_f32 v198, v104, v197
    v_sub_f32 v199, v105, v197
    v_sub_f32 v252, v106, v197
    v_sub_f32 v255, v107, v197
    v_exp_f32 v198, v198
    v_exp_f32 v199, v199
    v_exp_f32 v252, v252
    v_exp_f32 v255, v255
    s_nop 0
    v_add_f32 v205, v205, v198
    v_add_f32 v205, v205, v199
    v_add_f32 v205, v205, v252
    v_add_f32 v205, v205, v255
    v_cvt_pk_bf16_f32 v152, v198, v199
    v_cvt_pk_bf16_f32 v153, v252, v255
    v_sub_f32 v198, v116, v197
    v_sub_f32 v199, v117, v197
    v_sub_f32 v252, v118, v197
    v_sub_f32 v255, v119, v197
    v_exp_f32 v198, v198
    v_exp_f32 v199, v199
    v_exp_f32 v252, v252
    v_exp_f32 v255, v255
    s_nop 0
    v_add_f32 v205, v205, v198
    v_add_f32 v205, v205, v199
    v_add_f32 v205, v205, v252
    v_add_f32 v205, v205, v255
    v_cvt_pk_bf16_f32 v154, v198, v199
    v_cvt_pk_bf16_f32 v155, v252, v255
    v_sub_f32 v198, v128, v197
    v_sub_f32 v199, v129, v197
    v_sub_f32 v252, v130, v197
    v_sub_f32 v255, v131, v197
    v_exp_f32 v198, v198
    v_exp_f32 v199, v199
    v_exp_f32 v252, v252
    v_exp_f32 v255, v255
    s_nop 0
    v_add_f32 v205, v205, v198
    v_add_f32 v205, v205, v199
    v_add_f32 v205, v205, v252
    v_add_f32 v205, v205, v255
    v_cvt_pk_bf16_f32 v164, v198, v199
    v_cvt_pk_bf16_f32 v165, v252, v255
    v_sub_f32 v198, v140, v197
    v_sub_f32 v199, v141, v197
    v_sub_f32 v252, v142, v197
    v_sub_f32 v255, v143, v197
    v_exp_f32 v198, v198
    v_exp_f32 v199, v199
    v_exp_f32 v252, v252
    v_exp_f32 v255, v255
    s_nop 0
    v_add_f32 v205, v205, v198
    v_add_f32 v205, v205, v199
    v_add_f32 v205, v205, v252
    v_add_f32 v205, v205, v255
    v_cvt_pk_bf16_f32 v166, v198, v199
    v_cvt_pk_bf16_f32 v167, v252, v255
    s_nop 3
    s_setpc_b64 s[30:31]
L_slow_f0:
    s_nop 15
    v_log_f32 v198, v200
    v_max3_f32 v195, v96, v97, v98
    v_max3_f32 v195, v195, v99, v108
    v_max3_f32 v195, v195, v109, v110
    v_max3_f32 v195, v195, v111, v120
    v_max3_f32 v195, v195, v121, v122
    v_max3_f32 v195, v195, v123, v132
    v_max3_f32 v195, v195, v133, v134
    v_max3_f32 v195, v195, v135, v198
    v_mov_b32 v199, v195
    s_nop 1
    v_permlane32_swap_b32 v195, v199
    s_nop 1
    v_max_f32 v195, v195, v199
    v_mov_b32 v199, v195
    s_nop 1
    v_permlane16_swap_b32 v195, v199
    s_nop 1
    v_max_f32 v195, v195, v199
    v_max_f32 v195, 0, v195
    v_ceil_f32 v195, v195
    v_sub_f32 v208, v208, v195
    v_sub_f32 v209, v209, v195
    v_sub_f32 v210, v210, v195
    v_sub_f32 v211, v211, v195
    v_min_f32 v198, 0x43800000, v195
    v_cvt_i32_f32 v198, v198
    v_sub_u32 v198, 0, v198
    v_ldexp_f32 v192, 1.0, v198
    v_log_f32 v198, v201
    v_max3_f32 v196, v100, v101, v102
    v_max3_f32 v196, v196, v103, v112
    v_max3_f32 v196, v196, v113, v114
    v_max3_f32 v196, v196, v115, v124
    v_max3_f32 v196, v196, v125, v126
    v_max3_f32 v196, v196, v127, v136
    v_max3_f32 v196, v196, v137, v138
    v_max3_f32 v196, v196, v139, v198
    v_mov_b32 v199, v196
    s_nop 1
    v_permlane32_swap_b32 v196, v199
    s_nop 1
    v_max_f32 v196, v196, v199
    v_mov_b32 v199, v196
    s_nop 1
    v_permlane16_swap_b32 v196, v199
    s_nop 1
    v_max_f32 v196, v196, v199
    v_max_f32 v196, 0, v196
    v_ceil_f32 v196, v196
    v_sub_f32 v212, v212, v196
    v_sub_f32 v213, v213, v196
    v_sub_f32 v214, v214, v196
    v_sub_f32 v215, v215, v196
    v_min_f32 v198, 0x43800000, v196
    v_cvt_i32_f32 v198, v198
    v_sub_u32 v198, 0, v198
    v_ldexp_f32 v193, 1.0, v198
    v_log_f32 v198, v202
    v_max3_f32 v197, v104, v105, v106
    v_max3_f32 v197, v197, v107, v116
    v_max3_f32 v197, v197, v117, v118
    v_max3_f32 v197, v197, v119, v128
    v_max3_f32 v197, v197, v129, v130
    v_max3_f32 v197, v197, v131, v140
    v_max3_f32 v197, v197, v141, v142
    v_max3_f32 v197, v197, v143, v198
    v_mov_b32 v199, v197
    s_nop 1
    v_permlane32_swap_b32 v197, v199
    s_nop 1
    v_max_f32 v197, v197, v199
    v_mov_b32 v199, v197
    s_nop 1
    v_permlane16_swap_b32 v197, v199
    s_nop 1
    v_max_f32 v197, v197, v199
    v_max_f32 v197, 0, v197
    v_ceil_f32 v197, v197
    v_sub_f32 v216, v216, v197
    v_sub_f32 v217, v217, v197
    v_sub_f32 v218, v218, v197
    v_sub_f32 v219, v219, v197
    v_min_f32 v198, 0x43800000, v197
    v_cvt_i32_f32 v198, v198
    v_sub_u32 v198, 0, v198
    v_ldexp_f32 v194, 1.0, v198
    v_mbcnt_lo_u32_b32 v198, -1, 0
    v_mbcnt_hi_u32_b32 v198, -1, v198
    v_and_b32 v198, 48, v198
    ds_bpermute_b32 v144, v198, v192 offset:0
    ds_bpermute_b32 v145, v198, v192 offset:4
    ds_bpermute_b32 v146, v198, v192 offset:8
    ds_bpermute_b32 v147, v198, v192 offset:12
    ds_bpermute_b32 v148, v198, v193 offset:0
    ds_bpermute_b32 v149, v198, v193 offset:4
    ds_bpermute_b32 v150, v198, v193 offset:8
    ds_bpermute_b32 v151, v198, v193 offset:12
    ds_bpermute_b32 v152, v198, v194 offset:0
    ds_bpermute_b32 v153, v198, v194 offset:4
    ds_bpermute_b32 v154, v198, v194 offset:8
    ds_bpermute_b32 v155, v198, v194 offset:12
    s_waitcnt lgkmcnt(0)
    v_mul_f32 v0, v0, v144
    v_mul_f32 v1, v1, v145
    v_mul_f32 v2, v2, v146
    v_mul_f32 v3, v3, v147
    v_mul_f32 v4, v4, v148
    v_mul_f32 v5, v5, v149
    v_mul_f32 v6, v6, v150
    v_mul_f32 v7, v7, v151
    v_mul_f32 v8, v8, v152
    v_mul_f32 v9, v9, v153
    v_mul_f32 v10, v10, v154
    v_mul_f32 v11, v11, v155
    v_mul_f32 v12, v12, v144
    v_mul_f32 v13, v13, v145
    v_mul_f32 v14, v14, v146
    v_mul_f32 v15, v15, v147
    v_mul_f32 v16, v16, v148
    v_mul_f32 v17, v17, v149
    v_mul_f32 v18, v18, v150
    v_mul_f32 v19, v19, v151
    v_mul_f32 v20, v20, v152
    v_mul_f32 v21, v21, v153
    v_mul_f32 v22, v22, v154
    v_mul_f32 v23, v23, v155
    v_mul_f32 v24, v24, v144
    v_mul_f32 v25, v25, v145
    v_mul_f32 v26, v26, v146
    v_mul_f32 v27, v27, v147
    v_mul_f32 v28, v28, v148
    v_mul_f32 v29, v29, v149
    v_mul_f32 v30, v30, v150
    v_mul_f32 v31, v31, v151
    v_mul_f32 v32, v32, v152
    v_mul_f32 v33, v33, v153
    v_mul_f32 v34, v34, v154
    v_mul_f32 v35, v35, v155
    v_mul_f32 v36, v36, v144
    v_mul_f32 v37, v37, v145
    v_mul_f32 v38, v38, v146
    v_mul_f32 v39, v39, v147
    v_mul_f32 v40, v40, v148
    v_mul_f32 v41, v41, v149
    v_mul_f32 v42, v42, v150
    v_mul_f32 v43, v43, v151
    v_mul_f32 v44, v44, v152
    v_mul_f32 v45, v45, v153
    v_mul_f32 v46, v46, v154
    v_mul_f32 v47, v47, v155
    v_mul_f32 v48, v48, v144
    v_mul_f32 v49, v49, v145
    v_mul_f32 v50, v50, v146
    v_mul_f32 v51, v51, v147
    v_mul_f32 v52, v52, v148
    v_mul_f32 v53, v53, v149
    v_mul_f32 v54, v54, v150
    v_mul_f32 v55, v55, v151
    v_mul_f32 v56, v56, v152
    v_mul_f32 v57, v57, v153
    v_mul_f32 v58, v58, v154
    v_mul_f32 v59, v59, v155
    v_mul_f32 v60, v60, v144
    v_mul_f32 v61, v61, v145
    v_mul_f32 v62, v62, v146
    v_mul_f32 v63, v63, v147
    v_accvgpr_read_b32 v198, a0
    v_accvgpr_read_b32 v199, a1
    v_accvgpr_read_b32 v252, a2
    v_accvgpr_read_b32 v255, a3
    v_mul_f32 v198, v198, v148
    v_mul_f32 v199, v199, v149
    v_mul_f32 v252, v252, v150
    v_mul_f32 v255, v255, v151
    v_accvgpr_write_b32 a0, v198
    v_accvgpr_write_b32 a1, v199
    v_accvgpr_write_b32 a2, v252
    v_accvgpr_write_b32 a3, v255
    v_accvgpr_read_b32 v198, a4
    v_accvgpr_read_b32 v199, a5
    v_accvgpr_read_b32 v252, a6
    v_accvgpr_read_b32 v255, a7
    v_mul_f32 v198, v198, v152
    v_mul_f32 v199, v199, v153
    v_mul_f32 v252, v252, v154
    v_mul_f32 v255, v255, v155
    v_accvgpr_write_b32 a4, v198
    v_accvgpr_write_b32 a5, v199
    v_accvgpr_write_b32 a6, v252
    v_accvgpr_write_b32 a7, v255
    v_accvgpr_read_b32 v198, a8
    v_accvgpr_read_b32 v199, a9
    v_accvgpr_read_b32 v252, a10
    v_accvgpr_read_b32 v255, a11
    v_mul_f32 v198, v198, v144
    v_mul_f32 v199, v199, v145
    v_mul_f32 v252, v252, v146
    v_mul_f32 v255, v255, v147
    v_accvgpr_write_b32 a8, v198
    v_accvgpr_write_b32 a9, v199
    v_accvgpr_write_b32 a10, v252
    v_accvgpr_write_b32 a11, v255
    v_accvgpr_read_b32 v198, a12
    v_accvgpr_read_b32 v199, a13
    v_accvgpr_read_b32 v252, a14
    v_accvgpr_read_b32 v255, a15
    v_mul_f32 v198, v198, v148
    v_mul_f32 v199, v199, v149
    v_mul_f32 v252, v252, v150
    v_mul_f32 v255, v255, v151
    v_accvgpr_write_b32 a12, v198
    v_accvgpr_write_b32 a13, v199
    v_accvgpr_write_b32 a14, v252
    v_accvgpr_write_b32 a15, v255
    v_accvgpr_read_b32 v198, a16
    v_accvgpr_read_b32 v199, a17
    v_accvgpr_read_b32 v252, a18
    v_accvgpr_read_b32 v255, a19
    v_mul_f32 v198, v198, v152
    v_mul_f32 v199, v199, v153
    v_mul_f32 v252, v252, v154
    v_mul_f32 v255, v255, v155
    v_accvgpr_write_b32 a16, v198
    v_accvgpr_write_b32 a17, v199
    v_accvgpr_write_b32 a18, v252
    v_accvgpr_write_b32 a19, v255
    v_accvgpr_read_b32 v198, a20
    v_accvgpr_read_b32 v199, a21
    v_accvgpr_read_b32 v252, a22
    v_accvgpr_read_b32 v255, a23
    v_mul_f32 v198, v198, v144
    v_mul_f32 v199, v199, v145
    v_mul_f32 v252, v252, v146
    v_mul_f32 v255, v255, v147
    v_accvgpr_write_b32 a20, v198
    v_accvgpr_write_b32 a21, v199
    v_accvgpr_write_b32 a22, v252
    v_accvgpr_write_b32 a23, v255
    v_accvgpr_read_b32 v198, a24
    v_accvgpr_read_b32 v199, a25
    v_accvgpr_read_b32 v252, a26
    v_accvgpr_read_b32 v255, a27
    v_mul_f32 v198, v198, v148
    v_mul_f32 v199, v199, v149
    v_mul_f32 v252, v252, v150
    v_mul_f32 v255, v255, v151
    v_accvgpr_write_b32 a24, v198
    v_accvgpr_write_b32 a25, v199
    v_accvgpr_write_b32 a26, v252
    v_accvgpr_write_b32 a27, v255
    v_accvgpr_read_b32 v198, a28
    v_accvgpr_read_b32 v199, a29
    v_accvgpr_read_b32 v252, a30
    v_accvgpr_read_b32 v255, a31
    v_mul_f32 v198, v198, v152
    v_mul_f32 v199, v199, v153
    v_mul_f32 v252, v252, v154
    v_mul_f32 v255, v255, v155
    v_accvgpr_write_b32 a28, v198
    v_accvgpr_write_b32 a29, v199
    v_accvgpr_write_b32 a30, v252
    v_accvgpr_write_b32 a31, v255
    v_accvgpr_read_b32 v198, a32
    v_accvgpr_read_b32 v199, a33
    v_accvgpr_read_b32 v252, a34
    v_accvgpr_read_b32 v255, a35
    v_mul_f32 v198, v198, v144
    v_mul_f32 v199, v199, v145
    v_mul_f32 v252, v252, v146
    v_mul_f32 v255, v255, v147
    v_accvgpr_write_b32 a32, v198
    v_accvgpr_write_b32 a33, v199
    v_accvgpr_write_b32 a34, v252
    v_accvgpr_write_b32 a35, v255
    v_accvgpr_read_b32 v198, a36
    v_accvgpr_read_b32 v199, a37
    v_accvgpr_read_b32 v252, a38
    v_accvgpr_read_b32 v255, a39
    v_mul_f32 v198, v198, v148
    v_mul_f32 v199, v199, v149
    v_mul_f32 v252, v252, v150
    v_mul_f32 v255, v255, v151
    v_accvgpr_write_b32 a36, v198
    v_accvgpr_write_b32 a37, v199
    v_accvgpr_write_b32 a38, v252
    v_accvgpr_write_b32 a39, v255
    v_accvgpr_read_b32 v198, a40
    v_accvgpr_read_b32 v199, a41
    v_accvgpr_read_b32 v252, a42
    v_accvgpr_read_b32 v255, a43
    v_mul_f32 v198, v198, v152
    v_mul_f32 v199, v199, v153
    v_mul_f32 v252, v252, v154
    v_mul_f32 v255, v255, v155
    v_accvgpr_write_b32 a40, v198
    v_accvgpr_write_b32 a41, v199
    v_accvgpr_write_b32 a42, v252
    v_accvgpr_write_b32 a43, v255
    v_accvgpr_read_b32 v198, a44
    v_accvgpr_read_b32 v199, a45
    v_accvgpr_read_b32 v252, a46
    v_accvgpr_read_b32 v255, a47
    v_mul_f32 v198, v198, v144
    v_mul_f32 v199, v199, v145
    v_mul_f32 v252, v252, v146
    v_mul_f32 v255, v255, v147
    v_accvgpr_write_b32 a44, v198
    v_accvgpr_write_b32 a45, v199
    v_accvgpr_write_b32 a46, v252
    v_accvgpr_write_b32 a47, v255
    v_accvgpr_read_b32 v198, a48
    v_accvgpr_read_b32 v199, a49
    v_accvgpr_read_b32 v252, a50
    v_accvgpr_read_b32 v255, a51
    v_mul_f32 v198, v198, v148
    v_mul_f32 v199, v199, v149
    v_mul_f32 v252, v252, v150
    v_mul_f32 v255, v255, v151
    v_accvgpr_write_b32 a48, v198
    v_accvgpr_write_b32 a49, v199
    v_accvgpr_write_b32 a50, v252
    v_accvgpr_write_b32 a51, v255
    v_accvgpr_read_b32 v198, a52
    v_accvgpr_read_b32 v199, a53
    v_accvgpr_read_b32 v252, a54
    v_accvgpr_read_b32 v255, a55
    v_mul_f32 v198, v198, v152
    v_mul_f32 v199, v199, v153
    v_mul_f32 v252, v252, v154
    v_mul_f32 v255, v255, v155
    v_accvgpr_write_b32 a52, v198
    v_accvgpr_write_b32 a53, v199
    v_accvgpr_write_b32 a54, v252
    v_accvgpr_write_b32 a55, v255
    v_accvgpr_read_b32 v198, a56
    v_accvgpr_read_b32 v199, a57
    v_accvgpr_read_b32 v252, a58
    v_accvgpr_read_b32 v255, a59
    v_mul_f32 v198, v198, v144
    v_mul_f32 v199, v199, v145
    v_mul_f32 v252, v252, v146
    v_mul_f32 v255, v255, v147
    v_accvgpr_write_b32 a56, v198
    v_accvgpr_write_b32 a57, v199
    v_accvgpr_write_b32 a58, v252
    v_accvgpr_write_b32 a59, v255
    v_accvgpr_read_b32 v198, a60
    v_accvgpr_read_b32 v199, a61
    v_accvgpr_read_b32 v252, a62
    v_accvgpr_read_b32 v255, a63
    v_mul_f32 v198, v198, v148
    v_mul_f32 v199, v199, v149
    v_mul_f32 v252, v252, v150
    v_mul_f32 v255, v255, v151
    v_accvgpr_write_b32 a60, v198
    v_accvgpr_write_b32 a61, v199
    v_accvgpr_write_b32 a62, v252
    v_accvgpr_write_b32 a63, v255
    v_accvgpr_read_b32 v198, a64
    v_accvgpr_read_b32 v199, a65
    v_accvgpr_read_b32 v252, a66
    v_accvgpr_read_b32 v255, a67
    v_mul_f32 v198, v198, v152
    v_mul_f32 v199, v199, v153
    v_mul_f32 v252, v252, v154
    v_mul_f32 v255, v255, v155
    v_accvgpr_write_b32 a64, v198
    v_accvgpr_write_b32 a65, v199
    v_accvgpr_write_b32 a66, v252
    v_accvgpr_write_b32 a67, v255
    v_accvgpr_read_b32 v198, a68
    v_accvgpr_read_b32 v199, a69
    v_accvgpr_read_b32 v252, a70
    v_accvgpr_read_b32 v255, a71
    v_mul_f32 v198, v198, v144
    v_mul_f32 v199, v199, v145
    v_mul_f32 v252, v252, v146
    v_mul_f32 v255, v255, v147
    v_accvgpr_write_b32 a68, v198
    v_accvgpr_write_b32 a69, v199
    v_accvgpr_write_b32 a70, v252
    v_accvgpr_write_b32 a71, v255
    v_accvgpr_read_b32 v198, a72
    v_accvgpr_read_b32 v199, a73
    v_accvgpr_read_b32 v252, a74
    v_accvgpr_read_b32 v255, a75
    v_mul_f32 v198, v198, v148
    v_mul_f32 v199, v199, v149
    v_mul_f32 v252, v252, v150
    v_mul_f32 v255, v255, v151
    v_accvgpr_write_b32 a72, v198
    v_accvgpr_write_b32 a73, v199
    v_accvgpr_write_b32 a74, v252
    v_accvgpr_write_b32 a75, v255
    v_accvgpr_read_b32 v198, a76
    v_accvgpr_read_b32 v199, a77
    v_accvgpr_read_b32 v252, a78
    v_accvgpr_read_b32 v255, a79
    v_mul_f32 v198, v198, v152
    v_mul_f32 v199, v199, v153
    v_mul_f32 v252, v252, v154
    v_mul_f32 v255, v255, v155
    v_accvgpr_write_b32 a76, v198
    v_accvgpr_write_b32 a77, v199
    v_accvgpr_write_b32 a78, v252
    v_accvgpr_write_b32 a79, v255
    v_accvgpr_read_b32 v198, a80
    v_accvgpr_read_b32 v199, a81
    v_accvgpr_read_b32 v252, a82
    v_accvgpr_read_b32 v255, a83
    v_mul_f32 v198, v198, v144
    v_mul_f32 v199, v199, v145
    v_mul_f32 v252, v252, v146
    v_mul_f32 v255, v255, v147
    v_accvgpr_write_b32 a80, v198
    v_accvgpr_write_b32 a81, v199
    v_accvgpr_write_b32 a82, v252
    v_accvgpr_write_b32 a83, v255
    v_accvgpr_read_b32 v198, a84
    v_accvgpr_read_b32 v199, a85
    v_accvgpr_read_b32 v252, a86
    v_accvgpr_read_b32 v255, a87
    v_mul_f32 v198, v198, v148
    v_mul_f32 v199, v199, v149
    v_mul_f32 v252, v252, v150
    v_mul_f32 v255, v255, v151
    v_accvgpr_write_b32 a84, v198
    v_accvgpr_write_b32 a85, v199
    v_accvgpr_write_b32 a86, v252
    v_accvgpr_write_b32 a87, v255
    v_accvgpr_read_b32 v198, a88
    v_accvgpr_read_b32 v199, a89
    v_accvgpr_read_b32 v252, a90
    v_accvgpr_read_b32 v255, a91
    v_mul_f32 v198, v198, v152
    v_mul_f32 v199, v199, v153
    v_mul_f32 v252, v252, v154
    v_mul_f32 v255, v255, v155
    v_accvgpr_write_b32 a88, v198
    v_accvgpr_write_b32 a89, v199
    v_accvgpr_write_b32 a90, v252
    v_accvgpr_write_b32 a91, v255
    v_accvgpr_read_b32 v198, a92
    v_accvgpr_read_b32 v199, a93
    v_accvgpr_read_b32 v252, a94
    v_accvgpr_read_b32 v255, a95
    v_mul_f32 v198, v198, v144
    v_mul_f32 v199, v199, v145
    v_mul_f32 v252, v252, v146
    v_mul_f32 v255, v255, v147
    v_accvgpr_write_b32 a92, v198
    v_accvgpr_write_b32 a93, v199
    v_accvgpr_write_b32 a94, v252
    v_accvgpr_write_b32 a95, v255
    v_accvgpr_read_b32 v198, a96
    v_accvgpr_read_b32 v199, a97
    v_accvgpr_read_b32 v252, a98
    v_accvgpr_read_b32 v255, a99
    v_mul_f32 v198, v198, v148
    v_mul_f32 v199, v199, v149
    v_mul_f32 v252, v252, v150
    v_mul_f32 v255, v255, v151
    v_accvgpr_write_b32 a96, v198
    v_accvgpr_write_b32 a97, v199
    v_accvgpr_write_b32 a98, v252
    v_accvgpr_write_b32 a99, v255
    v_accvgpr_read_b32 v198, a100
    v_accvgpr_read_b32 v199, a101
    v_accvgpr_read_b32 v252, a102
    v_accvgpr_read_b32 v255, a103
    v_mul_f32 v198, v198, v152
    v_mul_f32 v199, v199, v153
    v_mul_f32 v252, v252, v154
    v_mul_f32 v255, v255, v155
    v_accvgpr_write_b32 a100, v198
    v_accvgpr_write_b32 a101, v199
    v_accvgpr_write_b32 a102, v252
    v_accvgpr_write_b32 a103, v255
    v_accvgpr_read_b32 v198, a104
    v_accvgpr_read_b32 v199, a105
    v_accvgpr_read_b32 v252, a106
    v_accvgpr_read_b32 v255, a107
    v_mul_f32 v198, v198, v144
    v_mul_f32 v199, v199, v145
    v_mul_f32 v252, v252, v146
    v_mul_f32 v255, v255, v147
    v_accvgpr_write_b32 a104, v198
    v_accvgpr_write_b32 a105, v199
    v_accvgpr_write_b32 a106, v252
    v_accvgpr_write_b32 a107, v255
    v_accvgpr_read_b32 v198, a108
    v_accvgpr_read_b32 v199, a109
    v_accvgpr_read_b32 v252, a110
    v_accvgpr_read_b32 v255, a111
    v_mul_f32 v198, v198, v148
    v_mul_f32 v199, v199, v149
    v_mul_f32 v252, v252, v150
    v_mul_f32 v255, v255, v151
    v_accvgpr_write_b32 a108, v198
    v_accvgpr_write_b32 a109, v199
    v_accvgpr_write_b32 a110, v252
    v_accvgpr_write_b32 a111, v255
    v_accvgpr_read_b32 v198, a112
    v_accvgpr_read_b32 v199, a113
    v_accvgpr_read_b32 v252, a114
    v_accvgpr_read_b32 v255, a115
    v_mul_f32 v198, v198, v152
    v_mul_f32 v199, v199, v153
    v_mul_f32 v252, v252, v154
    v_mul_f32 v255, v255, v155
    v_accvgpr_write_b32 a112, v198
    v_accvgpr_write_b32 a113, v199
    v_accvgpr_write_b32 a114, v252
    v_accvgpr_write_b32 a115, v255
    v_accvgpr_read_b32 v198, a116
    v_accvgpr_read_b32 v199, a117
    v_accvgpr_read_b32 v252, a118
    v_accvgpr_read_b32 v255, a119
    v_mul_f32 v198, v198, v144
    v_mul_f32 v199, v199, v145
    v_mul_f32 v252, v252, v146
    v_mul_f32 v255, v255, v147
    v_accvgpr_write_b32 a116, v198
    v_accvgpr_write_b32 a117, v199
    v_accvgpr_write_b32 a118, v252
    v_accvgpr_write_b32 a119, v255
    v_accvgpr_read_b32 v198, a120
    v_accvgpr_read_b32 v199, a121
    v_accvgpr_read_b32 v252, a122
    v_accvgpr_read_b32 v255, a123
    v_mul_f32 v198, v198, v148
    v_mul_f32 v199, v199, v149
    v_mul_f32 v252, v252, v150
    v_mul_f32 v255, v255, v151
    v_accvgpr_write_b32 a120, v198
    v_accvgpr_write_b32 a121, v199
    v_accvgpr_write_b32 a122, v252
    v_accvgpr_write_b32 a123, v255
    v_accvgpr_read_b32 v198, a124
    v_accvgpr_read_b32 v199, a125
    v_accvgpr_read_b32 v252, a126
    v_accvgpr_read_b32 v255, a127
    v_mul_f32 v198, v198, v152
    v_mul_f32 v199, v199, v153
    v_mul_f32 v252, v252, v154
    v_mul_f32 v255, v255, v155
    v_accvgpr_write_b32 a124, v198
    v_accvgpr_write_b32 a125, v199
    v_accvgpr_write_b32 a126, v252
    v_accvgpr_write_b32 a127, v255
    v_lshlrev_b32 v198, 16, v168
    v_and_b32 v199, 0xffff0000, v168
    v_mul_f32 v198, v198, v192
    v_mul_f32 v199, v199, v192
    v_cvt_pk_bf16_f32 v168, v198, v199
    v_lshlrev_b32 v198, 16, v169
    v_and_b32 v199, 0xffff0000, v169
    v_mul_f32 v198, v198, v192
    v_mul_f32 v199, v199, v192
    v_cvt_pk_bf16_f32 v169, v198, v199
    v_lshlrev_b32 v198, 16, v170
    v_and_b32 v199, 0xffff0000, v170
    v_mul_f32 v198, v198, v192
    v_mul_f32 v199, v199, v192
    v_cvt_pk_bf16_f32 v170, v198, v199
    v_lshlrev_b32 v198, 16, v171
    v_and_b32 v199, 0xffff0000, v171
    v_mul_f32 v198, v198, v192
    v_mul_f32 v199, v199, v192
    v_cvt_pk_bf16_f32 v171, v198, v199
    v_lshlrev_b32 v198, 16, v172
    v_and_b32 v199, 0xffff0000, v172
    v_mul_f32 v198, v198, v193
    v_mul_f32 v199, v199, v193
    v_cvt_pk_bf16_f32 v172, v198, v199
    v_lshlrev_b32 v198, 16, v173
    v_and_b32 v199, 0xffff0000, v173
    v_mul_f32 v198, v198, v193
    v_mul_f32 v199, v199, v193
    v_cvt_pk_bf16_f32 v173, v198, v199
    v_lshlrev_b32 v198, 16, v174
    v_and_b32 v199, 0xffff0000, v174
    v_mul_f32 v198, v198, v193
    v_mul_f32 v199, v199, v193
    v_cvt_pk_bf16_f32 v174, v198, v199
    v_lshlrev_b32 v198, 16, v175
    v_and_b32 v199, 0xffff0000, v175
    v_mul_f32 v198, v198, v193
    v_mul_f32 v199, v199, v193
    v_cvt_pk_bf16_f32 v175, v198, v199
    v_lshlrev_b32 v198, 16, v176
    v_and_b32 v199, 0xffff0000, v176
    v_mul_f32 v198, v198, v194
    v_mul_f32 v199, v199, v194
    v_cvt_pk_bf16_f32 v176, v198, v199
    v_lshlrev_b32 v198, 16, v177
    v_and_b32 v199, 0xffff0000, v177
    v_mul_f32 v198, v198, v194
    v_mul_f32 v199, v199, v194
    v_cvt_pk_bf16_f32 v177, v198, v199
    v_lshlrev_b32 v198, 16, v178
    v_and_b32 v199, 0xffff0000, v178
    v_mul_f32 v198, v198, v194
    v_mul_f32 v199, v199, v194
    v_cvt_pk_bf16_f32 v178, v198, v199
    v_lshlrev_b32 v198, 16, v179
    v_and_b32 v199, 0xffff0000, v179
    v_mul_f32 v198, v198, v194
    v_mul_f32 v199, v199, v194
    v_cvt_pk_bf16_f32 v179, v198, v199
    v_lshlrev_b32 v198, 16, v180
    v_and_b32 v199, 0xffff0000, v180
    v_mul_f32 v198, v198, v192
    v_mul_f32 v199, v199, v192
    v_cvt_pk_bf16_f32 v180, v198, v199
    v_lshlrev_b32 v198, 16, v181
    v_and_b32 v199, 0xffff0000, v181
    v_mul_f32 v198, v198, v192
    v_mul_f32 v199, v199, v192
    v_cvt_pk_bf16_f32 v181, v198, v199
    v_lshlrev_b32 v198, 16, v182
    v_and_b32 v199, 0xffff0000, v182
    v_mul_f32 v198, v198, v192
    v_mul_f32 v199, v199, v192
    v_cvt_pk_bf16_f32 v182, v198, v199
    v_lshlrev_b32 v198, 16, v183
    v_and_b32 v199, 0xffff0000, v183
    v_mul_f32 v198, v198, v192
    v_mul_f32 v199, v199, v192
    v_cvt_pk_bf16_f32 v183, v198, v199
    v_lshlrev_b32 v198, 16, v184
    v_and_b32 v199, 0xffff0000, v184
    v_mul_f32 v198, v198, v193
    v_mul_f32 v199, v199, v193
    v_cvt_pk_bf16_f32 v184, v198, v199
    v_lshlrev_b32 v198, 16, v185
    v_and_b32 v199, 0xffff0000, v185
    v_mul_f32 v198, v198, v193
    v_mul_f32 v199, v199, v193
    v_cvt_pk_bf16_f32 v185, v198, v199
    v_lshlrev_b32 v198, 16, v186
    v_and_b32 v199, 0xffff0000, v186
    v_mul_f32 v198, v198, v193
    v_mul_f32 v199, v199, v193
    v_cvt_pk_bf16_f32 v186, v198, v199
    v_lshlrev_b32 v198, 16, v187
    v_and_b32 v199, 0xffff0000, v187
    v_mul_f32 v198, v198, v193
    v_mul_f32 v199, v199, v193
    v_cvt_pk_bf16_f32 v187, v198, v199
    v_lshlrev_b32 v198, 16, v188
    v_and_b32 v199, 0xffff0000, v188
    v_mul_f32 v198, v198, v194
    v_mul_f32 v199, v199, v194
    v_cvt_pk_bf16_f32 v188, v198, v199
    v_lshlrev_b32 v198, 16, v189
    v_and_b32 v199, 0xffff0000, v189
    v_mul_f32 v198, v198, v194
    v_mul_f32 v199, v199, v194
    v_cvt_pk_bf16_f32 v189, v198, v199
    v_lshlrev_b32 v198, 16, v190
    v_and_b32 v199, 0xffff0000, v190
    v_mul_f32 v198, v198, v194
    v_mul_f32 v199, v199, v194
    v_cvt_pk_bf16_f32 v190, v198, v199
    v_lshlrev_b32 v198, 16, v191
    v_and_b32 v199, 0xffff0000, v191
    v_mul_f32 v198, v198, v194
    v_mul_f32 v199, v199, v194
    v_cvt_pk_bf16_f32 v191, v198, v199
    v_mul_f32 v203, v200, v192
    v_sub_f32 v198, v96, v195
    v_sub_f32 v199, v97, v195
    v_sub_f32 v252, v98, v195
    v_sub_f32 v255, v99, v195
    v_exp_f32 v198, v198
    v_exp_f32 v199, v199
    v_exp_f32 v252, v252
    v_exp_f32 v255, v255
    s_nop 0
    v_add_f32 v203, v203, v198
    v_add_f32 v203, v203, v199
    v_add_f32 v203, v203, v252
    v_add_f32 v203, v203, v255
    v_cvt_pk_bf16_f32 v144, v198, v199
    v_cvt_pk_bf16_f32 v145, v252, v255
    v_sub_f32 v198, v108, v195
    v_sub_f32 v199, v109, v195
    v_sub_f32 v252, v110, v195
    v_sub_f32 v255, v111, v195
    v_exp_f32 v198, v198
    v_exp_f32 v199, v199
    v_exp_f32 v252, v252
    v_exp_f32 v255, v255
    s_nop 0
    v_add_f32 v203, v203, v198
    v_add_f32 v203, v203, v199
    v_add_f32 v203, v203, v252
    v_add_f32 v203, v203, v255
    v_cvt_pk_bf16_f32 v146, v198, v199
    v_cvt_pk_bf16_f32 v147, v252, v255
    v_sub_f32 v198, v120, v195
    v_sub_f32 v199, v121, v195
    v_sub_f32 v252, v122, v195
    v_sub_f32 v255, v123, v195
    v_exp_f32 v198, v198
    v_exp_f32 v199, v199
    v_exp_f32 v252, v252
    v_exp_f32 v255, v255
    s_nop 0
    v_add_f32 v203, v203, v198
    v_add_f32 v203, v203, v199
    v_add_f32 v203, v203, v252
    v_add_f32 v203, v203, v255
    v_cvt_pk_bf16_f32 v156, v198, v199
    v_cvt_pk_bf16_f32 v157, v252, v255
    v_sub_f32 v198, v132, v195
    v_sub_f32 v199, v133, v195
    v_sub_f32 v252, v134, v195
    v_sub_f32 v255, v135, v195
    v_exp_f32 v198, v198
    v_exp_f32 v199, v199
    v_exp_f32 v252, v252
    v_exp_f32 v255, v255
    s_nop 0
    v_add_f32 v203, v203, v198
    v_add_f32 v203, v203, v199
    v_add_f32 v203, v203, v252
    v_add_f32 v203, v203, v255
    v_cvt_pk_bf16_f32 v158, v198, v199
    v_cvt_pk_bf16_f32 v159, v252, v255
    v_mul_f32 v204, v201, v193
    v_sub_f32 v198, v100, v196
    v_sub_f32 v199, v101, v196
    v_sub_f32 v252, v102, v196
    v_sub_f32 v255, v103, v196
    v_exp_f32 v198, v198
    v_exp_f32 v199, v199
    v_exp_f32 v252, v252
    v_exp_f32 v255, v255
    s_nop 0
    v_add_f32 v204, v204, v198
    v_add_f32 v204, v204, v199
    v_add_f32 v204, v204, v252
    v_add_f32 v204, v204, v255
    v_cvt_pk_bf16_f32 v148, v198, v199
    v_cvt_pk_bf16_f32 v149, v252, v255
    v_sub_f32 v198, v112, v196
    v_sub_f32 v199, v113, v196
    v_sub_f32 v252, v114, v196
    v_sub_f32 v255, v115, v196
    v_exp_f32 v198, v198
    v_exp_f32 v199, v199
    v_exp_f32 v252, v252
    v_exp_f32 v255, v255
    s_nop 0
    v_add_f32 v204, v204, v198
    v_add_f32 v204, v204, v199
    v_add_f32 v204, v204, v252
    v_add_f32 v204, v204, v255
    v_cvt_pk_bf16_f32 v150, v198, v199
    v_cvt_pk_bf16_f32 v151, v252, v255
    v_sub_f32 v198, v124, v196
    v_sub_f32 v199, v125, v196
    v_sub_f32 v252, v126, v196
    v_sub_f32 v255, v127, v196
    v_exp_f32 v198, v198
    v_exp_f32 v199, v199
    v_exp_f32 v252, v252
    v_exp_f32 v255, v255
    s_nop 0
    v_add_f32 v204, v204, v198
    v_add_f32 v204, v204, v199
    v_add_f32 v204, v204, v252
    v_add_f32 v204, v204, v255
    v_cvt_pk_bf16_f32 v160, v198, v199
    v_cvt_pk_bf16_f32 v161, v252, v255
    v_sub_f32 v198, v136, v196
    v_sub_f32 v199, v137, v196
    v_sub_f32 v252, v138, v196
    v_sub_f32 v255, v139, v196
    v_exp_f32 v198, v198
    v_exp_f32 v199, v199
    v_exp_f32 v252, v252
    v_exp_f32 v255, v255
    s_nop 0
    v_add_f32 v204, v204, v198
    v_add_f32 v204, v204, v199
    v_add_f32 v204, v204, v252
    v_add_f32 v204, v204, v255
    v_cvt_pk_bf16_f32 v162, v198, v199
    v_cvt_pk_bf16_f32 v163, v252, v255
    v_mul_f32 v205, v202, v194
    v_sub_f32 v198, v104, v197
    v_sub_f32 v199, v105, v197
    v_sub_f32 v252, v106, v197
    v_sub_f32 v255, v107, v197
    v_exp_f32 v198, v198
    v_exp_f32 v199, v199
    v_exp_f32 v252, v252
    v_exp_f32 v255, v255
    s_nop 0
    v_add_f32 v205, v205, v198
    v_add_f32 v205, v205, v199
    v_add_f32 v205, v205, v252
    v_add_f32 v205, v205, v255
    v_cvt_pk_bf16_f32 v152, v198, v199
    v_cvt_pk_bf16_f32 v153, v252, v255
    v_sub_f32 v198, v116, v197
    v_sub_f32 v199, v117, v197
    v_sub_f32 v252, v118, v197
    v_sub_f32 v255, v119, v197
    v_exp_f32 v198, v198
    v_exp_f32 v199, v199
    v_exp_f32 v252, v252
    v_exp_f32 v255, v255
    s_nop 0
    v_add_f32 v205, v205, v198
    v_add_f32 v205, v205, v199
    v_add_f32 v205, v205, v252
    v_add_f32 v205, v205, v255
    v_cvt_pk_bf16_f32 v154, v198, v199
    v_cvt_pk_bf16_f32 v155, v252, v255
    v_sub_f32 v198, v128, v197
    v_sub_f32 v199, v129, v197
    v_sub_f32 v252, v130, v197
    v_sub_f32 v255, v131, v197
    v_exp_f32 v198, v198
    v_exp_f32 v199, v199
    v_exp_f32 v252, v252
    v_exp_f32 v255, v255
    s_nop 0
    v_add_f32 v205, v205, v198
    v_add_f32 v205, v205, v199
    v_add_f32 v205, v205, v252
    v_add_f32 v205, v205, v255
    v_cvt_pk_bf16_f32 v164, v198, v199
    v_cvt_pk_bf16_f32 v165, v252, v255
    v_sub_f32 v198, v140, v197
    v_sub_f32 v199, v141, v197
    v_sub_f32 v252, v142, v197
    v_sub_f32 v255, v143, v197
    v_exp_f32 v198, v198
    v_exp_f32 v199, v199
    v_exp_f32 v252, v252
    v_exp_f32 v255, v255
    s_nop 0
    v_add_f32 v205, v205, v198
    v_add_f32 v205, v205, v199
    v_add_f32 v205, v205, v252
    v_add_f32 v205, v205, v255
    v_cvt_pk_bf16_f32 v166, v198, v199
    v_cvt_pk_bf16_f32 v167, v252, v255
    s_nop 3
    s_setpc_b64 s[30:31]
L_slow_f1:
    s_nop 15
    v_log_f32 v198, v203
    v_max3_f32 v195, v96, v97, v98
    v_max3_f32 v195, v195, v99, v108
    v_max3_f32 v195, v195, v109, v110
    v_max3_f32 v195, v195, v111, v120
    v_max3_f32 v195, v195, v121, v122
    v_max3_f32 v195, v195, v123, v132
    v_max3_f32 v195, v195, v133, v134
    v_max3_f32 v195, v195, v135, v198
    v_mov_b32 v199, v195
    s_nop 1
    v_permlane32_swap_b32 v195, v199
    s_nop 1
    v_max_f32 v195, v195, v199
    v_mov_b32 v199, v195
    s_nop 1
    v_permlane16_swap_b32 v195, v199
    s_nop 1
    v_max_f32 v195, v195, v199
    v_max_f32 v195, 0, v195
    v_ceil_f32 v195, v195
    v_sub_f32 v208, v208, v195
    v_sub_f32 v209, v209, v195
    v_sub_f32 v210, v210, v195
    v_sub_f32 v211, v211, v195
    v_min_f32 v198, 0x43800000, v195
    v_cvt_i32_f32 v198, v198
    v_sub_u32 v198, 0, v198
    v_ldexp_f32 v192, 1.0, v198
    v_log_f32 v198, v204
    v_max3_f32 v196, v100, v101, v102
    v_max3_f32 v196, v196, v103, v112
    v_max3_f32 v196, v196, v113, v114
    v_max3_f32 v196, v196, v115, v124
    v_max3_f32 v196, v196, v125, v126
    v_max3_f32 v196, v196, v127, v136
    v_max3_f32 v196, v196, v137, v138
    v_max3_f32 v196, v196, v139, v198
    v_mov_b32 v199, v196
    s_nop 1
    v_permlane32_swap_b32 v196, v199
    s_nop 1
    v_max_f32 v196, v196, v199
    v_mov_b32 v199, v196
    s_nop 1
    v_permlane16_swap_b32 v196, v199
    s_nop 1
    v_max_f32 v196, v196, v199
    v_max_f32 v196, 0, v196
    v_ceil_f32 v196, v196
    v_sub_f32 v212, v212, v196
    v_sub_f32 v213, v213, v196
    v_sub_f32 v214, v214, v196
    v_sub_f32 v215, v215, v196
    v_min_f32 v198, 0x43800000, v196
    v_cvt_i32_f32 v198, v198
    v_sub_u32 v198, 0, v198
    v_ldexp_f32 v193, 1.0, v198
    v_log_f32 v198, v205
    v_max3_f32 v197, v104, v105, v106
    v_max3_f32 v197, v197, v107, v116
    v_max3_f32 v197, v197, v117, v118
    v_max3_f32 v197, v197, v119, v128
    v_max3_f32 v197, v197, v129, v130
    v_max3_f32 v197, v197, v131, v140
    v_max3_f32 v197, v197, v141, v142
    v_max3_f32 v197, v197, v143, v198
    v_mov_b32 v199, v197
    s_nop 1
    v_permlane32_swap_b32 v197, v199
    s_nop 1
    v_max_f32 v197, v197, v199
    v_mov_b32 v199, v197
    s_nop 1
    v_permlane16_swap_b32 v197, v199
    s_nop 1
    v_max_f32 v197, v197, v199
    v_max_f32 v197, 0, v197
    v_ceil_f32 v197, v197
    v_sub_f32 v216, v216, v197
    v_sub_f32 v217, v217, v197
    v_sub_f32 v218, v218, v197
    v_sub_f32 v219, v219, v197
    v_min_f32 v198, 0x43800000, v197
    v_cvt_i32_f32 v198, v198
    v_sub_u32 v198, 0, v198
    v_ldexp_f32 v194, 1.0, v198
    v_mbcnt_lo_u32_b32 v198, -1, 0
    v_mbcnt_hi_u32_b32 v198, -1, v198
    v_and_b32 v198, 48, v198
    ds_bpermute_b32 v228, v198, v192 offset:0
    ds_bpermute_b32 v229, v198, v192 offset:4
    ds_bpermute_b32 v230, v198, v192 offset:8
    ds_bpermute_b32 v231, v198, v192 offset:12
    ds_bpermute_b32 v232, v198, v193 offset:0
    ds_bpermute_b32 v233, v198, v193 offset:4
    ds_bpermute_b32 v234, v198, v193 offset:8
    ds_bpermute_b32 v235, v198, v193 offset:12
    ds_bpermute_b32 v236, v198, v194 offset:0
    ds_bpermute_b32 v237, v198, v194 offset:4
    ds_bpermute_b32 v238, v198, v194 offset:8
    ds_bpermute_b32 v239, v198, v194 offset:12
    s_waitcnt lgkmcnt(0)
    v_mul_f32 v0, v0, v228
    v_mul_f32 v1, v1, v229
    v_mul_f32 v2, v2, v230
    v_mul_f32 v3, v3, v231
    v_mul_f32 v4, v4, v232
    v_mul_f32 v5, v5, v233
    v_mul_f32 v6, v6, v234
    v_mul_f32 v7, v7, v235
    v_mul_f32 v8, v8, v236
    v_mul_f32 v9, v9, v237
    v_mul_f32 v10, v10, v238
    v_mul_f32 v11, v11, v239
    v_mul_f32 v12, v12, v228
    v_mul_f32 v13, v13, v229
    v_mul_f32 v14, v14, v230
    v_mul_f32 v15, v15, v231
    v_mul_f32 v16, v16, v232
    v_mul_f32 v17, v17, v233
    v_mul_f32 v18, v18, v234
    v_mul_f32 v19, v19, v235
    v_mul_f32 v20, v20, v236
    v_mul_f32 v21, v21, v237
    v_mul_f32 v22, v22, v238
    v_mul_f32 v23, v23, v239
    v_mul_f32 v24, v24, v228
    v_mul_f32 v25, v25, v229
    v_mul_f32 v26, v26, v230
    v_mul_f32 v27, v27, v231
    v_mul_f32 v28, v28, v232
    v_mul_f32 v29, v29, v233
    v_mul_f32 v30, v30, v234
    v_mul_f32 v31, v31, v235
    v_mul_f32 v32, v32, v236
    v_mul_f32 v33, v33, v237
    v_mul_f32 v34, v34, v238
    v_mul_f32 v35, v35, v239
    v_mul_f32 v36, v36, v228
    v_mul_f32 v37, v37, v229
    v_mul_f32 v38, v38, v230
    v_mul_f32 v39, v39, v231
    v_mul_f32 v40, v40, v232
    v_mul_f32 v41, v41, v233
    v_mul_f32 v42, v42, v234
    v_mul_f32 v43, v43, v235
    v_mul_f32 v44, v44, v236
    v_mul_f32 v45, v45, v237
    v_mul_f32 v46, v46, v238
    v_mul_f32 v47, v47, v239
    v_mul_f32 v48, v48, v228
    v_mul_f32 v49, v49, v229
    v_mul_f32 v50, v50, v230
    v_mul_f32 v51, v51, v231
    v_mul_f32 v52, v52, v232
    v_mul_f32 v53, v53, v233
    v_mul_f32 v54, v54, v234
    v_mul_f32 v55, v55, v235
    v_mul_f32 v56, v56, v236
    v_mul_f32 v57, v57, v237
    v_mul_f32 v58, v58, v238
    v_mul_f32 v59, v59, v239
    v_mul_f32 v60, v60, v228
    v_mul_f32 v61, v61, v229
    v_mul_f32 v62, v62, v230
    v_mul_f32 v63, v63, v231
    v_accvgpr_read_b32 v198, a0
    v_accvgpr_read_b32 v199, a1
    v_accvgpr_read_b32 v252, a2
    v_accvgpr_read_b32 v255, a3
    v_mul_f32 v198, v198, v232
    v_mul_f32 v199, v199, v233
    v_mul_f32 v252, v252, v234
    v_mul_f32 v255, v255, v235
    v_accvgpr_write_b32 a0, v198
    v_accvgpr_write_b32 a1, v199
    v_accvgpr_write_b32 a2, v252
    v_accvgpr_write_b32 a3, v255
    v_accvgpr_read_b32 v198, a4
    v_accvgpr_read_b32 v199, a5
    v_accvgpr_read_b32 v252, a6
    v_accvgpr_read_b32 v255, a7
    v_mul_f32 v198, v198, v236
    v_mul_f32 v199, v199, v237
    v_mul_f32 v252, v252, v238
    v_mul_f32 v255, v255, v239
    v_accvgpr_write_b32 a4, v198
    v_accvgpr_write_b32 a5, v199
    v_accvgpr_write_b32 a6, v252
    v_accvgpr_write_b32 a7, v255
    v_accvgpr_read_b32 v198, a8
    v_accvgpr_read_b32 v199, a9
    v_accvgpr_read_b32 v252, a10
    v_accvgpr_read_b32 v255, a11
    v_mul_f32 v198, v198, v228
    v_mul_f32 v199, v199, v229
    v_mul_f32 v252, v252, v230
    v_mul_f32 v255, v255, v231
    v_accvgpr_write_b32 a8, v198
    v_accvgpr_write_b32 a9, v199
    v_accvgpr_write_b32 a10, v252
    v_accvgpr_write_b32 a11, v255
    v_accvgpr_read_b32 v198, a12
    v_accvgpr_read_b32 v199, a13
    v_accvgpr_read_b32 v252, a14
    v_accvgpr_read_b32 v255, a15
    v_mul_f32 v198, v198, v232
    v_mul_f32 v199, v199, v233
    v_mul_f32 v252, v252, v234
    v_mul_f32 v255, v255, v235
    v_accvgpr_write_b32 a12, v198
    v_accvgpr_write_b32 a13, v199
    v_accvgpr_write_b32 a14, v252
    v_accvgpr_write_b32 a15, v255
    v_accvgpr_read_b32 v198, a16
    v_accvgpr_read_b32 v199, a17
    v_accvgpr_read_b32 v252, a18
    v_accvgpr_read_b32 v255, a19
    v_mul_f32 v198, v198, v236
    v_mul_f32 v199, v199, v237
    v_mul_f32 v252, v252, v238
    v_mul_f32 v255, v255, v239
    v_accvgpr_write_b32 a16, v198
    v_accvgpr_write_b32 a17, v199
    v_accvgpr_write_b32 a18, v252
    v_accvgpr_write_b32 a19, v255
    v_accvgpr_read_b32 v198, a20
    v_accvgpr_read_b32 v199, a21
    v_accvgpr_read_b32 v252, a22
    v_accvgpr_read_b32 v255, a23
    v_mul_f32 v198, v198, v228
    v_mul_f32 v199, v199, v229
    v_mul_f32 v252, v252, v230
    v_mul_f32 v255, v255, v231
    v_accvgpr_write_b32 a20, v198
    v_accvgpr_write_b32 a21, v199
    v_accvgpr_write_b32 a22, v252
    v_accvgpr_write_b32 a23, v255
    v_accvgpr_read_b32 v198, a24
    v_accvgpr_read_b32 v199, a25
    v_accvgpr_read_b32 v252, a26
    v_accvgpr_read_b32 v255, a27
    v_mul_f32 v198, v198, v232
    v_mul_f32 v199, v199, v233
    v_mul_f32 v252, v252, v234
    v_mul_f32 v255, v255, v235
    v_accvgpr_write_b32 a24, v198
    v_accvgpr_write_b32 a25, v199
    v_accvgpr_write_b32 a26, v252
    v_accvgpr_write_b32 a27, v255
    v_accvgpr_read_b32 v198, a28
    v_accvgpr_read_b32 v199, a29
    v_accvgpr_read_b32 v252, a30
    v_accvgpr_read_b32 v255, a31
    v_mul_f32 v198, v198, v236
    v_mul_f32 v199, v199, v237
    v_mul_f32 v252, v252, v238
    v_mul_f32 v255, v255, v239
    v_accvgpr_write_b32 a28, v198
    v_accvgpr_write_b32 a29, v199
    v_accvgpr_write_b32 a30, v252
    v_accvgpr_write_b32 a31, v255
    v_accvgpr_read_b32 v198, a32
    v_accvgpr_read_b32 v199, a33
    v_accvgpr_read_b32 v252, a34
    v_accvgpr_read_b32 v255, a35
    v_mul_f32 v198, v198, v228
    v_mul_f32 v199, v199, v229
    v_mul_f32 v252, v252, v230
    v_mul_f32 v255, v255, v231
    v_accvgpr_write_b32 a32, v198
    v_accvgpr_write_b32 a33, v199
    v_accvgpr_write_b32 a34, v252
    v_accvgpr_write_b32 a35, v255
    v_accvgpr_read_b32 v198, a36
    v_accvgpr_read_b32 v199, a37
    v_accvgpr_read_b32 v252, a38
    v_accvgpr_read_b32 v255, a39
    v_mul_f32 v198, v198, v232
    v_mul_f32 v199, v199, v233
    v_mul_f32 v252, v252, v234
    v_mul_f32 v255, v255, v235
    v_accvgpr_write_b32 a36, v198
    v_accvgpr_write_b32 a37, v199
    v_accvgpr_write_b32 a38, v252
    v_accvgpr_write_b32 a39, v255
    v_accvgpr_read_b32 v198, a40
    v_accvgpr_read_b32 v199, a41
    v_accvgpr_read_b32 v252, a42
    v_accvgpr_read_b32 v255, a43
    v_mul_f32 v198, v198, v236
    v_mul_f32 v199, v199, v237
    v_mul_f32 v252, v252, v238
    v_mul_f32 v255, v255, v239
    v_accvgpr_write_b32 a40, v198
    v_accvgpr_write_b32 a41, v199
    v_accvgpr_write_b32 a42, v252
    v_accvgpr_write_b32 a43, v255
    v_accvgpr_read_b32 v198, a44
    v_accvgpr_read_b32 v199, a45
    v_accvgpr_read_b32 v252, a46
    v_accvgpr_read_b32 v255, a47
    v_mul_f32 v198, v198, v228
    v_mul_f32 v199, v199, v229
    v_mul_f32 v252, v252, v230
    v_mul_f32 v255, v255, v231
    v_accvgpr_write_b32 a44, v198
    v_accvgpr_write_b32 a45, v199
    v_accvgpr_write_b32 a46, v252
    v_accvgpr_write_b32 a47, v255
    v_accvgpr_read_b32 v198, a48
    v_accvgpr_read_b32 v199, a49
    v_accvgpr_read_b32 v252, a50
    v_accvgpr_read_b32 v255, a51
    v_mul_f32 v198, v198, v232
    v_mul_f32 v199, v199, v233
    v_mul_f32 v252, v252, v234
    v_mul_f32 v255, v255, v235
    v_accvgpr_write_b32 a48, v198
    v_accvgpr_write_b32 a49, v199
    v_accvgpr_write_b32 a50, v252
    v_accvgpr_write_b32 a51, v255
    v_accvgpr_read_b32 v198, a52
    v_accvgpr_read_b32 v199, a53
    v_accvgpr_read_b32 v252, a54
    v_accvgpr_read_b32 v255, a55
    v_mul_f32 v198, v198, v236
    v_mul_f32 v199, v199, v237
    v_mul_f32 v252, v252, v238
    v_mul_f32 v255, v255, v239
    v_accvgpr_write_b32 a52, v198
    v_accvgpr_write_b32 a53, v199
    v_accvgpr_write_b32 a54, v252
    v_accvgpr_write_b32 a55, v255
    v_accvgpr_read_b32 v198, a56
    v_accvgpr_read_b32 v199, a57
    v_accvgpr_read_b32 v252, a58
    v_accvgpr_read_b32 v255, a59
    v_mul_f32 v198, v198, v228
    v_mul_f32 v199, v199, v229
    v_mul_f32 v252, v252, v230
    v_mul_f32 v255, v255, v231
    v_accvgpr_write_b32 a56, v198
    v_accvgpr_write_b32 a57, v199
    v_accvgpr_write_b32 a58, v252
    v_accvgpr_write_b32 a59, v255
    v_accvgpr_read_b32 v198, a60
    v_accvgpr_read_b32 v199, a61
    v_accvgpr_read_b32 v252, a62
    v_accvgpr_read_b32 v255, a63
    v_mul_f32 v198, v198, v232
    v_mul_f32 v199, v199, v233
    v_mul_f32 v252, v252, v234
    v_mul_f32 v255, v255, v235
    v_accvgpr_write_b32 a60, v198
    v_accvgpr_write_b32 a61, v199
    v_accvgpr_write_b32 a62, v252
    v_accvgpr_write_b32 a63, v255
    v_accvgpr_read_b32 v198, a64
    v_accvgpr_read_b32 v199, a65
    v_accvgpr_read_b32 v252, a66
    v_accvgpr_read_b32 v255, a67
    v_mul_f32 v198, v198, v236
    v_mul_f32 v199, v199, v237
    v_mul_f32 v252, v252, v238
    v_mul_f32 v255, v255, v239
    v_accvgpr_write_b32 a64, v198
    v_accvgpr_write_b32 a65, v199
    v_accvgpr_write_b32 a66, v252
    v_accvgpr_write_b32 a67, v255
    v_accvgpr_read_b32 v198, a68
    v_accvgpr_read_b32 v199, a69
    v_accvgpr_read_b32 v252, a70
    v_accvgpr_read_b32 v255, a71
    v_mul_f32 v198, v198, v228
    v_mul_f32 v199, v199, v229
    v_mul_f32 v252, v252, v230
    v_mul_f32 v255, v255, v231
    v_accvgpr_write_b32 a68, v198
    v_accvgpr_write_b32 a69, v199
    v_accvgpr_write_b32 a70, v252
    v_accvgpr_write_b32 a71, v255
    v_accvgpr_read_b32 v198, a72
    v_accvgpr_read_b32 v199, a73
    v_accvgpr_read_b32 v252, a74
    v_accvgpr_read_b32 v255, a75
    v_mul_f32 v198, v198, v232
    v_mul_f32 v199, v199, v233
    v_mul_f32 v252, v252, v234
    v_mul_f32 v255, v255, v235
    v_accvgpr_write_b32 a72, v198
    v_accvgpr_write_b32 a73, v199
    v_accvgpr_write_b32 a74, v252
    v_accvgpr_write_b32 a75, v255
    v_accvgpr_read_b32 v198, a76
    v_accvgpr_read_b32 v199, a77
    v_accvgpr_read_b32 v252, a78
    v_accvgpr_read_b32 v255, a79
    v_mul_f32 v198, v198, v236
    v_mul_f32 v199, v199, v237
    v_mul_f32 v252, v252, v238
    v_mul_f32 v255, v255, v239
    v_accvgpr_write_b32 a76, v198
    v_accvgpr_write_b32 a77, v199
    v_accvgpr_write_b32 a78, v252
    v_accvgpr_write_b32 a79, v255
    v_accvgpr_read_b32 v198, a80
    v_accvgpr_read_b32 v199, a81
    v_accvgpr_read_b32 v252, a82
    v_accvgpr_read_b32 v255, a83
    v_mul_f32 v198, v198, v228
    v_mul_f32 v199, v199, v229
    v_mul_f32 v252, v252, v230
    v_mul_f32 v255, v255, v231
    v_accvgpr_write_b32 a80, v198
    v_accvgpr_write_b32 a81, v199
    v_accvgpr_write_b32 a82, v252
    v_accvgpr_write_b32 a83, v255
    v_accvgpr_read_b32 v198, a84
    v_accvgpr_read_b32 v199, a85
    v_accvgpr_read_b32 v252, a86
    v_accvgpr_read_b32 v255, a87
    v_mul_f32 v198, v198, v232
    v_mul_f32 v199, v199, v233
    v_mul_f32 v252, v252, v234
    v_mul_f32 v255, v255, v235
    v_accvgpr_write_b32 a84, v198
    v_accvgpr_write_b32 a85, v199
    v_accvgpr_write_b32 a86, v252
    v_accvgpr_write_b32 a87, v255
    v_accvgpr_read_b32 v198, a88
    v_accvgpr_read_b32 v199, a89
    v_accvgpr_read_b32 v252, a90
    v_accvgpr_read_b32 v255, a91
    v_mul_f32 v198, v198, v236
    v_mul_f32 v199, v199, v237
    v_mul_f32 v252, v252, v238
    v_mul_f32 v255, v255, v239
    v_accvgpr_write_b32 a88, v198
    v_accvgpr_write_b32 a89, v199
    v_accvgpr_write_b32 a90, v252
    v_accvgpr_write_b32 a91, v255
    v_accvgpr_read_b32 v198, a92
    v_accvgpr_read_b32 v199, a93
    v_accvgpr_read_b32 v252, a94
    v_accvgpr_read_b32 v255, a95
    v_mul_f32 v198, v198, v228
    v_mul_f32 v199, v199, v229
    v_mul_f32 v252, v252, v230
    v_mul_f32 v255, v255, v231
    v_accvgpr_write_b32 a92, v198
    v_accvgpr_write_b32 a93, v199
    v_accvgpr_write_b32 a94, v252
    v_accvgpr_write_b32 a95, v255
    v_accvgpr_read_b32 v198, a96
    v_accvgpr_read_b32 v199, a97
    v_accvgpr_read_b32 v252, a98
    v_accvgpr_read_b32 v255, a99
    v_mul_f32 v198, v198, v232
    v_mul_f32 v199, v199, v233
    v_mul_f32 v252, v252, v234
    v_mul_f32 v255, v255, v235
    v_accvgpr_write_b32 a96, v198
    v_accvgpr_write_b32 a97, v199
    v_accvgpr_write_b32 a98, v252
    v_accvgpr_write_b32 a99, v255
    v_accvgpr_read_b32 v198, a100
    v_accvgpr_read_b32 v199, a101
    v_accvgpr_read_b32 v252, a102
    v_accvgpr_read_b32 v255, a103
    v_mul_f32 v198, v198, v236
    v_mul_f32 v199, v199, v237
    v_mul_f32 v252, v252, v238
    v_mul_f32 v255, v255, v239
    v_accvgpr_write_b32 a100, v198
    v_accvgpr_write_b32 a101, v199
    v_accvgpr_write_b32 a102, v252
    v_accvgpr_write_b32 a103, v255
    v_accvgpr_read_b32 v198, a104
    v_accvgpr_read_b32 v199, a105
    v_accvgpr_read_b32 v252, a106
    v_accvgpr_read_b32 v255, a107
    v_mul_f32 v198, v198, v228
    v_mul_f32 v199, v199, v229
    v_mul_f32 v252, v252, v230
    v_mul_f32 v255, v255, v231
    v_accvgpr_write_b32 a104, v198
    v_accvgpr_write_b32 a105, v199
    v_accvgpr_write_b32 a106, v252
    v_accvgpr_write_b32 a107, v255
    v_accvgpr_read_b32 v198, a108
    v_accvgpr_read_b32 v199, a109
    v_accvgpr_read_b32 v252, a110
    v_accvgpr_read_b32 v255, a111
    v_mul_f32 v198, v198, v232
    v_mul_f32 v199, v199, v233
    v_mul_f32 v252, v252, v234
    v_mul_f32 v255, v255, v235
    v_accvgpr_write_b32 a108, v198
    v_accvgpr_write_b32 a109, v199
    v_accvgpr_write_b32 a110, v252
    v_accvgpr_write_b32 a111, v255
    v_accvgpr_read_b32 v198, a112
    v_accvgpr_read_b32 v199, a113
    v_accvgpr_read_b32 v252, a114
    v_accvgpr_read_b32 v255, a115
    v_mul_f32 v198, v198, v236
    v_mul_f32 v199, v199, v237
    v_mul_f32 v252, v252, v238
    v_mul_f32 v255, v255, v239
    v_accvgpr_write_b32 a112, v198
    v_accvgpr_write_b32 a113, v199
    v_accvgpr_write_b32 a114, v252
    v_accvgpr_write_b32 a115, v255
    v_accvgpr_read_b32 v198, a116
    v_accvgpr_read_b32 v199, a117
    v_accvgpr_read_b32 v252, a118
    v_accvgpr_read_b32 v255, a119
    v_mul_f32 v198, v198, v228
    v_mul_f32 v199, v199, v229
    v_mul_f32 v252, v252, v230
    v_mul_f32 v255, v255, v231
    v_accvgpr_write_b32 a116, v198
    v_accvgpr_write_b32 a117, v199
    v_accvgpr_write_b32 a118, v252
    v_accvgpr_write_b32 a119, v255
    v_accvgpr_read_b32 v198, a120
    v_accvgpr_read_b32 v199, a121
    v_accvgpr_read_b32 v252, a122
    v_accvgpr_read_b32 v255, a123
    v_mul_f32 v198, v198, v232
    v_mul_f32 v199, v199, v233
    v_mul_f32 v252, v252, v234
    v_mul_f32 v255, v255, v235
    v_accvgpr_write_b32 a120, v198
    v_accvgpr_write_b32 a121, v199
    v_accvgpr_write_b32 a122, v252
    v_accvgpr_write_b32 a123, v255
    v_accvgpr_read_b32 v198, a124
    v_accvgpr_read_b32 v199, a125
    v_accvgpr_read_b32 v252, a126
    v_accvgpr_read_b32 v255, a127
    v_mul_f32 v198, v198, v236
    v_mul_f32 v199, v199, v237
    v_mul_f32 v252, v252, v238
    v_mul_f32 v255, v255, v239
    v_accvgpr_write_b32 a124, v198
    v_accvgpr_write_b32 a125, v199
    v_accvgpr_write_b32 a126, v252
    v_accvgpr_write_b32 a127, v255
    v_lshlrev_b32 v198, 16, v144
    v_and_b32 v199, 0xffff0000, v144
    v_mul_f32 v198, v198, v192
    v_mul_f32 v199, v199, v192
    v_cvt_pk_bf16_f32 v144, v198, v199
    v_lshlrev_b32 v198, 16, v145
    v_and_b32 v199, 0xffff0000, v145
    v_mul_f32 v198, v198, v192
    v_mul_f32 v199, v199, v192
    v_cvt_pk_bf16_f32 v145, v198, v199
    v_lshlrev_b32 v198, 16, v146
    v_and_b32 v199, 0xffff0000, v146
    v_mul_f32 v198, v198, v192
    v_mul_f32 v199, v199, v192
    v_cvt_pk_bf16_f32 v146, v198, v199
    v_lshlrev_b32 v198, 16, v147
    v_and_b32 v199, 0xffff0000, v147
    v_mul_f32 v198, v198, v192
    v_mul_f32 v199, v199, v192
    v_cvt_pk_bf16_f32 v147, v198, v199
    v_lshlrev_b32 v198, 16, v148
    v_and_b32 v199, 0xffff0000, v148
    v_mul_f32 v198, v198, v193
    v_mul_f32 v199, v199, v193
    v_cvt_pk_bf16_f32 v148, v198, v199
    v_lshlrev_b32 v198, 16, v149
    v_and_b32 v199, 0xffff0000, v149
    v_mul_f32 v198, v198, v193
    v_mul_f32 v199, v199, v193
    v_cvt_pk_bf16_f32 v149, v198, v199
    v_lshlrev_b32 v198, 16, v150
    v_and_b32 v199, 0xffff0000, v150
    v_mul_f32 v198, v198, v193
    v_mul_f32 v199, v199, v193
    v_cvt_pk_bf16_f32 v150, v198, v199
    v_lshlrev_b32 v198, 16, v151
    v_and_b32 v199, 0xffff0000, v151
    v_mul_f32 v198, v198, v193
    v_mul_f32 v199, v199, v193
    v_cvt_pk_bf16_f32 v151, v198, v199
    v_lshlrev_b32 v198, 16, v152
    v_and_b32 v199, 0xffff0000, v152
    v_mul_f32 v198, v198, v194
    v_mul_f32 v199, v199, v194
    v_cvt_pk_bf16_f32 v152, v198, v199
    v_lshlrev_b32 v198, 16, v153
    v_and_b32 v199, 0xffff0000, v153
    v_mul_f32 v198, v198, v194
    v_mul_f32 v199, v199, v194
    v_cvt_pk_bf16_f32 v153, v198, v199
    v_lshlrev_b32 v198, 16, v154
    v_and_b32 v199, 0xffff0000, v154
    v_mul_f32 v198, v198, v194
    v_mul_f32 v199, v199, v194
    v_cvt_pk_bf16_f32 v154, v198, v199
    v_lshlrev_b32 v198, 16, v155
    v_and_b32 v199, 0xffff0000, v155
    v_mul_f32 v198, v198, v194
    v_mul_f32 v199, v199, v194
    v_cvt_pk_bf16_f32 v155, v198, v199
    v_lshlrev_b32 v198, 16, v156
    v_and_b32 v199, 0xffff0000, v156
    v_mul_f32 v198, v198, v192
    v_mul_f32 v199, v199, v192
    v_cvt_pk_bf16_f32 v156, v198, v199
    v_lshlrev_b32 v198, 16, v157
    v_and_b32 v199, 0xffff0000, v157
    v_mul_f32 v198, v198, v192
    v_mul_f32 v199, v199, v192
    v_cvt_pk_bf16_f32 v157, v198, v199
    v_lshlrev_b32 v198, 16, v158
    v_and_b32 v199, 0xffff0000, v158
    v_mul_f32 v198, v198, v192
    v_mul_f32 v199, v199, v192
    v_cvt_pk_bf16_f32 v158, v198, v199
    v_lshlrev_b32 v198, 16, v159
    v_and_b32 v199, 0xffff0000, v159
    v_mul_f32 v198, v198, v192
    v_mul_f32 v199, v199, v192
    v_cvt_pk_bf16_f32 v159, v198, v199
    v_lshlrev_b32 v198, 16, v160
    v_and_b32 v199, 0xffff0000, v160
    v_mul_f32 v198, v198, v193
    v_mul_f32 v199, v199, v193
    v_cvt_pk_bf16_f32 v160, v198, v199
    v_lshlrev_b32 v198, 16, v161
    v_and_b32 v199, 0xffff0000, v161
    v_mul_f32 v198, v198, v193
    v_mul_f32 v199, v199, v193
    v_cvt_pk_bf16_f32 v161, v198, v199
    v_lshlrev_b32 v198, 16, v162
    v_and_b32 v199, 0xffff0000, v162
    v_mul_f32 v198, v198, v193
    v_mul_f32 v199, v199, v193
    v_cvt_pk_bf16_f32 v162, v198, v199
    v_lshlrev_b32 v198, 16, v163
    v_and_b32 v199, 0xffff0000, v163
    v_mul_f32 v198, v198, v193
    v_mul_f32 v199, v199, v193
    v_cvt_pk_bf16_f32 v163, v198, v199
    v_lshlrev_b32 v198, 16, v164
    v_and_b32 v199, 0xffff0000, v164
    v_mul_f32 v198, v198, v194
    v_mul_f32 v199, v199, v194
    v_cvt_pk_bf16_f32 v164, v198, v199
    v_lshlrev_b32 v198, 16, v165
    v_and_b32 v199, 0xffff0000, v165
    v_mul_f32 v198, v198, v194
    v_mul_f32 v199, v199, v194
    v_cvt_pk_bf16_f32 v165, v198, v199
    v_lshlrev_b32 v198, 16, v166
    v_and_b32 v199, 0xffff0000, v166
    v_mul_f32 v198, v198, v194
    v_mul_f32 v199, v199, v194
    v_cvt_pk_bf16_f32 v166, v198, v199
    v_lshlrev_b32 v198, 16, v167
    v_and_b32 v199, 0xffff0000, v167
    v_mul_f32 v198, v198, v194
    v_mul_f32 v199, v199, v194
    v_cvt_pk_bf16_f32 v167, v198, v199
    v_lshlrev_b32 v198, 16, v168
    v_and_b32 v199, 0xffff0000, v168
    v_mul_f32 v198, v198, v192
    v_mul_f32 v199, v199, v192
    v_cvt_pk_bf16_f32 v168, v198, v199
    v_lshlrev_b32 v198, 16, v169
    v_and_b32 v199, 0xffff0000, v169
    v_mul_f32 v198, v198, v192
    v_mul_f32 v199, v199, v192
    v_cvt_pk_bf16_f32 v169, v198, v199
    v_lshlrev_b32 v198, 16, v170
    v_and_b32 v199, 0xffff0000, v170
    v_mul_f32 v198, v198, v192
    v_mul_f32 v199, v199, v192
    v_cvt_pk_bf16_f32 v170, v198, v199
    v_lshlrev_b32 v198, 16, v171
    v_and_b32 v199, 0xffff0000, v171
    v_mul_f32 v198, v198, v192
    v_mul_f32 v199, v199, v192
    v_cvt_pk_bf16_f32 v171, v198, v199
    v_lshlrev_b32 v198, 16, v172
    v_and_b32 v199, 0xffff0000, v172
    v_mul_f32 v198, v198, v193
    v_mul_f32 v199, v199, v193
    v_cvt_pk_bf16_f32 v172, v198, v199
    v_lshlrev_b32 v198, 16, v173
    v_and_b32 v199, 0xffff0000, v173
    v_mul_f32 v198, v198, v193
    v_mul_f32 v199, v199, v193
    v_cvt_pk_bf16_f32 v173, v198, v199
    v_lshlrev_b32 v198, 16, v174
    v_and_b32 v199, 0xffff0000, v174
    v_mul_f32 v198, v198, v193
    v_mul_f32 v199, v199, v193
    v_cvt_pk_bf16_f32 v174, v198, v199
    v_lshlrev_b32 v198, 16, v175
    v_and_b32 v199, 0xffff0000, v175
    v_mul_f32 v198, v198, v193
    v_mul_f32 v199, v199, v193
    v_cvt_pk_bf16_f32 v175, v198, v199
    v_lshlrev_b32 v198, 16, v176
    v_and_b32 v199, 0xffff0000, v176
    v_mul_f32 v198, v198, v194
    v_mul_f32 v199, v199, v194
    v_cvt_pk_bf16_f32 v176, v198, v199
    v_lshlrev_b32 v198, 16, v177
    v_and_b32 v199, 0xffff0000, v177
    v_mul_f32 v198, v198, v194
    v_mul_f32 v199, v199, v194
    v_cvt_pk_bf16_f32 v177, v198, v199
    v_lshlrev_b32 v198, 16, v178
    v_and_b32 v199, 0xffff0000, v178
    v_mul_f32 v198, v198, v194
    v_mul_f32 v199, v199, v194
    v_cvt_pk_bf16_f32 v178, v198, v199
    v_lshlrev_b32 v198, 16, v179
    v_and_b32 v199, 0xffff0000, v179
    v_mul_f32 v198, v198, v194
    v_mul_f32 v199, v199, v194
    v_cvt_pk_bf16_f32 v179, v198, v199
    v_lshlrev_b32 v198, 16, v180
    v_and_b32 v199, 0xffff0000, v180
    v_mul_f32 v198, v198, v192
    v_mul_f32 v199, v199, v192
    v_cvt_pk_bf16_f32 v180, v198, v199
    v_lshlrev_b32 v198, 16, v181
    v_and_b32 v199, 0xffff0000, v181
    v_mul_f32 v198, v198, v192
    v_mul_f32 v199, v199, v192
    v_cvt_pk_bf16_f32 v181, v198, v199
    v_lshlrev_b32 v198, 16, v182
    v_and_b32 v199, 0xffff0000, v182
    v_mul_f32 v198, v198, v192
    v_mul_f32 v199, v199, v192
    v_cvt_pk_bf16_f32 v182, v198, v199
    v_lshlrev_b32 v198, 16, v183
    v_and_b32 v199, 0xffff0000, v183
    v_mul_f32 v198, v198, v192
    v_mul_f32 v199, v199, v192
    v_cvt_pk_bf16_f32 v183, v198, v199
    v_lshlrev_b32 v198, 16, v184
    v_and_b32 v199, 0xffff0000, v184
    v_mul_f32 v198, v198, v193
    v_mul_f32 v199, v199, v193
    v_cvt_pk_bf16_f32 v184, v198, v199
    v_lshlrev_b32 v198, 16, v185
    v_and_b32 v199, 0xffff0000, v185
    v_mul_f32 v198, v198, v193
    v_mul_f32 v199, v199, v193
    v_cvt_pk_bf16_f32 v185, v198, v199
    v_lshlrev_b32 v198, 16, v186
    v_and_b32 v199, 0xffff0000, v186
    v_mul_f32 v198, v198, v193
    v_mul_f32 v199, v199, v193
    v_cvt_pk_bf16_f32 v186, v198, v199
    v_lshlrev_b32 v198, 16, v187
    v_and_b32 v199, 0xffff0000, v187
    v_mul_f32 v198, v198, v193
    v_mul_f32 v199, v199, v193
    v_cvt_pk_bf16_f32 v187, v198, v199
    v_lshlrev_b32 v198, 16, v188
    v_and_b32 v199, 0xffff0000, v188
    v_mul_f32 v198, v198, v194
    v_mul_f32 v199, v199, v194
    v_cvt_pk_bf16_f32 v188, v198, v199
    v_lshlrev_b32 v198, 16, v189
    v_and_b32 v199, 0xffff0000, v189
    v_mul_f32 v198, v198, v194
    v_mul_f32 v199, v199, v194
    v_cvt_pk_bf16_f32 v189, v198, v199
    v_lshlrev_b32 v198, 16, v190
    v_and_b32 v199, 0xffff0000, v190
    v_mul_f32 v198, v198, v194
    v_mul_f32 v199, v199, v194
    v_cvt_pk_bf16_f32 v190, v198, v199
    v_lshlrev_b32 v198, 16, v191
    v_and_b32 v199, 0xffff0000, v191
    v_mul_f32 v198, v198, v194
    v_mul_f32 v199, v199, v194
    v_cvt_pk_bf16_f32 v191, v198, v199
    v_mul_f32 v200, v203, v192
    v_sub_f32 v198, v96, v195
    v_sub_f32 v199, v97, v195
    v_sub_f32 v252, v98, v195
    v_sub_f32 v255, v99, v195
    v_exp_f32 v198, v198
    v_exp_f32 v199, v199
    v_exp_f32 v252, v252
    v_exp_f32 v255, v255
    s_nop 0
    v_add_f32 v200, v200, v198
    v_add_f32 v200, v200, v199
    v_add_f32 v200, v200, v252
    v_add_f32 v200, v200, v255
    v_cvt_pk_bf16_f32 v228, v198, v199
    v_cvt_pk_bf16_f32 v229, v252, v255
    v_sub_f32 v198, v108, v195
    v_sub_f32 v199, v109, v195
    v_sub_f32 v252, v110, v195
    v_sub_f32 v255, v111, v195
    v_exp_f32 v198, v198
    v_exp_f32 v199, v199
    v_exp_f32 v252, v252
    v_exp_f32 v255, v255
    s_nop 0
    v_add_f32 v200, v200, v198
    v_add_f32 v200, v200, v199
    v_add_f32 v200, v200, v252
    v_add_f32 v200, v200, v255
    v_cvt_pk_bf16_f32 v230, v198, v199
    v_cvt_pk_bf16_f32 v231, v252, v255
    v_sub_f32 v198, v120, v195
    v_sub_f32 v199, v121, v195
    v_sub_f32 v252, v122, v195
    v_sub_f32 v255, v123, v195
    v_exp_f32 v198, v198
    v_exp_f32 v199, v199
    v_exp_f32 v252, v252
    v_exp_f32 v255, v255
    s_nop 0
    v_add_f32 v200, v200, v198
    v_add_f32 v200, v200, v199
    v_add_f32 v200, v200, v252
    v_add_f32 v200, v200, v255
    v_cvt_pk_bf16_f32 v240, v198, v199
    v_cvt_pk_bf16_f32 v241, v252, v255
    v_sub_f32 v198, v132, v195
    v_sub_f32 v199, v133, v195
    v_sub_f32 v252, v134, v195
    v_sub_f32 v255, v135, v195
    v_exp_f32 v198, v198
    v_exp_f32 v199, v199
    v_exp_f32 v252, v252
    v_exp_f32 v255, v255
    s_nop 0
    v_add_f32 v200, v200, v198
    v_add_f32 v200, v200, v199
    v_add_f32 v200, v200, v252
    v_add_f32 v200, v200, v255
    v_cvt_pk_bf16_f32 v242, v198, v199
    v_cvt_pk_bf16_f32 v243, v252, v255
    v_mul_f32 v201, v204, v193
    v_sub_f32 v198, v100, v196
    v_sub_f32 v199, v101, v196
    v_sub_f32 v252, v102, v196
    v_sub_f32 v255, v103, v196
    v_exp_f32 v198, v198
    v_exp_f32 v199, v199
    v_exp_f32 v252, v252
    v_exp_f32 v255, v255
    s_nop 0
    v_add_f32 v201, v201, v198
    v_add_f32 v201, v201, v199
    v_add_f32 v201, v201, v252
    v_add_f32 v201, v201, v255
    v_cvt_pk_bf16_f32 v232, v198, v199
    v_cvt_pk_bf16_f32 v233, v252, v255
    v_sub_f32 v198, v112, v196
    v_sub_f32 v199, v113, v196
    v_sub_f32 v252, v114, v196
    v_sub_f32 v255, v115, v196
    v_exp_f32 v198, v198
    v_exp_f32 v199, v199
    v_exp_f32 v252, v252
    v_exp_f32 v255, v255
    s_nop 0
    v_add_f32 v201, v201, v198
    v_add_f32 v201, v201, v199
    v_add_f32 v201, v201, v252
    v_add_f32 v201, v201, v255
    v_cvt_pk_bf16_f32 v234, v198, v199
    v_cvt_pk_bf16_f32 v235, v252, v255
    v_sub_f32 v198, v124, v196
    v_sub_f32 v199, v125, v196
    v_sub_f32 v252, v126, v196
    v_sub_f32 v255, v127, v196
    v_exp_f32 v198, v198
    v_exp_f32 v199, v199
    v_exp_f32 v252, v252
    v_exp_f32 v255, v255
    s_nop 0
    v_add_f32 v201, v201, v198
    v_add_f32 v201, v201, v199
    v_add_f32 v201, v201, v252
    v_add_f32 v201, v201, v255
    v_cvt_pk_bf16_f32 v244, v198, v199
    v_cvt_pk_bf16_f32 v245, v252, v255
    v_sub_f32 v198, v136, v196
    v_sub_f32 v199, v137, v196
    v_sub_f32 v252, v138, v196
    v_sub_f32 v255, v139, v196
    v_exp_f32 v198, v198
    v_exp_f32 v199, v199
    v_exp_f32 v252, v252
    v_exp_f32 v255, v255
    s_nop 0
    v_add_f32 v201, v201, v198
    v_add_f32 v201, v201, v199
    v_add_f32 v201, v201, v252
    v_add_f32 v201, v201, v255
    v_cvt_pk_bf16_f32 v246, v198, v199
    v_cvt_pk_bf16_f32 v247, v252, v255
    v_mul_f32 v202, v205, v194
    v_sub_f32 v198, v104, v197
    v_sub_f32 v199, v105, v197
    v_sub_f32 v252, v106, v197
    v_sub_f32 v255, v107, v197
    v_exp_f32 v198, v198
    v_exp_f32 v199, v199
    v_exp_f32 v252, v252
    v_exp_f32 v255, v255
    s_nop 0
    v_add_f32 v202, v202, v198
    v_add_f32 v202, v202, v199
    v_add_f32 v202, v202, v252
    v_add_f32 v202, v202, v255
    v_cvt_pk_bf16_f32 v236, v198, v199
    v_cvt_pk_bf16_f32 v237, v252, v255
    v_sub_f32 v198, v116, v197
    v_sub_f32 v199, v117, v197
    v_sub_f32 v252, v118, v197
    v_sub_f32 v255, v119, v197
    v_exp_f32 v198, v198
    v_exp_f32 v199, v199
    v_exp_f32 v252, v252
    v_exp_f32 v255, v255
    s_nop 0
    v_add_f32 v202, v202, v198
    v_add_f32 v202, v202, v199
    v_add_f32 v202, v202, v252
    v_add_f32 v202, v202, v255
    v_cvt_pk_bf16_f32 v238, v198, v199
    v_cvt_pk_bf16_f32 v239, v252, v255
    v_sub_f32 v198, v128, v197
    v_sub_f32 v199, v129, v197
    v_sub_f32 v252, v130, v197
    v_sub_f32 v255, v131, v197
    v_exp_f32 v198, v198
    v_exp_f32 v199, v199
    v_exp_f32 v252, v252
    v_exp_f32 v255, v255
    s_nop 0
    v_add_f32 v202, v202, v198
    v_add_f32 v202, v202, v199
    v_add_f32 v202, v202, v252
    v_add_f32 v202, v202, v255
    v_cvt_pk_bf16_f32 v248, v198, v199
    v_cvt_pk_bf16_f32 v249, v252, v255
    v_sub_f32 v198, v140, v197
    v_sub_f32 v199, v141, v197
    v_sub_f32 v252, v142, v197
    v_sub_f32 v255, v143, v197
    v_exp_f32 v198, v198
    v_exp_f32 v199, v199
    v_exp_f32 v252, v252
    v_exp_f32 v255, v255
    s_nop 0
    v_add_f32 v202, v202, v198
    v_add_f32 v202, v202, v199
    v_add_f32 v202, v202, v252
    v_add_f32 v202, v202, v255
    v_cvt_pk_bf16_f32 v250, v198, v199
    v_cvt_pk_bf16_f32 v251, v252, v255
    s_nop 3
    s_setpc_b64 s[30:31]
    s_endpgm
.section .rodata,"a"
.p2align 6
.amdhsa_kernel standalone__mha_softmax__near_ridge_kernel
  .amdhsa_next_free_vgpr 512
  .amdhsa_next_free_sgpr 100
  .amdhsa_accum_offset 256
  .amdhsa_group_segment_fixed_size 0
  .amdhsa_kernarg_size 48
  .amdhsa_user_sgpr_count 2
  .amdhsa_user_sgpr_kernarg_segment_ptr 1
  .amdhsa_system_sgpr_workgroup_id_x 1
.end_amdhsa_kernel
```
